```python
import torch

def _softmax(x, axis=-1):
    return torch.softmax(x, dim=axis)
def _gelu(x):
    return torch.nn.functional.gelu(x, approximate="tanh")
def _silu(x):
    return torch.nn.functional.silu(x)
def _sigmoid(x):
    return torch.sigmoid(x)
def _layernorm(x, axis=-1, eps=1e-5):
    m = x.mean(dim=axis, keepdim=True)
    v = x.var(dim=axis, keepdim=True, unbiased=False)
    return (x - m) / torch.sqrt(v + eps)
def _scatter_add(tgt, idx, src, axis=0):
    return tgt.clone().index_add_(axis, idx, src)
def _segment_sum(src, seg, n):
    out = torch.zeros((n,) + src.shape[1:], dtype=src.dtype)
    return out.index_add_(0, seg, src)
def _pad(x, pw):
    flat = tuple(v for pair in reversed(pw) for v in pair)
    return torch.nn.functional.pad(x, flat)

kernel_name = 'recurrent_scan__sliding_local_dilated__glu_gated_geglu__prompt'

def setup_inputs():

    _w = (lambda a: (lambda t: t.to(torch.bfloat16) if t.is_floating_point() else t)(torch.as_tensor(a)))
    def _A_setup():
        B, S, D = 1, 2048, 512
        return {
            "x": _w((lambda *s: torch.randn(*s, dtype=torch.bfloat16) * 0.05)(B, S, D)),
            "wqkv": _w((lambda *s: torch.randn(*s, dtype=torch.bfloat16) * 0.2)(D, 3 * D)),
            "wo": _w((lambda *s: torch.randn(*s, dtype=torch.bfloat16) * 0.2)(D, D)),
        }
    _A_in = _A_setup()

    def _B_setup():
        B, S, Dm, Df = 1, 2048, 512, 1792
        return {
            "x": _w((lambda *s: torch.randn(*s, dtype=torch.bfloat16) * 0.05)(B, S, Dm)),
            "w_gate": _w((lambda *s: torch.randn(*s, dtype=torch.bfloat16) * 0.1)(Dm, Df) * (Dm ** -0.5)),
            "w_up": _w((lambda *s: torch.randn(*s, dtype=torch.bfloat16) * 0.1)(Dm, Df) * (Dm ** -0.5)),
            "w_down": _w((lambda *s: torch.randn(*s, dtype=torch.bfloat16) * 0.1)(Df, Dm) * (Df ** -0.5)),
        }
    _B_in = _B_setup()

    return {
        "A_x": _A_in["x"],
        "A_wqkv": _A_in["wqkv"],
        "A_wo": _A_in["wo"],
        "B_x": _B_in["x"],
        "B_w_gate": _B_in["w_gate"],
        "B_w_up": _B_in["w_up"],
        "B_w_down": _B_in["w_down"],
    }

def reference(A_x, A_wqkv, A_wo, B_x, B_w_gate, B_w_up, B_w_down):
    def _A_ref(x, wqkv, wo):
        B, S, D = x.shape
        H = 32; Dh = D // H
        W, dil = 8, 2
        qkv = (lambda x, *d: x.permute(*d))((x @ wqkv).reshape(B, S, 3, H, Dh), 2, 0, 3, 1, 4)
        q, k, v = qkv[0], qkv[1], qkv[2]
        scale = Dh ** -0.5
        pos = torch.arange(S)
        off = torch.arange(W) * dil
        idx = pos[:, None] - off[None, :]
        mask = idx >= 0
        idx_c = torch.where(mask, idx, 0).reshape(-1)
        kg = k[:, :, idx_c, :].reshape(B, H, S, W, Dh)
        vg = v[:, :, idx_c, :].reshape(B, H, S, W, Dh)
        logits = torch.einsum("bhsd,bhswd->bhsw", q, kg) * scale
        logits = torch.where(mask[None, None, :, :], logits, -1e9)
        attn = _softmax(logits, axis=-1)
        o = torch.einsum("bhsw,bhswd->bhsd", attn, vg)
        return (lambda x, *d: x.permute(*d))(o, 0, 2, 1, 3).reshape(B, S, D) @ wo

    def _B_ref(x, w_gate, w_up, w_down):
        g = torch.einsum("bsd,df->bsf", x, w_gate)
        u = torch.einsum("bsd,df->bsf", x, w_up)
        h = _gelu(g) * u
        return torch.einsum("bsf,fd->bsd", h, w_down)

    x = A_x
    xn = _layernorm(x, axis=-1)
    s = _A_ref(xn, A_wqkv, A_wo)
    g = _silu(_B_ref(xn, B_w_gate, B_w_up, B_w_down))
    return x + s * g
```

```asm
; @launch grid=(256,1,1) block=(512,1,1) lds=156032
.amdgcn_target "amdgcn-amd-amdhsa--gfx950"
.text
.globl recurrent_scan__sliding_local_dilated__glu_gated_geglu__prompt_kernel
.p2align 8
.type recurrent_scan__sliding_local_dilated__glu_gated_geglu__prompt_kernel,@function
recurrent_scan__sliding_local_dilated__glu_gated_geglu__prompt_kernel:
  s_cmp_ge_u32 s2, 256
  s_cbranch_scc1 K_end
  s_load_dwordx4 s[4:7], s[0:1], 0
  s_load_dwordx4 s[8:11], s[0:1], 32
  s_load_dwordx2 s[12:13], s[0:1], 72
  v_lshrrev_b32 v1, 6, v0
  v_and_b32 v0, 63, v0
  v_readfirstlane_b32 s43, v1
  s_and_b32 s60, s2, 7
  s_lshr_b32 s61, s2, 3
  s_and_b32 s40, s61, 15
  s_and_b32 s63, s61, 7
  s_lshl_b32 s62, s60, 1
  s_lshr_b32 s41, s61, 4
  s_or_b32 s41, s62, s41
  s_lshl_b32 s46, s40, 17
  s_lshl_b32 s52, s63, 7
  s_or_b32 s52, s52, s46
  s_lshl_b32 s55, s63, 11
  s_lshl_b32 s47, s63, 1
  s_lshl_b32 s48, s43, 10
  s_add_u32 s48, s48, 81920
  s_mov_b32 s53, s48
  s_add_u32 s75, s48, 0xc000
  v_lshrrev_b32 v20, 3, v0
  s_lshl_b32 s60, s43, 3
  v_add_u32 v22, s60, v20
  v_bfe_u32 v23, v22, 1, 3
  v_and_b32 v24, 7, v0
  v_xor_b32 v24, v24, v23
  v_lshlrev_b32 v24, 4, v24
  v_lshl_add_u32 v4, v22, 10, v24
  v_add_u32 v5, 0x10000, v4
  v_lshlrev_b32 v32, 4, v0
  s_lshl_b32 s62, s41, 3
  s_add_u32 s62, s62, s43
  s_lshl_b32 s62, s62, 10
  s_add_u32 s62, s62, s46
  s_and_b32 s44, s43, 3
  s_lshr_b32 s45, s43, 2
  s_lshr_b32 s42, s41, 1
  s_lshl_b32 s58, s44, 10
  s_waitcnt lgkmcnt(0)
  s_mov_b32 s16, s4
  s_and_b32 s17, s5, 0xffff
  s_mov_b32 s18, 0x200000
  s_mov_b32 s19, 0x20000
  buffer_load_dwordx4 v[212:215], v32, s[16:19], s62 offen
  s_add_u32 m0, s53, 0
  s_nop 0
  buffer_load_dwordx4 v4, s[16:19], s52 offen lds
  s_add_u32 m0, s53, 8192
  s_nop 0
  buffer_load_dwordx4 v5, s[16:19], s52 offen lds
  s_add_u32 s60, s52, 128
  s_and_b32 s60, s60, 0x380
  s_or_b32 s52, s60, s46
  s_add_u32 s53, s53, 0x4000
  s_cmp_eq_u32 s53, s75
  s_cselect_b32 s53, s48, s53
  s_and_b32 s60, s41, 1
  s_lshl_b32 s60, s60, 1
  s_or_b32 s60, s60, s45
  s_cmp_eq_u32 s60, 1
  s_cbranch_scc1 P1_X1
  s_cmp_eq_u32 s60, 2
  s_cbranch_scc1 P1_Y0
  s_cmp_eq_u32 s60, 3
  s_cbranch_scc1 P1_Y1
P1_X0:
  v_lshrrev_b32 v20, 3, v0
  s_lshl_b32 s60, s44, 3
  v_add_u32 v20, s60, v20
  v_mul_u32_u24 v20, 3072, v20
  v_bfe_u32 v21, v0, 4, 1
  s_and_b32 s60, s44, 1
  s_lshl_b32 s60, s60, 1
  v_or_b32 v21, s60, v21
  v_bfe_u32 v22, v0, 1, 2
  v_xor_b32 v21, v21, v22
  v_lshl_add_u32 v20, v21, 5, v20
  v_and_b32 v22, 1, v0
  v_lshl_add_u32 v1, v22, 4, v20
  s_lshl_b32 s49, s42, 7
  v_add_u32 v1, s49, v1
  v_add_u32 v2, 1024, v1
  v_add_u32 v3, 2048, v1
  s_mul_i32 s47, s47, 98304
  s_mov_b32 s20, s6
  s_and_b32 s21, s7, 0xffff
  s_mov_b32 s22, 0x180000
  s_mov_b32 s23, 0x20000
  s_add_u32 m0, s58, 0
  s_nop 0
  buffer_load_dwordx4 v1, s[20:23], s47 offen lds
  s_add_u32 m0, s58, 4096
  s_nop 0
  buffer_load_dwordx4 v2, s[20:23], s47 offen lds
  s_add_u32 m0, s58, 8192
  s_nop 0
  buffer_load_dwordx4 v3, s[20:23], s47 offen lds
  s_add_u32 s47, s47, 98304
  s_cmp_eq_u32 s47, 1572864
  s_cselect_b32 s47, 0, s47
  s_add_u32 m0, s58, 20480
  s_nop 0
  buffer_load_dwordx4 v1, s[20:23], s47 offen lds
  s_add_u32 m0, s58, 24576
  s_nop 0
  buffer_load_dwordx4 v2, s[20:23], s47 offen lds
  s_add_u32 m0, s58, 28672
  s_nop 0
  buffer_load_dwordx4 v3, s[20:23], s47 offen lds
  s_add_u32 s47, s47, 98304
  s_cmp_eq_u32 s47, 1572864
  s_cselect_b32 s47, 0, s47
  s_mov_b32 s32, s12
  s_and_b32 s33, s13, 0xffff
  s_mov_b32 s34, 0x970000
  s_mov_b32 s35, 0x20000
  s_load_dwordx2 s[70:71], s[0:1], 16
  s_load_dwordx2 s[72:73], s[0:1], 48
  s_load_dwordx2 s[14:15], s[0:1], 56
  s_and_b32 s60, s2, 7
  s_lshr_b32 s61, s2, 3
  s_lshr_b32 s63, s61, 3
  s_lshl_b32 s69, s60, 2
  s_add_u32 s69, s69, s63
  s_and_b32 s74, s61, 7
  s_mov_b32 s54, 0
  s_mov_b32 s56, 0
  s_lshr_b32 s60, s40, 3
  s_lshl_b32 s60, 1, s60
  s_cmp_eq_u32 s45, 0
  s_cselect_b32 s57, s60, 0
  s_mov_b32 s59, 99
  s_cmp_eq_u32 s43, 0
  s_cselect_b32 s60, 0x110, 0
  s_cselect_b32 s59, 2, 99
  s_or_b32 s57, s57, s60
  v_mov_b32 v43, 9830400
  v_mov_b32 v47, 9830400
  v_mov_b32 v40, 0
  s_cmp_eq_u32 s43, 0
  s_cbranch_scc0 L_noep_1
  v_mov_b32 v35, 9838592
  buffer_load_dword v40, v35, s[32:35], 0 offen sc1
L_noep_1:
  v_lshrrev_b32 v20, 3, v0
  v_lshrrev_b32 v21, 1, v20
  v_and_b32 v22, 7, v0
  v_xor_b32 v21, v21, v22
  s_lshl_b32 s60, s40, 7
  s_sub_u32 s60, s60, 16
  v_add_u32 v20, s60, v20
  v_max_i32 v20, 0, v20
  v_lshlrev_b32 v20, 10, v20
  v_lshl_add_u32 v33, v21, 4, v20
  v_lshrrev_b32 v20, 3, v0
  v_add_u32 v20, 8, v20
  v_lshrrev_b32 v21, 1, v20
  v_and_b32 v22, 7, v0
  v_xor_b32 v21, v21, v22
  s_lshl_b32 s60, s40, 7
  s_sub_u32 s60, s60, 16
  v_add_u32 v20, s60, v20
  v_max_i32 v20, 0, v20
  v_lshlrev_b32 v20, 10, v20
  v_lshl_add_u32 v34, v21, 4, v20
  v_lshrrev_b32 v20, 3, v0
  v_lshrrev_b32 v21, 4, v0
  v_and_b32 v25, 15, v0
  v_lshrrev_b32 v26, 1, v25
  v_xor_b32 v26, v26, v21
  v_lshlrev_b32 v26, 4, v26
  v_lshl_add_u32 v26, v25, 7, v26
  v_add_u32 v8, 131072, v26
  v_xor_b32 v9, 64, v8
  v_add_u32 v6, 81920, v26
  v_xor_b32 v7, 64, v6
  v_bfe_u32 v27, v0, 2, 2
  v_lshl_add_u32 v27, v21, 3, v27
  v_and_b32 v28, 3, v20
  v_xor_b32 v28, s44, v28
  v_lshlrev_b32 v28, 5, v28
  v_lshl_add_u32 v28, v27, 7, v28
  v_and_b32 v29, 3, v0
  v_lshl_add_u32 v10, v29, 3, v28
  v_add_u32 v11, 61440, v10
  v_mov_b32 v16, 0x3f803f80
  v_mov_b32 v17, 0x3f803f80
  v_mov_b32 v18, 0x3f803f80
  v_mov_b32 v19, 0x3f803f80
  s_mul_i32 s60, s41, 20480
  s_mul_i32 s61, s40, 1280
  s_add_u32 s60, s60, s61
  s_lshl_b32 s61, s44, 6
  s_add_u32 s60, s60, s61
  s_add_u32 s60, s60, 9453568
  v_lshlrev_b32 v42, 4, v21
  v_add_u32 v42, s60, v42
  v_cmp_eq_u32 vcc, 0, v25
  v_mov_b32 v31, 0x7fffff00
  s_nop 0
  v_cndmask_b32 v42, v31, v42, vcc
  v_mov_b32 v128, 0
  v_mov_b32 v129, 0
  v_mov_b32 v130, 0
  v_mov_b32 v131, 0
  v_mov_b32 v132, 0
  v_mov_b32 v133, 0
  v_mov_b32 v134, 0
  v_mov_b32 v135, 0
  v_mov_b32 v136, 0
  v_mov_b32 v137, 0
  v_mov_b32 v138, 0
  v_mov_b32 v139, 0
  v_mov_b32 v140, 0
  v_mov_b32 v141, 0
  v_mov_b32 v142, 0
  v_mov_b32 v143, 0
  v_mov_b32 v144, 0
  v_mov_b32 v145, 0
  v_mov_b32 v146, 0
  v_mov_b32 v147, 0
  v_mov_b32 v148, 0
  v_mov_b32 v149, 0
  v_mov_b32 v150, 0
  v_mov_b32 v151, 0
  v_mov_b32 v152, 0
  v_mov_b32 v153, 0
  v_mov_b32 v154, 0
  v_mov_b32 v155, 0
  v_mov_b32 v156, 0
  v_mov_b32 v157, 0
  v_mov_b32 v158, 0
  v_mov_b32 v159, 0
  v_mov_b32 v160, 0
  v_mov_b32 v161, 0
  v_mov_b32 v162, 0
  v_mov_b32 v163, 0
  v_mov_b32 v164, 0
  v_mov_b32 v165, 0
  v_mov_b32 v166, 0
  v_mov_b32 v167, 0
  v_mov_b32 v168, 0
  v_mov_b32 v169, 0
  v_mov_b32 v170, 0
  v_mov_b32 v171, 0
  v_mov_b32 v172, 0
  v_mov_b32 v173, 0
  v_mov_b32 v174, 0
  v_mov_b32 v175, 0
  v_mov_b32 v176, 0
  v_mov_b32 v177, 0
  v_mov_b32 v178, 0
  v_mov_b32 v179, 0
  v_mov_b32 v180, 0
  v_mov_b32 v181, 0
  v_mov_b32 v182, 0
  v_mov_b32 v183, 0
  v_mov_b32 v184, 0
  v_mov_b32 v185, 0
  v_mov_b32 v186, 0
  v_mov_b32 v187, 0
  v_mov_b32 v188, 0
  v_mov_b32 v189, 0
  v_mov_b32 v190, 0
  v_mov_b32 v191, 0
  v_mov_b32 v192, 0
  v_mov_b32 v193, 0
  v_mov_b32 v194, 0
  v_mov_b32 v195, 0
  v_mov_b32 v196, 0
  v_mov_b32 v197, 0
  v_mov_b32 v198, 0
  v_mov_b32 v199, 0
  v_mov_b32 v200, 0
  v_mov_b32 v201, 0
  v_mov_b32 v202, 0
  v_mov_b32 v203, 0
  v_mov_b32 v204, 0
  v_mov_b32 v205, 0
  v_mov_b32 v206, 0
  v_mov_b32 v207, 0
  v_mov_b32 v208, 0
  v_mov_b32 v209, 0
  v_mov_b32 v210, 0
  v_mov_b32 v211, 0
  v_lshlrev_b32 v24, 4, v0
  v_add_u32 v24, 149888, v24
  v_and_b32 v25, 48, v0
  s_lshl_b32 s60, s43, 6
  s_add_u32 s60, s60, 148608
  v_add_u32 v25, s60, v25
  v_and_b32 v26, 15, v0
  v_cmp_eq_u32 vcc, 0, v26
  s_lshl_b32 s61, s43, 6
  v_add_u32 v27, s61, v0
  v_cndmask_b32 v36, v24, v25, vcc
  s_cmp_lt_u32 s43, 4
  s_cselect_b64 s[64:65], vcc, 0
  v_add_u32 v25, 1024, v25
  v_cndmask_b32 v37, v24, v25, s[64:65]
  v_cmp_gt_u32 vcc, 144, v27
  v_lshlrev_b32 v27, 2, v27
  v_add_u32 v27, 147456, v27
  s_nop 0
  v_cndmask_b32 v38, v24, v27, vcc
  s_lshl_b32 s68, s45, 12
  s_lshl_b32 s60, s44, 10
  s_add_u32 s68, s68, s60
  v_lshrrev_b32 v24, 3, v0
  s_lshl_b32 s60, s44, 3
  v_add_u32 v24, s60, v24
  v_lshlrev_b32 v24, 10, v24
  v_bfe_u32 v25, v0, 4, 1
  s_and_b32 s60, s44, 1
  s_lshl_b32 s60, s60, 1
  v_or_b32 v25, s60, v25
  v_bfe_u32 v26, v0, 1, 2
  v_xor_b32 v25, v25, v26
  v_lshl_add_u32 v24, v25, 5, v24
  v_and_b32 v26, 1, v0
  v_lshl_add_u32 v24, v26, 4, v24
  s_lshl_b32 s60, s74, 7
  v_add_u32 v41, s60, v24
  s_cmp_eq_u32 s43, 0
  s_cbranch_scc0 L_halo0_2
  s_lshr_b32 s60, s55, 11
  s_add_u32 s60, s60, s43
  s_and_b32 s60, s60, 7
  s_lshl_b32 s61, s60, 11
  s_add_u32 m0, s61, 131072
  s_lshl_b32 s61, s60, 7
  buffer_load_dwordx4 v33, s[16:19], s61 offen lds
  s_lshl_b32 s61, s60, 11
  s_add_u32 m0, s61, 132096
  s_lshl_b32 s61, s60, 7
  buffer_load_dwordx4 v34, s[16:19], s61 offen lds
L_halo0_2:
  s_add_u32 m0, s53, 0
  s_nop 0
  buffer_load_dwordx4 v4, s[16:19], s52 offen lds
  s_add_u32 m0, s53, 8192
  s_nop 0
  buffer_load_dwordx4 v5, s[16:19], s52 offen lds
  s_add_u32 s60, s52, 128
  s_and_b32 s60, s60, 0x380
  s_or_b32 s52, s60, s46
  s_add_u32 s53, s53, 0x4000
  s_cmp_eq_u32 s53, s75
  s_cselect_b32 s53, s48, s53
  s_cmp_eq_u32 s43, 1
  s_cbranch_scc0 L_halo1_3
  s_lshr_b32 s60, s55, 11
  s_add_u32 s60, s60, s43
  s_and_b32 s60, s60, 7
  s_lshl_b32 s61, s60, 11
  s_add_u32 m0, s61, 131072
  s_lshl_b32 s61, s60, 7
  buffer_load_dwordx4 v33, s[16:19], s61 offen lds
  s_lshl_b32 s61, s60, 11
  s_add_u32 m0, s61, 132096
  s_lshl_b32 s61, s60, 7
  buffer_load_dwordx4 v34, s[16:19], s61 offen lds
L_halo1_3:
  s_waitcnt vmcnt(10)
  v_lshlrev_b32 v20, 16, v212
  v_and_b32 v21, 0xffff0000, v212
  v_lshlrev_b32 v22, 16, v213
  v_and_b32 v23, 0xffff0000, v213
  v_lshlrev_b32 v24, 16, v214
  v_and_b32 v25, 0xffff0000, v214
  v_lshlrev_b32 v26, 16, v215
  v_and_b32 v27, 0xffff0000, v215
  v_add_f32 v28, v20, v21
  v_add_f32 v29, v22, v23
  v_add_f32 v30, v24, v25
  v_add_f32 v31, v26, v27
  v_add_f32 v28, v28, v29
  v_add_f32 v30, v30, v31
  v_add_f32 v28, v28, v30
  s_nop 1
  v_add_f32_dpp v28, v28, v28 row_ror:8 row_mask:0xf bank_mask:0xf
  s_nop 1
  v_add_f32_dpp v28, v28, v28 row_ror:4 row_mask:0xf bank_mask:0xf
  s_nop 1
  v_add_f32_dpp v28, v28, v28 row_ror:2 row_mask:0xf bank_mask:0xf
  s_nop 1
  v_add_f32_dpp v28, v28, v28 row_ror:1 row_mask:0xf bank_mask:0xf
  s_nop 1
  v_mov_b32 v29, v28
  s_nop 1
  v_permlane16_swap_b32 v28, v29
  s_nop 1
  v_add_f32 v28, v28, v29
  s_nop 0
  v_mov_b32 v29, v28
  s_nop 1
  v_permlane32_swap_b32 v28, v29
  s_nop 1
  v_add_f32 v28, v28, v29
  s_nop 0
  v_mul_f32 v28, 0x3b000000, v28
  v_sub_f32 v20, v20, v28
  v_sub_f32 v21, v21, v28
  v_sub_f32 v22, v22, v28
  v_sub_f32 v23, v23, v28
  v_sub_f32 v24, v24, v28
  v_sub_f32 v25, v25, v28
  v_sub_f32 v26, v26, v28
  v_sub_f32 v27, v27, v28
  v_mul_f32 v29, v20, v20
  v_mul_f32 v30, v21, v21
  v_fmac_f32 v29, v22, v22
  v_fmac_f32 v30, v23, v23
  v_fmac_f32 v29, v24, v24
  v_fmac_f32 v30, v25, v25
  v_fmac_f32 v29, v26, v26
  v_fmac_f32 v30, v27, v27
  v_add_f32 v29, v29, v30
  s_nop 1
  v_add_f32_dpp v29, v29, v29 row_ror:8 row_mask:0xf bank_mask:0xf
  s_nop 1
  v_add_f32_dpp v29, v29, v29 row_ror:4 row_mask:0xf bank_mask:0xf
  s_nop 1
  v_add_f32_dpp v29, v29, v29 row_ror:2 row_mask:0xf bank_mask:0xf
  s_nop 1
  v_add_f32_dpp v29, v29, v29 row_ror:1 row_mask:0xf bank_mask:0xf
  s_nop 1
  v_mov_b32 v30, v29
  s_nop 1
  v_permlane16_swap_b32 v29, v30
  s_nop 1
  v_add_f32 v29, v29, v30
  s_nop 0
  v_mov_b32 v30, v29
  s_nop 1
  v_permlane32_swap_b32 v29, v30
  s_nop 1
  v_add_f32 v29, v29, v30
  s_nop 0
  v_mov_b32 v30, 0x3727c5ac
  v_fmac_f32 v30, 0x3b000000, v29
  v_rsq_f32 v29, v30
  s_lshl_b32 s60, s41, 3
  s_add_u32 s60, s60, s43
  s_lshl_b32 s61, s40, 7
  s_add_u32 s60, s60, s61
  s_lshl_b32 s60, s60, 3
  s_add_u32 s60, s60, 9437184
  v_mov_b32 v30, 0x7fffff00
  v_writelane_b32 v30, s60, 0
  s_nop 1
  buffer_store_dwordx2 v[28:29], v30, s[32:35], 0 offen sc1
  s_cmp_eq_u32 s43, 1
  s_cbranch_scc0 L_w0_4
  s_waitcnt vmcnt(5)
  s_branch L_w1_5
L_w0_4:
  s_waitcnt vmcnt(3)
L_w1_5:
  s_barrier
  v_add_u32 v14, s54, v6
  v_add_u32 v15, s55, v8
  ds_read_b64_tr_b16 v[48:49], v10 offset:0
  ds_read_b64_tr_b16 v[50:51], v10 offset:512
  ds_read_b64_tr_b16 v[52:53], v10 offset:4096
  ds_read_b64_tr_b16 v[54:55], v10 offset:4608
  ds_read_b128 v[88:91], v14 offset:0
  ds_read_b64_tr_b16 v[56:57], v10 offset:8192
  ds_read_b64_tr_b16 v[58:59], v10 offset:8704
  ds_read_b128 v[92:95], v14 offset:2048
  ds_read_b64_tr_b16 v[60:61], v10 offset:12288
  ds_read_b64_tr_b16 v[62:63], v10 offset:12800
  ds_read_b128 v[96:99], v14 offset:4096
  ds_read_b64_tr_b16 v[64:65], v10 offset:16384
  ds_read_b64_tr_b16 v[66:67], v10 offset:16896
  ds_read_b128 v[100:103], v14 offset:6144
  ds_read_b128 v[104:107], v15
  s_add_u32 m0, s58, 40960
  s_nop 0
  buffer_load_dwordx4 v1, s[20:23], s47 offen lds
  s_add_u32 m0, s58, 45056
  s_nop 0
  buffer_load_dwordx4 v2, s[20:23], s47 offen lds
  s_add_u32 m0, s58, 49152
  s_nop 0
  buffer_load_dwordx4 v3, s[20:23], s47 offen lds
  s_add_u32 s47, s47, 98304
  s_cmp_eq_u32 s47, 1572864
  s_cselect_b32 s47, 0, s47
  s_cmp_lt_u32 s43, 2
  s_cbranch_scc1 L_halo2_6
  s_lshr_b32 s60, s55, 11
  s_add_u32 s60, s60, s43
  s_and_b32 s60, s60, 7
  s_lshl_b32 s61, s60, 11
  s_add_u32 m0, s61, 131072
  s_lshl_b32 s61, s60, 7
  buffer_load_dwordx4 v33, s[16:19], s61 offen lds
  s_lshl_b32 s61, s60, 11
  s_add_u32 m0, s61, 132096
  s_lshl_b32 s61, s60, 7
  buffer_load_dwordx4 v34, s[16:19], s61 offen lds
L_halo2_6:
  s_add_u32 m0, s58, 61440
  s_nop 0
  buffer_load_dwordx4 v1, s[20:23], s47 offen lds
  s_add_u32 m0, s58, 65536
  s_nop 0
  buffer_load_dwordx4 v2, s[20:23], s47 offen lds
  s_add_u32 m0, s58, 69632
  s_nop 0
  buffer_load_dwordx4 v3, s[20:23], s47 offen lds
  s_add_u32 s47, s47, 98304
  s_cmp_eq_u32 s47, 1572864
  s_cselect_b32 s47, 0, s47
  s_add_u32 m0, s53, 0
  s_nop 0
  buffer_load_dwordx4 v4, s[16:19], s52 offen lds
P1_X0_loop:
  s_waitcnt vmcnt(8) lgkmcnt(0)
  s_barrier
  v_mfma_f32_16x16x32_bf16 v[128:131], v[48:51], v[88:91], v[128:131]
  v_add_u32 v14, s54, v7
  ds_read_b64_tr_b16 v[68:69], v10 offset:20480
  v_mfma_f32_16x16x32_bf16 v[144:147], v[52:55], v[88:91], v[144:147]
  v_add_u32 v15, s55, v9
  ds_read_b64_tr_b16 v[70:71], v10 offset:20992
  v_mfma_f32_16x16x32_bf16 v[160:163], v[88:91], v[56:59], v[160:163]
  ds_read_b64_tr_b16 v[72:73], v10 offset:24576
  s_add_u32 m0, s58, 0
  v_mfma_f32_16x16x32_bf16 v[176:179], v[60:63], v[88:91], v[176:179]
  ds_read_b64_tr_b16 v[74:75], v10 offset:25088
  buffer_load_dwordx4 v1, s[20:23], s47 offen lds
  v_mfma_f32_16x16x32_bf16 v[192:195], v[64:67], v[88:91], v[192:195]
  ds_read_b128 v[108:111], v14 offset:0
  v_mfma_f32_16x16x32_bf16 v[132:135], v[48:51], v[92:95], v[132:135]
  ds_read_b64_tr_b16 v[76:77], v10 offset:28672
  v_mfma_f32_16x16x32_bf16 v[148:151], v[52:55], v[92:95], v[148:151]
  ds_read_b64_tr_b16 v[78:79], v10 offset:29184
  v_mfma_f32_16x16x32_bf16 v[164:167], v[92:95], v[56:59], v[164:167]
  ds_read_b128 v[112:115], v14 offset:2048
  s_add_u32 m0, s58, 4096
  v_mfma_f32_16x16x32_bf16 v[180:183], v[60:63], v[92:95], v[180:183]
  ds_read_b64_tr_b16 v[80:81], v10 offset:32768
  buffer_load_dwordx4 v2, s[20:23], s47 offen lds
  v_mfma_f32_16x16x32_bf16 v[196:199], v[64:67], v[92:95], v[196:199]
  ds_read_b64_tr_b16 v[82:83], v10 offset:33280
  v_mfma_f32_16x16x32_bf16 v[136:139], v[48:51], v[96:99], v[136:139]
  ds_read_b128 v[116:119], v14 offset:4096
  v_mfma_f32_16x16x32_bf16 v[152:155], v[52:55], v[96:99], v[152:155]
  ds_read_b64_tr_b16 v[84:85], v10 offset:36864
  v_mfma_f32_16x16x32_bf16 v[168:171], v[96:99], v[56:59], v[168:171]
  ds_read_b64_tr_b16 v[86:87], v10 offset:37376
  s_add_u32 m0, s58, 8192
  v_mfma_f32_16x16x32_bf16 v[184:187], v[60:63], v[96:99], v[184:187]
  ds_read_b128 v[120:123], v14 offset:6144
  buffer_load_dwordx4 v3, s[20:23], s47 offen lds
  v_mfma_f32_16x16x32_bf16 v[200:203], v[64:67], v[96:99], v[200:203]
  ds_read_b128 v[124:127], v15
  s_add_u32 s47, s47, 98304
  s_cmp_eq_u32 s47, 1572864
  s_cselect_b32 s47, 0, s47
  v_mfma_f32_16x16x32_bf16 v[140:143], v[48:51], v[100:103], v[140:143]
  v_mfma_f32_16x16x32_bf16 v[156:159], v[52:55], v[100:103], v[156:159]
  v_mfma_f32_16x16x32_bf16 v[172:175], v[100:103], v[56:59], v[172:175]
  s_add_u32 m0, s53, 8192
  v_mfma_f32_16x16x32_bf16 v[188:191], v[60:63], v[100:103], v[188:191]
  buffer_load_dwordx4 v5, s[16:19], s52 offen lds
  v_mfma_f32_16x16x32_bf16 v[204:207], v[64:67], v[100:103], v[204:207]
  s_add_u32 s60, s52, 128
  s_and_b32 s60, s60, 0x380
  s_or_b32 s52, s60, s46
  v_mfma_f32_16x16x32_bf16 v[208:211], v[52:55], v[104:107], v[208:211]
  s_add_u32 s53, s53, 0x4000
  s_cmp_eq_u32 s53, s75
  s_cselect_b32 s53, s48, s53
  s_bitcmp1_b32 s57, 0
  s_cbranch_scc1 L_ev_7
L_evback_8:
  s_waitcnt vmcnt(8) lgkmcnt(0)
  s_barrier
  v_mfma_f32_16x16x32_bf16 v[128:131], v[68:71], v[108:111], v[128:131]
  s_add_u32 s54, s54, 0x4000
  s_cmp_eq_u32 s54, 0xc000
  s_cselect_b32 s54, 0, s54
  ds_read_b64_tr_b16 v[48:49], v10 offset:40960
  v_mfma_f32_16x16x32_bf16 v[144:147], v[72:75], v[108:111], v[144:147]
  v_add_u32 v14, s54, v6
  ds_read_b64_tr_b16 v[50:51], v10 offset:41472
  v_mfma_f32_16x16x32_bf16 v[160:163], v[108:111], v[76:79], v[160:163]
  s_add_u32 s55, s55, 0x800
  s_and_b32 s55, s55, 0x3fff
  v_add_u32 v15, s55, v8
  ds_read_b64_tr_b16 v[52:53], v10 offset:45056
  s_add_u32 m0, s58, 20480
  v_mfma_f32_16x16x32_bf16 v[176:179], v[80:83], v[108:111], v[176:179]
  ds_read_b64_tr_b16 v[54:55], v10 offset:45568
  buffer_load_dwordx4 v1, s[20:23], s47 offen lds
  v_mfma_f32_16x16x32_bf16 v[192:195], v[84:87], v[108:111], v[192:195]
  ds_read_b128 v[88:91], v14 offset:0
  v_mfma_f32_16x16x32_bf16 v[132:135], v[68:71], v[112:115], v[132:135]
  ds_read_b64_tr_b16 v[56:57], v10 offset:49152
  v_mfma_f32_16x16x32_bf16 v[148:151], v[72:75], v[112:115], v[148:151]
  ds_read_b64_tr_b16 v[58:59], v10 offset:49664
  v_mfma_f32_16x16x32_bf16 v[164:167], v[112:115], v[76:79], v[164:167]
  ds_read_b128 v[92:95], v14 offset:2048
  s_add_u32 m0, s58, 24576
  v_mfma_f32_16x16x32_bf16 v[180:183], v[80:83], v[112:115], v[180:183]
  ds_read_b64_tr_b16 v[60:61], v10 offset:53248
  buffer_load_dwordx4 v2, s[20:23], s47 offen lds
  v_mfma_f32_16x16x32_bf16 v[196:199], v[84:87], v[112:115], v[196:199]
  ds_read_b64_tr_b16 v[62:63], v10 offset:53760
  v_mfma_f32_16x16x32_bf16 v[136:139], v[68:71], v[116:119], v[136:139]
  ds_read_b128 v[96:99], v14 offset:4096
  v_mfma_f32_16x16x32_bf16 v[152:155], v[72:75], v[116:119], v[152:155]
  ds_read_b64_tr_b16 v[64:65], v10 offset:57344
  v_mfma_f32_16x16x32_bf16 v[168:171], v[116:119], v[76:79], v[168:171]
  ds_read_b64_tr_b16 v[66:67], v10 offset:57856
  s_add_u32 m0, s58, 28672
  v_mfma_f32_16x16x32_bf16 v[184:187], v[80:83], v[116:119], v[184:187]
  ds_read_b128 v[100:103], v14 offset:6144
  buffer_load_dwordx4 v3, s[20:23], s47 offen lds
  v_mfma_f32_16x16x32_bf16 v[200:203], v[84:87], v[116:119], v[200:203]
  ds_read_b128 v[104:107], v15
  s_add_u32 s47, s47, 98304
  s_cmp_eq_u32 s47, 1572864
  s_cselect_b32 s47, 0, s47
  v_mfma_f32_16x16x32_bf16 v[140:143], v[68:71], v[120:123], v[140:143]
  v_mfma_f32_16x16x32_bf16 v[156:159], v[72:75], v[120:123], v[156:159]
  v_mfma_f32_16x16x32_bf16 v[172:175], v[120:123], v[76:79], v[172:175]
  s_add_u32 m0, s53, 0
  v_mfma_f32_16x16x32_bf16 v[188:191], v[80:83], v[120:123], v[188:191]
  buffer_load_dwordx4 v4, s[16:19], s52 offen lds
  v_mfma_f32_16x16x32_bf16 v[204:207], v[84:87], v[120:123], v[204:207]
  v_mfma_f32_16x16x32_bf16 v[208:211], v[72:75], v[124:127], v[208:211]
  s_bitcmp1_b32 s57, 1
  s_cbranch_scc1 L_ev_1012
L_evback_1013:
  s_waitcnt vmcnt(8) lgkmcnt(0)
  s_barrier
  v_mfma_f32_16x16x32_bf16 v[128:131], v[48:51], v[88:91], v[128:131]
  v_add_u32 v14, s54, v7
  ds_read_b64_tr_b16 v[68:69], v11 offset:0
  v_mfma_f32_16x16x32_bf16 v[144:147], v[52:55], v[88:91], v[144:147]
  v_add_u32 v15, s55, v9
  ds_read_b64_tr_b16 v[70:71], v11 offset:512
  v_mfma_f32_16x16x32_bf16 v[160:163], v[88:91], v[56:59], v[160:163]
  ds_read_b64_tr_b16 v[72:73], v11 offset:4096
  s_add_u32 m0, s58, 40960
  v_mfma_f32_16x16x32_bf16 v[176:179], v[60:63], v[88:91], v[176:179]
  ds_read_b64_tr_b16 v[74:75], v11 offset:4608
  buffer_load_dwordx4 v1, s[20:23], s47 offen lds
  v_mfma_f32_16x16x32_bf16 v[192:195], v[64:67], v[88:91], v[192:195]
  ds_read_b128 v[108:111], v14 offset:0
  v_mfma_f32_16x16x32_bf16 v[132:135], v[48:51], v[92:95], v[132:135]
  ds_read_b64_tr_b16 v[76:77], v11 offset:8192
  v_mfma_f32_16x16x32_bf16 v[148:151], v[52:55], v[92:95], v[148:151]
  ds_read_b64_tr_b16 v[78:79], v11 offset:8704
  v_mfma_f32_16x16x32_bf16 v[164:167], v[92:95], v[56:59], v[164:167]
  ds_read_b128 v[112:115], v14 offset:2048
  s_add_u32 m0, s58, 45056
  v_mfma_f32_16x16x32_bf16 v[180:183], v[60:63], v[92:95], v[180:183]
  ds_read_b64_tr_b16 v[80:81], v11 offset:12288
  buffer_load_dwordx4 v2, s[20:23], s47 offen lds
  v_mfma_f32_16x16x32_bf16 v[196:199], v[64:67], v[92:95], v[196:199]
  ds_read_b64_tr_b16 v[82:83], v11 offset:12800
  v_mfma_f32_16x16x32_bf16 v[136:139], v[48:51], v[96:99], v[136:139]
  ds_read_b128 v[116:119], v14 offset:4096
  v_mfma_f32_16x16x32_bf16 v[152:155], v[52:55], v[96:99], v[152:155]
  ds_read_b64_tr_b16 v[84:85], v11 offset:16384
  v_mfma_f32_16x16x32_bf16 v[168:171], v[96:99], v[56:59], v[168:171]
  ds_read_b64_tr_b16 v[86:87], v11 offset:16896
  s_add_u32 m0, s58, 49152
  v_mfma_f32_16x16x32_bf16 v[184:187], v[60:63], v[96:99], v[184:187]
  ds_read_b128 v[120:123], v14 offset:6144
  buffer_load_dwordx4 v3, s[20:23], s47 offen lds
  v_mfma_f32_16x16x32_bf16 v[200:203], v[64:67], v[96:99], v[200:203]
  ds_read_b128 v[124:127], v15
  s_add_u32 s47, s47, 98304
  s_cmp_eq_u32 s47, 1572864
  s_cselect_b32 s47, 0, s47
  v_mfma_f32_16x16x32_bf16 v[140:143], v[48:51], v[100:103], v[140:143]
  v_mfma_f32_16x16x32_bf16 v[156:159], v[52:55], v[100:103], v[156:159]
  v_mfma_f32_16x16x32_bf16 v[172:175], v[100:103], v[56:59], v[172:175]
  s_add_u32 m0, s53, 8192
  v_mfma_f32_16x16x32_bf16 v[188:191], v[60:63], v[100:103], v[188:191]
  buffer_load_dwordx4 v5, s[16:19], s52 offen lds
  v_mfma_f32_16x16x32_bf16 v[204:207], v[64:67], v[100:103], v[204:207]
  s_add_u32 s60, s52, 128
  s_and_b32 s60, s60, 0x380
  s_or_b32 s52, s60, s46
  v_mfma_f32_16x16x32_bf16 v[208:211], v[52:55], v[104:107], v[208:211]
  s_add_u32 s53, s53, 0x4000
  s_cmp_eq_u32 s53, s75
  s_cselect_b32 s53, s48, s53
  s_waitcnt vmcnt(8) lgkmcnt(0)
  s_cmp_eq_u32 s56, s59
  s_cbranch_scc1 L_chk_2015
L_chkback_2016:
  s_barrier
  v_mfma_f32_16x16x32_bf16 v[128:131], v[68:71], v[108:111], v[128:131]
  s_add_u32 s54, s54, 0x4000
  s_cmp_eq_u32 s54, 0xc000
  s_cselect_b32 s54, 0, s54
  ds_read_b64_tr_b16 v[48:49], v10 offset:0
  v_mfma_f32_16x16x32_bf16 v[144:147], v[72:75], v[108:111], v[144:147]
  v_add_u32 v14, s54, v6
  ds_read_b64_tr_b16 v[50:51], v10 offset:512
  v_mfma_f32_16x16x32_bf16 v[160:163], v[108:111], v[76:79], v[160:163]
  s_add_u32 s55, s55, 0x800
  s_and_b32 s55, s55, 0x3fff
  v_add_u32 v15, s55, v8
  ds_read_b64_tr_b16 v[52:53], v10 offset:4096
  s_add_u32 m0, s58, 61440
  v_mfma_f32_16x16x32_bf16 v[176:179], v[80:83], v[108:111], v[176:179]
  ds_read_b64_tr_b16 v[54:55], v10 offset:4608
  buffer_load_dwordx4 v1, s[20:23], s47 offen lds
  v_mfma_f32_16x16x32_bf16 v[192:195], v[84:87], v[108:111], v[192:195]
  ds_read_b128 v[88:91], v14 offset:0
  v_mfma_f32_16x16x32_bf16 v[132:135], v[68:71], v[112:115], v[132:135]
  ds_read_b64_tr_b16 v[56:57], v10 offset:8192
  v_mfma_f32_16x16x32_bf16 v[148:151], v[72:75], v[112:115], v[148:151]
  ds_read_b64_tr_b16 v[58:59], v10 offset:8704
  v_mfma_f32_16x16x32_bf16 v[164:167], v[112:115], v[76:79], v[164:167]
  ds_read_b128 v[92:95], v14 offset:2048
  s_add_u32 m0, s58, 65536
  v_mfma_f32_16x16x32_bf16 v[180:183], v[80:83], v[112:115], v[180:183]
  ds_read_b64_tr_b16 v[60:61], v10 offset:12288
  buffer_load_dwordx4 v2, s[20:23], s47 offen lds
  v_mfma_f32_16x16x32_bf16 v[196:199], v[84:87], v[112:115], v[196:199]
  ds_read_b64_tr_b16 v[62:63], v10 offset:12800
  v_mfma_f32_16x16x32_bf16 v[136:139], v[68:71], v[116:119], v[136:139]
  ds_read_b128 v[96:99], v14 offset:4096
  v_mfma_f32_16x16x32_bf16 v[152:155], v[72:75], v[116:119], v[152:155]
  ds_read_b64_tr_b16 v[64:65], v10 offset:16384
  v_mfma_f32_16x16x32_bf16 v[168:171], v[116:119], v[76:79], v[168:171]
  ds_read_b64_tr_b16 v[66:67], v10 offset:16896
  s_add_u32 m0, s58, 69632
  v_mfma_f32_16x16x32_bf16 v[184:187], v[80:83], v[116:119], v[184:187]
  ds_read_b128 v[100:103], v14 offset:6144
  buffer_load_dwordx4 v3, s[20:23], s47 offen lds
  v_mfma_f32_16x16x32_bf16 v[200:203], v[84:87], v[116:119], v[200:203]
  ds_read_b128 v[104:107], v15
  s_add_u32 s47, s47, 98304
  s_cmp_eq_u32 s47, 1572864
  s_cselect_b32 s47, 0, s47
  v_mfma_f32_16x16x32_bf16 v[140:143], v[68:71], v[120:123], v[140:143]
  v_mfma_f32_16x16x32_bf16 v[156:159], v[72:75], v[120:123], v[156:159]
  v_mfma_f32_16x16x32_bf16 v[172:175], v[120:123], v[76:79], v[172:175]
  s_add_u32 m0, s53, 0
  v_mfma_f32_16x16x32_bf16 v[188:191], v[80:83], v[120:123], v[188:191]
  buffer_load_dwordx4 v4, s[16:19], s52 offen lds
  v_mfma_f32_16x16x32_bf16 v[204:207], v[84:87], v[120:123], v[204:207]
  v_mfma_f32_16x16x32_bf16 v[208:211], v[72:75], v[124:127], v[208:211]
  s_lshr_b32 s57, s57, 4
  s_add_u32 s56, s56, 1
  s_cmp_lt_u32 s56, 3
  s_cbranch_scc1 P1_X0_loop
  s_waitcnt vmcnt(8) lgkmcnt(0)
  s_barrier
  v_mfma_f32_16x16x32_bf16 v[128:131], v[48:51], v[88:91], v[128:131]
  v_add_u32 v14, s54, v7
  ds_read_b64_tr_b16 v[68:69], v10 offset:20480
  s_mul_i32 s60, s41, 20480
  s_lshl_b32 s61, s43, 6
  s_add_u32 s60, s60, s61
  v_mfma_f32_16x16x32_bf16 v[144:147], v[52:55], v[88:91], v[144:147]
  v_add_u32 v15, s55, v9
  ds_read_b64_tr_b16 v[70:71], v10 offset:20992
  s_add_u32 s60, s60, 9453568
  v_and_b32 v20, 15, v0
  v_mfma_f32_16x16x32_bf16 v[160:163], v[88:91], v[56:59], v[160:163]
  ds_read_b64_tr_b16 v[72:73], v10 offset:24576
  v_mul_u32_u24 v20, 1280, v20
  v_lshrrev_b32 v21, 4, v0
  v_lshl_add_u32 v20, v21, 4, v20
  v_mfma_f32_16x16x32_bf16 v[176:179], v[60:63], v[88:91], v[176:179]
  ds_read_b64_tr_b16 v[74:75], v10 offset:25088
  v_add_u32 v20, s60, v20
  buffer_load_dwordx4 v[212:215], v20, s[32:35], 0 offen sc1
  v_mfma_f32_16x16x32_bf16 v[192:195], v[64:67], v[88:91], v[192:195]
  ds_read_b128 v[108:111], v14 offset:0
  buffer_load_dwordx4 v[216:219], v20, s[32:35], 0 offen offset:512 sc1
  buffer_load_dwordx4 v[220:223], v20, s[32:35], 0 offen offset:1024 sc1
  s_lshl_b32 s60, s43, 6
  v_mfma_f32_16x16x32_bf16 v[132:135], v[48:51], v[92:95], v[132:135]
  ds_read_b64_tr_b16 v[76:77], v10 offset:28672
  s_lshl_b32 s61, s40, 7
  s_add_u32 s60, s60, s61
  v_mfma_f32_16x16x32_bf16 v[148:151], v[52:55], v[92:95], v[148:151]
  ds_read_b64_tr_b16 v[78:79], v10 offset:29184
  s_sub_u32 s60, s60, 16
  v_add_u32 v22, s60, v0
  v_max_i32 v22, 0, v22
  v_mfma_f32_16x16x32_bf16 v[164:167], v[92:95], v[56:59], v[164:167]
  ds_read_b128 v[112:115], v14 offset:2048
  v_min_i32 v22, 2047, v22
  v_lshlrev_b32 v22, 3, v22
  v_mfma_f32_16x16x32_bf16 v[180:183], v[60:63], v[92:95], v[180:183]
  ds_read_b64_tr_b16 v[80:81], v10 offset:32768
  v_add_u32 v22, 9437184, v22
  buffer_load_dwordx2 v[224:225], v22, s[32:35], 0 offen sc1
  v_mfma_f32_16x16x32_bf16 v[196:199], v[64:67], v[92:95], v[196:199]
  ds_read_b64_tr_b16 v[82:83], v10 offset:33280
  v_mfma_f32_16x16x32_bf16 v[136:139], v[48:51], v[96:99], v[136:139]
  ds_read_b128 v[116:119], v14 offset:4096
  v_mfma_f32_16x16x32_bf16 v[152:155], v[52:55], v[96:99], v[152:155]
  ds_read_b64_tr_b16 v[84:85], v10 offset:36864
  v_mfma_f32_16x16x32_bf16 v[168:171], v[96:99], v[56:59], v[168:171]
  ds_read_b64_tr_b16 v[86:87], v10 offset:37376
  v_mfma_f32_16x16x32_bf16 v[184:187], v[60:63], v[96:99], v[184:187]
  ds_read_b128 v[120:123], v14 offset:6144
  v_mfma_f32_16x16x32_bf16 v[200:203], v[64:67], v[96:99], v[200:203]
  ds_read_b128 v[124:127], v15
  v_mfma_f32_16x16x32_bf16 v[140:143], v[48:51], v[100:103], v[140:143]
  v_mfma_f32_16x16x32_bf16 v[156:159], v[52:55], v[100:103], v[156:159]
  v_mfma_f32_16x16x32_bf16 v[172:175], v[100:103], v[56:59], v[172:175]
  v_mfma_f32_16x16x32_bf16 v[188:191], v[60:63], v[100:103], v[188:191]
  v_mfma_f32_16x16x32_bf16 v[204:207], v[64:67], v[100:103], v[204:207]
  v_mfma_f32_16x16x32_bf16 v[208:211], v[52:55], v[104:107], v[208:211]
  s_cmp_lt_u32 s43, 5
  s_cbranch_scc0 L_tch_3020
  s_mov_b32 s61, s43
  s_lshr_b32 s60, s2, 3
  s_mul_i32 s60, s60, 5
  s_add_u32 s60, s60, s61
  s_min_u32 s60, s60, 143
  s_add_u32 s61, s60, 64
  s_add_u32 s62, s60, 72
  s_cmp_lt_u32 s60, 72
  s_cselect_b32 s60, s61, s62
  s_lshl_b32 s60, s60, 13
  v_lshlrev_b32 v23, 7, v0
  v_add_u32 v23, s60, v23
  global_load_dword v45, v23, s[72:73]
L_tch_3020:
  s_waitcnt vmcnt(8) lgkmcnt(0)
  s_barrier
  v_mfma_f32_16x16x32_bf16 v[128:131], v[68:71], v[108:111], v[128:131]
  s_add_u32 s54, s54, 0x4000
  s_cmp_eq_u32 s54, 0xc000
  s_cselect_b32 s54, 0, s54
  ds_read_b64_tr_b16 v[48:49], v10 offset:40960
  v_mfma_f32_16x16x32_bf16 v[144:147], v[72:75], v[108:111], v[144:147]
  v_add_u32 v14, s54, v6
  ds_read_b64_tr_b16 v[50:51], v10 offset:41472
  v_mfma_f32_16x16x32_bf16 v[160:163], v[108:111], v[76:79], v[160:163]
  s_add_u32 s55, s55, 0x800
  s_and_b32 s55, s55, 0x3fff
  v_add_u32 v15, s55, v8
  ds_read_b64_tr_b16 v[52:53], v10 offset:45056
  v_mfma_f32_16x16x32_bf16 v[176:179], v[80:83], v[108:111], v[176:179]
  ds_read_b64_tr_b16 v[54:55], v10 offset:45568
  s_mov_b32 s20, s72
  v_mfma_f32_16x16x32_bf16 v[192:195], v[84:87], v[108:111], v[192:195]
  ds_read_b128 v[88:91], v14 offset:0
  v_mfma_f32_16x16x32_bf16 v[132:135], v[68:71], v[112:115], v[132:135]
  ds_read_b64_tr_b16 v[56:57], v10 offset:49152
  v_mfma_f32_16x16x32_bf16 v[148:151], v[72:75], v[112:115], v[148:151]
  ds_read_b64_tr_b16 v[58:59], v10 offset:49664
  s_and_b32 s21, s73, 0xffff
  v_mfma_f32_16x16x32_bf16 v[164:167], v[112:115], v[76:79], v[164:167]
  ds_read_b128 v[92:95], v14 offset:2048
  v_mfma_f32_16x16x32_bf16 v[180:183], v[80:83], v[112:115], v[180:183]
  ds_read_b64_tr_b16 v[60:61], v10 offset:53248
  v_mfma_f32_16x16x32_bf16 v[196:199], v[84:87], v[112:115], v[196:199]
  ds_read_b64_tr_b16 v[62:63], v10 offset:53760
  s_mov_b32 s22, 0x1c0000
  v_mfma_f32_16x16x32_bf16 v[136:139], v[68:71], v[116:119], v[136:139]
  ds_read_b128 v[96:99], v14 offset:4096
  v_mfma_f32_16x16x32_bf16 v[152:155], v[72:75], v[116:119], v[152:155]
  ds_read_b64_tr_b16 v[64:65], v10 offset:57344
  v_mfma_f32_16x16x32_bf16 v[168:171], v[116:119], v[76:79], v[168:171]
  ds_read_b64_tr_b16 v[66:67], v10 offset:57856
  s_mov_b32 s23, 0x20000
  v_mfma_f32_16x16x32_bf16 v[184:187], v[80:83], v[116:119], v[184:187]
  ds_read_b128 v[100:103], v14 offset:6144
  v_mfma_f32_16x16x32_bf16 v[200:203], v[84:87], v[116:119], v[200:203]
  ds_read_b128 v[104:107], v15
  v_mfma_f32_16x16x32_bf16 v[140:143], v[68:71], v[120:123], v[140:143]
  s_mul_i32 s66, s45, 655360
  v_mfma_f32_16x16x32_bf16 v[156:159], v[72:75], v[120:123], v[156:159]
  v_mfma_f32_16x16x32_bf16 v[172:175], v[120:123], v[76:79], v[172:175]
  v_mfma_f32_16x16x32_bf16 v[188:191], v[80:83], v[120:123], v[188:191]
  s_add_u32 s66, s66, 524288
  v_mfma_f32_16x16x32_bf16 v[204:207], v[84:87], v[120:123], v[204:207]
  v_mfma_f32_16x16x32_bf16 v[208:211], v[72:75], v[124:127], v[208:211]
  s_waitcnt vmcnt(5)
  s_waitcnt vmcnt(63) lgkmcnt(0)
  s_barrier
  v_mfma_f32_16x16x32_bf16 v[128:131], v[48:51], v[88:91], v[128:131]
  v_add_u32 v14, s54, v7
  ds_read_b64_tr_b16 v[68:69], v11 offset:0
  v_mfma_f32_16x16x32_bf16 v[144:147], v[52:55], v[88:91], v[144:147]
  v_add_u32 v15, s55, v9
  ds_read_b64_tr_b16 v[70:71], v11 offset:512
  v_mfma_f32_16x16x32_bf16 v[160:163], v[88:91], v[56:59], v[160:163]
  ds_read_b64_tr_b16 v[72:73], v11 offset:4096
  v_mfma_f32_16x16x32_bf16 v[176:179], v[60:63], v[88:91], v[176:179]
  ds_read_b64_tr_b16 v[74:75], v11 offset:4608
  v_mfma_f32_16x16x32_bf16 v[192:195], v[64:67], v[88:91], v[192:195]
  ds_read_b128 v[108:111], v14 offset:0
  v_mfma_f32_16x16x32_bf16 v[132:135], v[48:51], v[92:95], v[132:135]
  ds_read_b64_tr_b16 v[76:77], v11 offset:8192
  v_mfma_f32_16x16x32_bf16 v[148:151], v[52:55], v[92:95], v[148:151]
  ds_read_b64_tr_b16 v[78:79], v11 offset:8704
  v_mfma_f32_16x16x32_bf16 v[164:167], v[92:95], v[56:59], v[164:167]
  ds_read_b128 v[112:115], v14 offset:2048
  v_mfma_f32_16x16x32_bf16 v[180:183], v[60:63], v[92:95], v[180:183]
  ds_read_b64_tr_b16 v[80:81], v11 offset:12288
  v_mfma_f32_16x16x32_bf16 v[196:199], v[64:67], v[92:95], v[196:199]
  ds_read_b64_tr_b16 v[82:83], v11 offset:12800
  v_mfma_f32_16x16x32_bf16 v[136:139], v[48:51], v[96:99], v[136:139]
  ds_read_b128 v[116:119], v14 offset:4096
  v_mfma_f32_16x16x32_bf16 v[152:155], v[52:55], v[96:99], v[152:155]
  ds_read_b64_tr_b16 v[84:85], v11 offset:16384
  v_mfma_f32_16x16x32_bf16 v[168:171], v[96:99], v[56:59], v[168:171]
  ds_read_b64_tr_b16 v[86:87], v11 offset:16896
  v_mfma_f32_16x16x32_bf16 v[184:187], v[60:63], v[96:99], v[184:187]
  ds_read_b128 v[120:123], v14 offset:6144
  v_mfma_f32_16x16x32_bf16 v[200:203], v[64:67], v[96:99], v[200:203]
  ds_read_b128 v[124:127], v15
  v_mfma_f32_16x16x32_bf16 v[140:143], v[48:51], v[100:103], v[140:143]
  v_mfma_f32_16x16x32_bf16 v[156:159], v[52:55], v[100:103], v[156:159]
  v_mfma_f32_16x16x32_bf16 v[172:175], v[100:103], v[56:59], v[172:175]
  v_mfma_f32_16x16x32_bf16 v[188:191], v[60:63], v[100:103], v[188:191]
  v_mfma_f32_16x16x32_bf16 v[204:207], v[64:67], v[100:103], v[204:207]
  v_mfma_f32_16x16x32_bf16 v[208:211], v[52:55], v[104:107], v[208:211]
  s_cmp_ge_u32 s43, 3
  s_cbranch_scc0 L_tch_3021
  s_sub_u32 s61, s43, 3
  s_lshr_b32 s60, s2, 3
  s_mul_i32 s60, s60, 5
  s_add_u32 s60, s60, s61
  s_min_u32 s60, s60, 143
  s_add_u32 s61, s60, 136
  s_add_u32 s62, s60, 208
  s_cmp_lt_u32 s60, 8
  s_cselect_b32 s61, s61, s62
  s_sub_u32 s62, s60, 16
  s_cmp_lt_u32 s60, 16
  s_cselect_b32 s61, s61, s62
  s_sub_u32 s62, s60, 80
  s_cmp_lt_u32 s60, 80
  s_cselect_b32 s61, s61, s62
  s_sub_u32 s62, s60, 16
  s_cmp_lt_u32 s62, 64
  s_cselect_b32 s64, s70, s72
  s_cselect_b32 s65, s71, s73
  s_mov_b32 s60, s61
  s_lshl_b32 s60, s60, 13
  v_lshlrev_b32 v23, 7, v0
  v_add_u32 v23, s60, v23
  global_load_dword v46, v23, s[64:65]
L_tch_3021:
  s_cmp_eq_u32 s43, 3
  s_cbranch_scc0 L_wbn_3023
  s_waitcnt vmcnt(2)
  s_branch L_wbw_3022
L_wbn_3023:
  s_waitcnt vmcnt(1)
L_wbw_3022:
  s_waitcnt vmcnt(63) lgkmcnt(0)
  s_barrier
  v_mfma_f32_16x16x32_bf16 v[128:131], v[68:71], v[108:111], v[128:131]
  v_add_f32_dpp v212, v212, v212 row_ror:8 row_mask:0xf bank_mask:0xf
  v_add_f32_dpp v213, v213, v213 row_ror:8 row_mask:0xf bank_mask:0xf
  v_add_f32_dpp v214, v214, v214 row_ror:8 row_mask:0xf bank_mask:0xf
  v_mfma_f32_16x16x32_bf16 v[144:147], v[72:75], v[108:111], v[144:147]
  v_add_f32_dpp v215, v215, v215 row_ror:8 row_mask:0xf bank_mask:0xf
  v_add_f32_dpp v216, v216, v216 row_ror:8 row_mask:0xf bank_mask:0xf
  v_add_f32_dpp v217, v217, v217 row_ror:8 row_mask:0xf bank_mask:0xf
  v_mfma_f32_16x16x32_bf16 v[160:163], v[108:111], v[76:79], v[160:163]
  v_add_f32_dpp v218, v218, v218 row_ror:8 row_mask:0xf bank_mask:0xf
  v_add_f32_dpp v219, v219, v219 row_ror:8 row_mask:0xf bank_mask:0xf
  v_mfma_f32_16x16x32_bf16 v[176:179], v[80:83], v[108:111], v[176:179]
  v_add_f32_dpp v220, v220, v220 row_ror:8 row_mask:0xf bank_mask:0xf
  v_add_f32_dpp v221, v221, v221 row_ror:8 row_mask:0xf bank_mask:0xf
  v_add_f32_dpp v222, v222, v222 row_ror:8 row_mask:0xf bank_mask:0xf
  v_mfma_f32_16x16x32_bf16 v[192:195], v[84:87], v[108:111], v[192:195]
  v_add_f32_dpp v223, v223, v223 row_ror:8 row_mask:0xf bank_mask:0xf
  v_add_f32_dpp v212, v212, v212 row_ror:4 row_mask:0xf bank_mask:0xf
  v_mfma_f32_16x16x32_bf16 v[132:135], v[68:71], v[112:115], v[132:135]
  v_add_f32_dpp v213, v213, v213 row_ror:4 row_mask:0xf bank_mask:0xf
  v_add_f32_dpp v214, v214, v214 row_ror:4 row_mask:0xf bank_mask:0xf
  v_add_f32_dpp v215, v215, v215 row_ror:4 row_mask:0xf bank_mask:0xf
  v_mfma_f32_16x16x32_bf16 v[148:151], v[72:75], v[112:115], v[148:151]
  v_add_f32_dpp v216, v216, v216 row_ror:4 row_mask:0xf bank_mask:0xf
  v_add_f32_dpp v217, v217, v217 row_ror:4 row_mask:0xf bank_mask:0xf
  v_mfma_f32_16x16x32_bf16 v[164:167], v[112:115], v[76:79], v[164:167]
  v_add_f32_dpp v218, v218, v218 row_ror:4 row_mask:0xf bank_mask:0xf
  v_add_f32_dpp v219, v219, v219 row_ror:4 row_mask:0xf bank_mask:0xf
  v_add_f32_dpp v220, v220, v220 row_ror:4 row_mask:0xf bank_mask:0xf
  v_mfma_f32_16x16x32_bf16 v[180:183], v[80:83], v[112:115], v[180:183]
  v_add_f32_dpp v221, v221, v221 row_ror:4 row_mask:0xf bank_mask:0xf
  v_add_f32_dpp v222, v222, v222 row_ror:4 row_mask:0xf bank_mask:0xf
  v_mfma_f32_16x16x32_bf16 v[196:199], v[84:87], v[112:115], v[196:199]
  v_add_f32_dpp v223, v223, v223 row_ror:4 row_mask:0xf bank_mask:0xf
  v_add_f32_dpp v212, v212, v212 row_ror:2 row_mask:0xf bank_mask:0xf
  v_add_f32_dpp v213, v213, v213 row_ror:2 row_mask:0xf bank_mask:0xf
  v_mfma_f32_16x16x32_bf16 v[136:139], v[68:71], v[116:119], v[136:139]
  v_add_f32_dpp v214, v214, v214 row_ror:2 row_mask:0xf bank_mask:0xf
  v_add_f32_dpp v215, v215, v215 row_ror:2 row_mask:0xf bank_mask:0xf
  v_mfma_f32_16x16x32_bf16 v[152:155], v[72:75], v[116:119], v[152:155]
  v_add_f32_dpp v216, v216, v216 row_ror:2 row_mask:0xf bank_mask:0xf
  v_add_f32_dpp v217, v217, v217 row_ror:2 row_mask:0xf bank_mask:0xf
  v_add_f32_dpp v218, v218, v218 row_ror:2 row_mask:0xf bank_mask:0xf
  v_mfma_f32_16x16x32_bf16 v[168:171], v[116:119], v[76:79], v[168:171]
  v_add_f32_dpp v219, v219, v219 row_ror:2 row_mask:0xf bank_mask:0xf
  v_add_f32_dpp v220, v220, v220 row_ror:2 row_mask:0xf bank_mask:0xf
  v_mfma_f32_16x16x32_bf16 v[184:187], v[80:83], v[116:119], v[184:187]
  v_add_f32_dpp v221, v221, v221 row_ror:2 row_mask:0xf bank_mask:0xf
  v_add_f32_dpp v222, v222, v222 row_ror:2 row_mask:0xf bank_mask:0xf
  v_add_f32_dpp v223, v223, v223 row_ror:2 row_mask:0xf bank_mask:0xf
  v_mfma_f32_16x16x32_bf16 v[200:203], v[84:87], v[116:119], v[200:203]
  v_add_f32_dpp v212, v212, v212 row_ror:1 row_mask:0xf bank_mask:0xf
  v_add_f32_dpp v213, v213, v213 row_ror:1 row_mask:0xf bank_mask:0xf
  v_mfma_f32_16x16x32_bf16 v[140:143], v[68:71], v[120:123], v[140:143]
  v_add_f32_dpp v214, v214, v214 row_ror:1 row_mask:0xf bank_mask:0xf
  v_add_f32_dpp v215, v215, v215 row_ror:1 row_mask:0xf bank_mask:0xf
  v_add_f32_dpp v216, v216, v216 row_ror:1 row_mask:0xf bank_mask:0xf
  v_mfma_f32_16x16x32_bf16 v[156:159], v[72:75], v[120:123], v[156:159]
  v_add_f32_dpp v217, v217, v217 row_ror:1 row_mask:0xf bank_mask:0xf
  v_add_f32_dpp v218, v218, v218 row_ror:1 row_mask:0xf bank_mask:0xf
  v_mfma_f32_16x16x32_bf16 v[172:175], v[120:123], v[76:79], v[172:175]
  v_add_f32_dpp v219, v219, v219 row_ror:1 row_mask:0xf bank_mask:0xf
  v_add_f32_dpp v220, v220, v220 row_ror:1 row_mask:0xf bank_mask:0xf
  v_add_f32_dpp v221, v221, v221 row_ror:1 row_mask:0xf bank_mask:0xf
  v_mfma_f32_16x16x32_bf16 v[188:191], v[80:83], v[120:123], v[188:191]
  v_add_f32_dpp v222, v222, v222 row_ror:1 row_mask:0xf bank_mask:0xf
  v_add_f32_dpp v223, v223, v223 row_ror:1 row_mask:0xf bank_mask:0xf
  v_mfma_f32_16x16x32_bf16 v[204:207], v[84:87], v[120:123], v[204:207]
  v_mfma_f32_16x16x32_bf16 v[208:211], v[72:75], v[124:127], v[208:211]
  ds_write_b128 v36, v[212:215]
  ds_write_b128 v36, v[216:219] offset:512
  ds_write_b128 v37, v[220:223]
  ds_write_b32 v38, v224 offset:0
  ds_write_b32 v38, v225 offset:576
  s_waitcnt lgkmcnt(0)
  s_barrier
  v_and_b32 v20, 15, v0
  v_lshlrev_b32 v10, 2, v20
  v_add_u32 v10, 147456, v10
  v_and_b32 v11, 48, v0
  v_add_u32 v11, 147456, v11
  s_lshl_b32 s60, s44, 6
  v_add_u32 v22, s60, v11
  v_add_u32 v23, s60, v10
  ds_read_b128 v[64:67], v22 offset:1408
  ds_read_b32 v48, v10 offset:64
  ds_read_b32 v52, v10 offset:640
  ds_read_b32 v49, v10 offset:128
  ds_read_b32 v53, v10 offset:704
  ds_read_b32 v50, v10 offset:192
  ds_read_b32 v54, v10 offset:768
  ds_read_b32 v51, v10 offset:256
  ds_read_b32 v55, v10 offset:832
  ds_read_b32 v58, v23 offset:1664
  ds_read_b128 v[88:91], v11 offset:256
  ds_read_b128 v[104:107], v11 offset:832
  ds_read_b32 v56, v10 offset:0
  ds_read_b32 v57, v10 offset:576
  v_mov_b32 v12, 0xbdd2d3e8
  s_mov_b32 s64, 0xc0135761
  s_mov_b32 s28, 0xaaaaaaaa
  s_mov_b32 s29, 0xaaaaaaaa
  s_mov_b32 s30, 0xfff0ffff
  s_mov_b32 s31, 0xf000ff00
  s_mov_b32 s36, 0xffc0fffc
  s_mov_b32 s37, 0xc000fc00
  s_cmp_eq_u32 s40, 0
  s_cselect_b32 s60, -1, 0
  s_andn2_b32 s38, s60, s30
  s_andn2_b32 s39, s60, s31
  s_andn2_b32 s52, s60, s36
  s_andn2_b32 s53, s60, s37
  v_mov_b32 v25, 0xffff
  v_mov_b32 v26, 0xffff0000
  v_cndmask_b32 v25, v25, v26, s[28:29]
  v_cndmask_b32 v232, v25, 0, s[30:31]
  v_cndmask_b32 v233, v25, 0, s[36:37]
  v_cndmask_b32 v234, 0, v25, s[30:31]
  v_cndmask_b32 v235, 0, v25, s[36:37]
  s_mul_i32 s60, s44, 1536
  s_add_u32 s60, s60, 147456
  v_lshlrev_b32 v24, 3, v0
  v_add_u32 v24, s60, v24
  s_add_u32 m0, s68, 0
  s_nop 0
  buffer_load_dwordx4 v41, s[20:23], s66 offen lds
  s_add_u32 s66, s66, 32768
  s_waitcnt lgkmcnt(0)
  ds_read_b128 v[76:79], v11 offset:64
  ds_read_b128 v[92:95], v11 offset:640
  ds_read_b128 v[80:83], v11 offset:128
  ds_read_b128 v[96:99], v11 offset:704
  ds_read_b128 v[84:87], v11 offset:192
  ds_read_b128 v[100:103], v11 offset:768
  ds_read_b128 v[68:71], v22 offset:1920
  ds_read_b128 v[72:75], v22 offset:2176
  ds_read_b128 v[60:63], v22 offset:1152
  v_pk_fma_f32 v[156:157], v[50:51], v[64:65], v[156:157] op_sel:[1,0,0] neg_lo:[1,0,0] neg_hi:[1,0,0]
  v_pk_fma_f32 v[158:159], v[50:51], v[66:67], v[158:159] op_sel:[1,0,0] neg_lo:[1,0,0] neg_hi:[1,0,0]
  v_pk_mul_f32 v[156:157], v[54:55], v[156:157] op_sel:[1,0]
  v_pk_mul_f32 v[158:159], v[54:55], v[158:159] op_sel:[1,0]
  v_cvt_pk_bf16_f32 v124, v156, v157
  v_cvt_pk_bf16_f32 v125, v158, v159
  v_pk_fma_f32 v[172:173], v[88:89], v[58:59], v[172:173] op_sel_hi:[1,0,1] neg_lo:[1,0,0] neg_hi:[1,0,0]
  v_pk_fma_f32 v[174:175], v[90:91], v[58:59], v[174:175] op_sel_hi:[1,0,1] neg_lo:[1,0,0] neg_hi:[1,0,0]
  v_pk_mul_f32 v[172:173], v[104:105], v[172:173]
  v_pk_mul_f32 v[174:175], v[106:107], v[174:175]
  v_cvt_pk_bf16_f32 v220, v172, v173
  v_cvt_pk_bf16_f32 v221, v174, v175
  ds_write_b64 v24, v[124:125] offset:2432
  ds_write_b64 v24, v[220:221] offset:2944
  s_waitcnt lgkmcnt(0)
  s_barrier
  ds_read_b64 v[212:213], v24 offset:3456
  v_pk_fma_f32 v[144:145], v[48:49], v[64:65], v[144:145] op_sel_hi:[0,1,1] neg_lo:[1,0,0] neg_hi:[1,0,0]
  v_pk_fma_f32 v[146:147], v[48:49], v[66:67], v[146:147] op_sel_hi:[0,1,1] neg_lo:[1,0,0] neg_hi:[1,0,0]
  v_pk_fma_f32 v[148:149], v[48:49], v[64:65], v[148:149] op_sel:[1,0,0] neg_lo:[1,0,0] neg_hi:[1,0,0]
  v_pk_fma_f32 v[150:151], v[48:49], v[66:67], v[150:151] op_sel:[1,0,0] neg_lo:[1,0,0] neg_hi:[1,0,0]
  v_pk_fma_f32 v[152:153], v[50:51], v[64:65], v[152:153] op_sel_hi:[0,1,1] neg_lo:[1,0,0] neg_hi:[1,0,0]
  v_pk_fma_f32 v[154:155], v[50:51], v[66:67], v[154:155] op_sel_hi:[0,1,1] neg_lo:[1,0,0] neg_hi:[1,0,0]
  v_pk_fma_f32 v[208:209], v[56:57], v[64:65], v[208:209] op_sel_hi:[0,1,1] neg_lo:[1,0,0] neg_hi:[1,0,0]
  v_pk_fma_f32 v[210:211], v[56:57], v[66:67], v[210:211] op_sel_hi:[0,1,1] neg_lo:[1,0,0] neg_hi:[1,0,0]
  v_pk_mul_f32 v[144:145], v[52:53], v[144:145] op_sel_hi:[0,1]
  v_pk_mul_f32 v[146:147], v[52:53], v[146:147] op_sel_hi:[0,1]
  v_pk_mul_f32 v[148:149], v[52:53], v[148:149] op_sel:[1,0]
  v_pk_mul_f32 v[150:151], v[52:53], v[150:151] op_sel:[1,0]
  v_pk_mul_f32 v[152:153], v[54:55], v[152:153] op_sel_hi:[0,1]
  v_pk_mul_f32 v[154:155], v[54:55], v[154:155] op_sel_hi:[0,1]
  v_pk_mul_f32 v[208:209], v[56:57], v[208:209] op_sel:[1,0]
  v_pk_mul_f32 v[210:211], v[56:57], v[210:211] op_sel:[1,0]
  v_cvt_pk_bf16_f32 v118, v144, v145
  v_cvt_pk_bf16_f32 v119, v146, v147
  v_cvt_pk_bf16_f32 v120, v148, v149
  v_cvt_pk_bf16_f32 v121, v150, v151
  v_cvt_pk_bf16_f32 v122, v152, v153
  v_cvt_pk_bf16_f32 v123, v154, v155
  v_cvt_pk_bf16_f32 v116, v208, v209
  v_cvt_pk_bf16_f32 v117, v210, v211
  s_add_u32 m0, s68, 8192
  s_nop 0
  buffer_load_dwordx4 v41, s[20:23], s66 offen lds
  s_add_u32 s66, s66, 32768
  s_add_u32 m0, s68, 16384
  s_nop 0
  buffer_load_dwordx4 v41, s[20:23], s66 offen lds
  s_add_u32 s66, s66, 32768
  v_mul_f32 v252, 0x3eb8aa3b, v52
  v_mul_f32 v253, 0x3eb8aa3b, v53
  v_mul_f32 v254, 0x3eb8aa3b, v54
  v_mul_f32 v255, 0x3eb8aa3b, v55
  v_pk_fma_f32 v[160:161], v[76:77], v[58:59], v[160:161] op_sel_hi:[1,0,1] neg_lo:[1,0,0] neg_hi:[1,0,0]
  v_pk_fma_f32 v[162:163], v[78:79], v[58:59], v[162:163] op_sel_hi:[1,0,1] neg_lo:[1,0,0] neg_hi:[1,0,0]
  v_pk_mul_f32 v[160:161], v[92:93], v[160:161]
  v_pk_mul_f32 v[162:163], v[94:95], v[162:163]
  v_cvt_pk_bf16_f32 v214, v160, v161
  v_cvt_pk_bf16_f32 v215, v162, v163
  v_pk_fma_f32 v[164:165], v[80:81], v[58:59], v[164:165] op_sel_hi:[1,0,1] neg_lo:[1,0,0] neg_hi:[1,0,0]
  v_pk_fma_f32 v[166:167], v[82:83], v[58:59], v[166:167] op_sel_hi:[1,0,1] neg_lo:[1,0,0] neg_hi:[1,0,0]
  v_pk_mul_f32 v[164:165], v[96:97], v[164:165]
  v_pk_mul_f32 v[166:167], v[98:99], v[166:167]
  v_cvt_pk_bf16_f32 v216, v164, v165
  v_cvt_pk_bf16_f32 v217, v166, v167
  v_pk_fma_f32 v[168:169], v[84:85], v[58:59], v[168:169] op_sel_hi:[1,0,1] neg_lo:[1,0,0] neg_hi:[1,0,0]
  v_pk_fma_f32 v[170:171], v[86:87], v[58:59], v[170:171] op_sel_hi:[1,0,1] neg_lo:[1,0,0] neg_hi:[1,0,0]
  v_pk_mul_f32 v[168:169], v[100:101], v[168:169]
  v_pk_mul_f32 v[170:171], v[102:103], v[170:171]
  v_cvt_pk_bf16_f32 v218, v168, v169
  v_cvt_pk_bf16_f32 v219, v170, v171
  v_pk_fma_f32 v[128:129], v[48:49], v[60:61], v[128:129] op_sel_hi:[0,1,1] neg_lo:[1,0,0] neg_hi:[1,0,0]
  v_pk_fma_f32 v[130:131], v[48:49], v[62:63], v[130:131] op_sel_hi:[0,1,1] neg_lo:[1,0,0] neg_hi:[1,0,0]
  v_pk_fma_f32 v[132:133], v[48:49], v[60:61], v[132:133] op_sel:[1,0,0] neg_lo:[1,0,0] neg_hi:[1,0,0]
  v_pk_fma_f32 v[134:135], v[48:49], v[62:63], v[134:135] op_sel:[1,0,0] neg_lo:[1,0,0] neg_hi:[1,0,0]
  v_pk_fma_f32 v[136:137], v[50:51], v[60:61], v[136:137] op_sel_hi:[0,1,1] neg_lo:[1,0,0] neg_hi:[1,0,0]
  v_pk_fma_f32 v[138:139], v[50:51], v[62:63], v[138:139] op_sel_hi:[0,1,1] neg_lo:[1,0,0] neg_hi:[1,0,0]
  v_pk_fma_f32 v[140:141], v[50:51], v[60:61], v[140:141] op_sel:[1,0,0] neg_lo:[1,0,0] neg_hi:[1,0,0]
  v_pk_fma_f32 v[142:143], v[50:51], v[62:63], v[142:143] op_sel:[1,0,0] neg_lo:[1,0,0] neg_hi:[1,0,0]
  v_pk_mul_f32 v[128:129], v[252:253], v[128:129] op_sel_hi:[0,1]
  v_pk_mul_f32 v[130:131], v[252:253], v[130:131] op_sel_hi:[0,1]
  v_pk_mul_f32 v[132:133], v[252:253], v[132:133] op_sel:[1,0]
  v_pk_mul_f32 v[134:135], v[252:253], v[134:135] op_sel:[1,0]
  v_pk_mul_f32 v[136:137], v[254:255], v[136:137] op_sel_hi:[0,1]
  v_pk_mul_f32 v[138:139], v[254:255], v[138:139] op_sel_hi:[0,1]
  v_pk_mul_f32 v[140:141], v[254:255], v[140:141] op_sel:[1,0]
  v_pk_mul_f32 v[142:143], v[254:255], v[142:143] op_sel:[1,0]
  v_cvt_pk_bf16_f32 v222, v128, v129
  v_cvt_pk_bf16_f32 v223, v130, v131
  v_cvt_pk_bf16_f32 v224, v132, v133
  v_cvt_pk_bf16_f32 v225, v134, v135
  v_cvt_pk_bf16_f32 v226, v136, v137
  v_cvt_pk_bf16_f32 v227, v138, v139
  v_cvt_pk_bf16_f32 v228, v140, v141
  v_cvt_pk_bf16_f32 v229, v142, v143
  s_add_u32 m0, s68, 24576
  s_nop 0
  buffer_load_dwordx4 v41, s[20:23], s66 offen lds
  s_add_u32 s66, s66, 32768
  s_add_u32 m0, s68, 32768
  s_nop 0
  buffer_load_dwordx4 v41, s[20:23], s66 offen lds
  s_add_u32 s66, s66, 32768
  v_bfe_u32 v27, v0, 4, 1
  s_lshl_b32 s60, s40, 3
  s_add_u32 s60, s60, 0
  v_add_u32 v27, s60, v27
  v_mul_u32_u24 v27, 73728, v27
  v_lshrrev_b32 v26, 5, v0
  v_lshl_add_u32 v27, v26, 8, v27
  v_and_b32 v26, 15, v0
  v_lshl_add_u32 v13, v26, 4, v27
  s_lshl_b32 s60, s42, 11
  s_lshl_b32 s61, s44, 9
  s_add_u32 s60, s60, s61
  v_add_u32 v13, s60, v13
  v_add_u32 v14, 16384, v13
  s_waitcnt lgkmcnt(0)
  v_mfma_f32_16x16x16_bf16 v[144:147], v[118:119], v[222:223], 0
  v_mfma_f32_16x16x16_bf16 v[128:131], v[116:117], v[222:223], 0
  v_mfma_f32_16x16x16_bf16 v[148:151], v[120:121], v[224:225], 0
  v_mfma_f32_16x16x16_bf16 v[132:135], v[118:119], v[224:225], 0
  v_mfma_f32_16x16x16_bf16 v[152:155], v[122:123], v[226:227], 0
  v_mfma_f32_16x16x16_bf16 v[136:139], v[120:121], v[226:227], 0
  v_mfma_f32_16x16x16_bf16 v[156:159], v[124:125], v[228:229], 0
  v_mfma_f32_16x16x16_bf16 v[140:143], v[122:123], v[228:229], 0
  v_pk_fma_f32 v[176:177], v[48:49], v[68:69], v[176:177] op_sel_hi:[0,1,1] neg_lo:[1,0,0] neg_hi:[1,0,0]
  v_pk_fma_f32 v[178:179], v[48:49], v[70:71], v[178:179] op_sel_hi:[0,1,1] neg_lo:[1,0,0] neg_hi:[1,0,0]
  v_pk_fma_f32 v[180:181], v[48:49], v[68:69], v[180:181] op_sel:[1,0,0] neg_lo:[1,0,0] neg_hi:[1,0,0]
  v_pk_fma_f32 v[182:183], v[48:49], v[70:71], v[182:183] op_sel:[1,0,0] neg_lo:[1,0,0] neg_hi:[1,0,0]
  v_pk_mul_f32 v[176:177], v[52:53], v[176:177] op_sel_hi:[0,1]
  v_pk_mul_f32 v[178:179], v[52:53], v[178:179] op_sel_hi:[0,1]
  v_pk_mul_f32 v[180:181], v[52:53], v[180:181] op_sel:[1,0]
  v_pk_mul_f32 v[182:183], v[52:53], v[182:183] op_sel:[1,0]
  v_pk_mul_f32 v[28:29], v[176:177], v[176:177]
  v_pk_mul_f32 v[30:31], v[178:179], v[178:179]
  v_pk_mul_f32 v[32:33], v[180:181], v[180:181]
  v_pk_mul_f32 v[34:35], v[182:183], v[182:183]
  v_pk_fma_f32 v[192:193], v[48:49], v[72:73], v[192:193] op_sel_hi:[0,1,1] neg_lo:[1,0,0] neg_hi:[1,0,0]
  v_pk_fma_f32 v[194:195], v[48:49], v[74:75], v[194:195] op_sel_hi:[0,1,1] neg_lo:[1,0,0] neg_hi:[1,0,0]
  v_pk_fma_f32 v[196:197], v[48:49], v[72:73], v[196:197] op_sel:[1,0,0] neg_lo:[1,0,0] neg_hi:[1,0,0]
  v_pk_fma_f32 v[198:199], v[48:49], v[74:75], v[198:199] op_sel:[1,0,0] neg_lo:[1,0,0] neg_hi:[1,0,0]
  v_pk_fma_f32 v[28:29], v[28:29], v[12:13], s[64:65] op_sel_hi:[1,0,0]
  v_pk_fma_f32 v[30:31], v[30:31], v[12:13], s[64:65] op_sel_hi:[1,0,0]
  v_pk_fma_f32 v[32:33], v[32:33], v[12:13], s[64:65] op_sel_hi:[1,0,0]
  v_pk_fma_f32 v[34:35], v[34:35], v[12:13], s[64:65] op_sel_hi:[1,0,0]
  v_pk_mul_f32 v[192:193], v[52:53], v[192:193] op_sel_hi:[0,1]
  v_pk_mul_f32 v[194:195], v[52:53], v[194:195] op_sel_hi:[0,1]
  v_pk_mul_f32 v[196:197], v[52:53], v[196:197] op_sel:[1,0]
  v_pk_mul_f32 v[198:199], v[52:53], v[198:199] op_sel:[1,0]
  v_pk_mul_f32 v[28:29], v[28:29], v[176:177]
  v_pk_mul_f32 v[30:31], v[30:31], v[178:179]
  v_pk_mul_f32 v[32:33], v[32:33], v[180:181]
  v_pk_mul_f32 v[34:35], v[34:35], v[182:183]
  v_exp_f32 v28, v28
  v_exp_f32 v29, v29
  v_exp_f32 v30, v30
  v_exp_f32 v31, v31
  v_exp_f32 v32, v32
  v_exp_f32 v33, v33
  v_exp_f32 v34, v34
  v_exp_f32 v35, v35
  v_pk_mul_f32 v[192:193], v[176:177], v[192:193]
  v_pk_mul_f32 v[194:195], v[178:179], v[194:195]
  v_pk_mul_f32 v[196:197], v[180:181], v[196:197]
  v_pk_mul_f32 v[198:199], v[182:183], v[198:199]
  v_pk_add_f32 v[28:29], v[28:29], 1.0 op_sel_hi:[1,0]
  v_pk_add_f32 v[30:31], v[30:31], 1.0 op_sel_hi:[1,0]
  v_pk_add_f32 v[32:33], v[32:33], 1.0 op_sel_hi:[1,0]
  v_pk_add_f32 v[34:35], v[34:35], 1.0 op_sel_hi:[1,0]
  v_rcp_f32 v28, v28
  v_rcp_f32 v29, v29
  v_rcp_f32 v30, v30
  v_rcp_f32 v31, v31
  v_rcp_f32 v32, v32
  v_rcp_f32 v33, v33
  v_rcp_f32 v34, v34
  v_rcp_f32 v35, v35
  s_nop 0
  v_pk_mul_f32 v[192:193], v[28:29], v[192:193]
  v_pk_mul_f32 v[194:195], v[30:31], v[194:195]
  v_pk_mul_f32 v[196:197], v[32:33], v[196:197]
  v_pk_mul_f32 v[198:199], v[34:35], v[198:199]
  v_cvt_pk_bf16_f32 v244, v192, v193
  v_cvt_pk_bf16_f32 v245, v194, v195
  v_cvt_pk_bf16_f32 v246, v196, v197
  v_cvt_pk_bf16_f32 v247, v198, v199
  s_add_u32 m0, s68, 40960
  s_nop 0
  buffer_load_dwordx4 v41, s[20:23], s66 offen lds
  s_add_u32 s66, s66, 32768
  s_add_u32 m0, s68, 49152
  s_nop 0
  buffer_load_dwordx4 v41, s[20:23], s66 offen lds
  s_add_u32 s66, s66, 32768
  v_mov_b32 v28, 0xf149f2ca
  v_cndmask_b32 v76, v144, v145, s[28:29]
  v_cndmask_b32 v77, v146, v147, s[28:29]
  v_cndmask_b32 v80, v148, v149, s[28:29]
  v_cndmask_b32 v81, v150, v151, s[28:29]
  v_cndmask_b32 v84, v152, v153, s[28:29]
  v_cndmask_b32 v85, v154, v155, s[28:29]
  v_cndmask_b32 v88, v156, v157, s[28:29]
  v_cndmask_b32 v89, v158, v159, s[28:29]
  v_cndmask_b32 v78, v128, v129, s[28:29]
  v_cndmask_b32 v79, v130, v131, s[28:29]
  v_cndmask_b32 v82, v132, v133, s[28:29]
  v_cndmask_b32 v83, v134, v135, s[28:29]
  v_cndmask_b32 v86, v136, v137, s[28:29]
  v_cndmask_b32 v87, v138, v139, s[28:29]
  v_cndmask_b32 v90, v140, v141, s[28:29]
  v_cndmask_b32 v91, v142, v143, s[28:29]
  v_cndmask_b32 v76, v78, v76, s[30:31]
  v_cndmask_b32 v77, v79, v77, s[36:37]
  v_cndmask_b32 v80, v82, v80, s[30:31]
  v_cndmask_b32 v81, v83, v81, s[36:37]
  v_cndmask_b32 v84, v86, v84, s[30:31]
  v_cndmask_b32 v85, v87, v85, s[36:37]
  v_cndmask_b32 v88, v90, v88, s[30:31]
  v_cndmask_b32 v89, v91, v89, s[36:37]
  v_cndmask_b32 v76, v76, v28, s[38:39]
  v_cndmask_b32 v77, v77, v28, s[52:53]
  v_max_f32 v20, v76, v77
  v_max_f32 v21, v80, v81
  v_max_f32 v22, v84, v85
  v_max_f32 v23, v88, v89
  v_mov_b32 v24, v20
  v_mov_b32 v25, v21
  v_mov_b32 v26, v22
  v_mov_b32 v27, v23
  v_permlane16_swap_b32 v20, v24
  v_permlane16_swap_b32 v21, v25
  v_permlane16_swap_b32 v22, v26
  v_permlane16_swap_b32 v23, v27
  v_max_f32 v20, v20, v24
  v_max_f32 v21, v21, v25
  v_max_f32 v22, v22, v26
  v_max_f32 v23, v23, v27
  v_mov_b32 v24, v20
  v_mov_b32 v25, v21
  v_mov_b32 v26, v22
  v_mov_b32 v27, v23
  v_permlane32_swap_b32 v20, v24
  v_permlane32_swap_b32 v21, v25
  v_permlane32_swap_b32 v22, v26
  v_permlane32_swap_b32 v23, v27
  v_max_f32 v20, v20, v24
  v_max_f32 v21, v21, v25
  v_max_f32 v22, v22, v26
  v_max_f32 v23, v23, v27
  v_sub_f32 v76, v76, v20
  v_sub_f32 v77, v77, v20
  v_sub_f32 v80, v80, v21
  v_sub_f32 v81, v81, v21
  v_sub_f32 v84, v84, v22
  v_sub_f32 v85, v85, v22
  v_sub_f32 v88, v88, v23
  v_sub_f32 v89, v89, v23
  v_exp_f32 v76, v76
  v_exp_f32 v77, v77
  v_exp_f32 v80, v80
  v_exp_f32 v81, v81
  v_exp_f32 v84, v84
  v_exp_f32 v85, v85
  v_exp_f32 v88, v88
  v_exp_f32 v89, v89
  s_add_u32 m0, s68, 57344
  s_nop 0
  buffer_load_dwordx4 v41, s[20:23], s66 offen lds
  s_add_u32 s66, s66, 32768
  s_add_u32 m0, s68, 65536
  s_nop 0
  buffer_load_dwordx4 v41, s[20:23], s66 offen lds
  s_add_u32 s66, s66, 32768
  v_cvt_pk_bf16_f32 v78, v76, v76
  v_cvt_pk_bf16_f32 v79, v77, v77
  v_cvt_pk_bf16_f32 v82, v80, v80
  v_cvt_pk_bf16_f32 v83, v81, v81
  v_cvt_pk_bf16_f32 v86, v84, v84
  v_cvt_pk_bf16_f32 v87, v85, v85
  v_cvt_pk_bf16_f32 v90, v88, v88
  v_cvt_pk_bf16_f32 v91, v89, v89
  v_and_b32 v160, v78, v232
  v_and_b32 v161, v79, v233
  v_and_b32 v162, v78, v234
  v_and_b32 v163, v79, v235
  v_and_b32 v164, v82, v232
  v_and_b32 v165, v83, v233
  v_and_b32 v166, v82, v234
  v_and_b32 v167, v83, v235
  v_and_b32 v168, v86, v232
  v_and_b32 v169, v87, v233
  v_and_b32 v170, v86, v234
  v_and_b32 v171, v87, v235
  v_and_b32 v172, v90, v232
  v_and_b32 v173, v91, v233
  v_and_b32 v174, v90, v234
  v_and_b32 v175, v91, v235
  s_nop 1
  v_mfma_f32_16x16x32_bf16 v[144:147], v[16:19], v[160:163], 0
  v_mfma_f32_16x16x32_bf16 v[148:151], v[16:19], v[164:167], 0
  v_mfma_f32_16x16x32_bf16 v[152:155], v[16:19], v[168:171], 0
  v_mfma_f32_16x16x32_bf16 v[156:159], v[16:19], v[172:175], 0
  v_mfma_f32_16x16x32_bf16 v[128:131], v[212:215], v[160:163], 0
  v_mfma_f32_16x16x32_bf16 v[132:135], v[214:217], v[164:167], 0
  v_mfma_f32_16x16x32_bf16 v[136:139], v[216:219], v[168:171], 0
  v_mfma_f32_16x16x32_bf16 v[140:143], v[218:221], v[172:175], 0
  v_pk_fma_f32 v[184:185], v[50:51], v[68:69], v[184:185] op_sel_hi:[0,1,1] neg_lo:[1,0,0] neg_hi:[1,0,0]
  v_pk_fma_f32 v[186:187], v[50:51], v[70:71], v[186:187] op_sel_hi:[0,1,1] neg_lo:[1,0,0] neg_hi:[1,0,0]
  v_pk_fma_f32 v[188:189], v[50:51], v[68:69], v[188:189] op_sel:[1,0,0] neg_lo:[1,0,0] neg_hi:[1,0,0]
  v_pk_fma_f32 v[190:191], v[50:51], v[70:71], v[190:191] op_sel:[1,0,0] neg_lo:[1,0,0] neg_hi:[1,0,0]
  v_pk_mul_f32 v[184:185], v[54:55], v[184:185] op_sel_hi:[0,1]
  v_pk_mul_f32 v[186:187], v[54:55], v[186:187] op_sel_hi:[0,1]
  v_pk_mul_f32 v[188:189], v[54:55], v[188:189] op_sel:[1,0]
  v_pk_mul_f32 v[190:191], v[54:55], v[190:191] op_sel:[1,0]
  v_pk_mul_f32 v[28:29], v[184:185], v[184:185]
  v_pk_mul_f32 v[30:31], v[186:187], v[186:187]
  v_pk_mul_f32 v[32:33], v[188:189], v[188:189]
  v_pk_mul_f32 v[34:35], v[190:191], v[190:191]
  v_pk_fma_f32 v[200:201], v[50:51], v[72:73], v[200:201] op_sel_hi:[0,1,1] neg_lo:[1,0,0] neg_hi:[1,0,0]
  v_pk_fma_f32 v[202:203], v[50:51], v[74:75], v[202:203] op_sel_hi:[0,1,1] neg_lo:[1,0,0] neg_hi:[1,0,0]
  v_pk_fma_f32 v[204:205], v[50:51], v[72:73], v[204:205] op_sel:[1,0,0] neg_lo:[1,0,0] neg_hi:[1,0,0]
  v_pk_fma_f32 v[206:207], v[50:51], v[74:75], v[206:207] op_sel:[1,0,0] neg_lo:[1,0,0] neg_hi:[1,0,0]
  v_pk_fma_f32 v[28:29], v[28:29], v[12:13], s[64:65] op_sel_hi:[1,0,0]
  v_pk_fma_f32 v[30:31], v[30:31], v[12:13], s[64:65] op_sel_hi:[1,0,0]
  v_pk_fma_f32 v[32:33], v[32:33], v[12:13], s[64:65] op_sel_hi:[1,0,0]
  v_pk_fma_f32 v[34:35], v[34:35], v[12:13], s[64:65] op_sel_hi:[1,0,0]
  v_pk_mul_f32 v[200:201], v[54:55], v[200:201] op_sel_hi:[0,1]
  v_pk_mul_f32 v[202:203], v[54:55], v[202:203] op_sel_hi:[0,1]
  v_pk_mul_f32 v[204:205], v[54:55], v[204:205] op_sel:[1,0]
  v_pk_mul_f32 v[206:207], v[54:55], v[206:207] op_sel:[1,0]
  v_pk_mul_f32 v[28:29], v[28:29], v[184:185]
  v_pk_mul_f32 v[30:31], v[30:31], v[186:187]
  v_pk_mul_f32 v[32:33], v[32:33], v[188:189]
  v_pk_mul_f32 v[34:35], v[34:35], v[190:191]
  v_exp_f32 v28, v28
  v_exp_f32 v29, v29
  v_exp_f32 v30, v30
  v_exp_f32 v31, v31
  v_exp_f32 v32, v32
  v_exp_f32 v33, v33
  v_exp_f32 v34, v34
  v_exp_f32 v35, v35
  v_pk_mul_f32 v[200:201], v[184:185], v[200:201]
  v_pk_mul_f32 v[202:203], v[186:187], v[202:203]
  v_pk_mul_f32 v[204:205], v[188:189], v[204:205]
  v_pk_mul_f32 v[206:207], v[190:191], v[206:207]
  v_pk_add_f32 v[28:29], v[28:29], 1.0 op_sel_hi:[1,0]
  v_pk_add_f32 v[30:31], v[30:31], 1.0 op_sel_hi:[1,0]
  v_pk_add_f32 v[32:33], v[32:33], 1.0 op_sel_hi:[1,0]
  v_pk_add_f32 v[34:35], v[34:35], 1.0 op_sel_hi:[1,0]
  v_rcp_f32 v28, v28
  v_rcp_f32 v29, v29
  v_rcp_f32 v30, v30
  v_rcp_f32 v31, v31
  v_rcp_f32 v32, v32
  v_rcp_f32 v33, v33
  v_rcp_f32 v34, v34
  v_rcp_f32 v35, v35
  s_nop 0
  v_pk_mul_f32 v[200:201], v[28:29], v[200:201]
  v_pk_mul_f32 v[202:203], v[30:31], v[202:203]
  v_pk_mul_f32 v[204:205], v[32:33], v[204:205]
  v_pk_mul_f32 v[206:207], v[34:35], v[206:207]
  v_cvt_pk_bf16_f32 v248, v200, v201
  v_cvt_pk_bf16_f32 v249, v202, v203
  v_cvt_pk_bf16_f32 v250, v204, v205
  v_cvt_pk_bf16_f32 v251, v206, v207
  s_nop 1
  v_permlane16_swap_b32 v244, v246
  v_permlane16_swap_b32 v245, v247
  v_permlane16_swap_b32 v248, v250
  v_permlane16_swap_b32 v249, v251
  s_mov_b32 s63, 147456
  buffer_store_dwordx4 v[244:247], v14, s[32:35], 0 offen sc1
  buffer_store_dwordx4 v[248:251], v14, s[32:35], s63 offen sc1
  v_rcp_f32 v20, v144
  v_rcp_f32 v21, v148
  v_rcp_f32 v22, v152
  v_rcp_f32 v23, v156
  s_nop 1
  v_mul_f32 v128, v20, v128
  v_mul_f32 v129, v20, v129
  v_mul_f32 v130, v20, v130
  v_mul_f32 v131, v20, v131
  v_mul_f32 v132, v21, v132
  v_mul_f32 v133, v21, v133
  v_mul_f32 v134, v21, v134
  v_mul_f32 v135, v21, v135
  v_mul_f32 v136, v22, v136
  v_mul_f32 v137, v22, v137
  v_mul_f32 v138, v22, v138
  v_mul_f32 v139, v22, v139
  v_mul_f32 v140, v23, v140
  v_mul_f32 v141, v23, v141
  v_mul_f32 v142, v23, v142
  v_mul_f32 v143, v23, v143
  v_cvt_pk_bf16_f32 v116, v128, v129
  v_cvt_pk_bf16_f32 v117, v130, v131
  v_cvt_pk_bf16_f32 v118, v132, v133
  v_cvt_pk_bf16_f32 v119, v134, v135
  v_cvt_pk_bf16_f32 v120, v136, v137
  v_cvt_pk_bf16_f32 v121, v138, v139
  v_cvt_pk_bf16_f32 v122, v140, v141
  v_cvt_pk_bf16_f32 v123, v142, v143
  s_nop 1
  v_permlane16_swap_b32 v116, v118
  v_permlane16_swap_b32 v117, v119
  v_permlane16_swap_b32 v120, v122
  v_permlane16_swap_b32 v121, v123
  s_mov_b32 s63, 147456
  buffer_store_dwordx4 v[116:119], v13, s[32:35], 0 offen sc1
  buffer_store_dwordx4 v[120:123], v13, s[32:35], s63 offen sc1
  s_add_u32 m0, s68, 73728
  s_nop 0
  buffer_load_dwordx4 v41, s[20:23], s66 offen lds
  s_add_u32 s66, s66, 32768
  s_add_u32 m0, s68, 81920
  s_nop 0
  buffer_load_dwordx4 v41, s[20:23], s66 offen lds
  s_add_u32 s66, s66, 32768
  s_add_u32 m0, s68, 90112
  s_nop 0
  buffer_load_dwordx4 v41, s[20:23], s66 offen lds
  s_add_u32 s66, s66, 32768
  s_add_u32 m0, s68, 98304
  s_nop 0
  buffer_load_dwordx4 v41, s[20:23], s66 offen lds
  s_add_u32 s66, s66, 32768
  s_add_u32 m0, s68, 106496
  s_nop 0
  buffer_load_dwordx4 v41, s[20:23], s66 offen lds
  s_add_u32 s66, s66, 32768
  s_add_u32 m0, s68, 114688
  s_nop 0
  buffer_load_dwordx4 v41, s[20:23], s66 offen lds
  s_add_u32 s66, s66, 32768
  s_add_u32 m0, s68, 122880
  s_nop 0
  buffer_load_dwordx4 v41, s[20:23], s66 offen lds
  s_add_u32 s66, s66, 32768
  s_add_u32 m0, s68, 131072
  s_nop 0
  buffer_load_dwordx4 v41, s[20:23], s66 offen lds
  s_add_u32 s66, s66, 32768
  s_add_u32 m0, s68, 139264
  s_nop 0
  buffer_load_dwordx4 v41, s[20:23], s66 offen lds
  s_add_u32 s66, s66, 32768
  s_branch P1_done
L_ev_7:
  s_cmp_eq_u32 s56, 0
  s_cbranch_scc0 L_evo_1009
  v_mfma_f32_16x16x32_bf16 v[226:229], v[48:51], v[16:19], 0
  v_mfma_f32_16x16x32_bf16 v[230:233], v[52:55], v[16:19], 0
  v_mfma_f32_16x16x32_bf16 v[234:237], v[56:59], v[16:19], 0
  v_mfma_f32_16x16x32_bf16 v[238:241], v[60:63], v[16:19], 0
  v_mfma_f32_16x16x32_bf16 v[242:245], v[64:67], v[16:19], 0
  s_nop 7
  s_nop 1
  buffer_store_dwordx4 v[226:229], v42, s[32:35], 0 offen offset:0 sc1
  buffer_store_dwordx4 v[230:233], v42, s[32:35], 0 offen offset:256 sc1
  buffer_store_dwordx4 v[234:237], v42, s[32:35], 0 offen offset:512 sc1
  buffer_store_dwordx4 v[238:241], v42, s[32:35], 0 offen offset:768 sc1
  buffer_store_dwordx4 v[242:245], v42, s[32:35], 0 offen offset:1024 sc1
  s_branch L_evback_8
L_evo_1009:
  s_cmp_eq_u32 s56, 1
  s_cbranch_scc0 L_evp_1010
  v_add_u32 v40, 1, v40
  s_lshl_b32 s60, s40, 7
  s_lshl_b32 s61, s41, 2
  s_add_u32 s60, s60, s61
  s_add_u32 s60, s60, 9830400
  s_lshl_b32 s61, s41, 7
  s_lshl_b32 s62, s40, 2
  s_add_u32 s61, s61, s62
  s_add_u32 s61, s61, 9832448
  v_mov_b32 v20, 0x7fffff00
  v_writelane_b32 v20, s60, 0
  v_writelane_b32 v20, s61, 1
  s_nop 1
  buffer_store_dword v40, v20, s[32:35], 0 offen sc1
  s_branch L_evback_8
L_evp_1010:
  v_and_b32 v20, 15, v0
  s_lshl_b32 s60, s40, 7
  s_add_u32 s60, s60, 9830400
  v_lshl_add_u32 v43, v20, 2, s60
  s_lshl_b32 s61, s41, 7
  s_add_u32 s61, s61, 9832448
  v_lshl_add_u32 v21, v20, 2, s61
  v_lshrrev_b32 v22, 4, v0
  v_cmp_eq_u32 vcc, 2, v22
  s_nop 1
  v_cndmask_b32 v43, v43, v21, vcc
  s_cmp_eq_u32 s40, 0
  s_cselect_b32 s61, 0, 128
  s_sub_u32 s60, s60, s61
  s_add_u32 s60, s60, 56
  s_add_u32 s61, s60, 4
  v_writelane_b32 v43, s60, 16
  v_writelane_b32 v43, s61, 17
  s_nop 1
  buffer_load_dword v44, v43, s[32:35], 0 offen sc1
  s_branch L_evback_8

L_ev_1012:
  v_mfma_f32_16x16x32_bf16 v[226:229], v[68:71], v[16:19], 0
  v_mfma_f32_16x16x32_bf16 v[230:233], v[72:75], v[16:19], 0
  v_mfma_f32_16x16x32_bf16 v[234:237], v[76:79], v[16:19], 0
  v_mfma_f32_16x16x32_bf16 v[238:241], v[80:83], v[16:19], 0
  v_mfma_f32_16x16x32_bf16 v[242:245], v[84:87], v[16:19], 0
  s_nop 7
  s_nop 1
  buffer_store_dwordx4 v[226:229], v42, s[32:35], 0 offen offset:0 sc1
  buffer_store_dwordx4 v[230:233], v42, s[32:35], 0 offen offset:256 sc1
  buffer_store_dwordx4 v[234:237], v42, s[32:35], 0 offen offset:512 sc1
  buffer_store_dwordx4 v[238:241], v42, s[32:35], 0 offen offset:768 sc1
  buffer_store_dwordx4 v[242:245], v42, s[32:35], 0 offen offset:1024 sc1
  s_branch L_evback_1013

L_chk_2015:
  v_cmp_ne_u32 vcc, v40, v44
  s_nop 1
  s_cmp_lg_u64 vcc, 0
  s_cbranch_scc1 L_early_slow_3017
L_early_ok_3018:
  s_branch L_chkback_2016

L_early_slow_3017:
  s_mov_b32 s3, 0
L_early_slow_3017_loop:
  buffer_load_dword v44, v43, s[32:35], 0 offen sc1
  s_add_u32 s3, s3, 1
  s_waitcnt vmcnt(0)
  v_cmp_ne_u32 vcc, v40, v44
  s_nop 1
  s_cmp_lg_u64 vcc, 0
  s_cbranch_scc0 L_early_ok_3018
  s_cmp_lt_u32 s3, 262144
  s_cbranch_scc1 L_early_slow_3017_loop
  s_branch L_early_ok_3018

P1_X1:
  v_lshrrev_b32 v20, 3, v0
  s_lshl_b32 s60, s44, 3
  v_add_u32 v20, s60, v20
  v_mul_u32_u24 v20, 3584, v20
  v_bfe_u32 v21, v0, 4, 1
  s_and_b32 s60, s44, 1
  s_lshl_b32 s60, s60, 1
  v_or_b32 v21, s60, v21
  v_bfe_u32 v22, v0, 1, 2
  v_xor_b32 v21, v21, v22
  v_lshl_add_u32 v20, v21, 5, v20
  v_and_b32 v22, 1, v0
  v_lshl_add_u32 v1, v22, 4, v20
  s_lshl_b32 s49, s42, 7
  v_add_u32 v1, s49, v1
  s_mul_i32 s47, s47, 114688
  s_mov_b32 s24, s8
  s_and_b32 s25, s9, 0xffff
  s_mov_b32 s26, 0x1c0000
  s_mov_b32 s27, 0x20000
  s_mov_b32 s28, s10
  s_and_b32 s29, s11, 0xffff
  s_mov_b32 s30, 0x1c0000
  s_mov_b32 s31, 0x20000
  s_add_u32 m0, s58, 12288
  s_nop 0
  buffer_load_dwordx4 v1, s[24:27], s47 offen lds
  s_add_u32 m0, s58, 16384
  s_nop 0
  buffer_load_dwordx4 v1, s[28:31], s47 offen lds
  s_add_u32 s47, s47, 114688
  s_cmp_eq_u32 s47, 1835008
  s_cselect_b32 s47, 0, s47
  s_add_u32 m0, s58, 32768
  s_nop 0
  buffer_load_dwordx4 v1, s[24:27], s47 offen lds
  s_add_u32 m0, s58, 36864
  s_nop 0
  buffer_load_dwordx4 v1, s[28:31], s47 offen lds
  s_add_u32 s47, s47, 114688
  s_cmp_eq_u32 s47, 1835008
  s_cselect_b32 s47, 0, s47
  s_mov_b32 s32, s12
  s_and_b32 s33, s13, 0xffff
  s_mov_b32 s34, 0x970000
  s_mov_b32 s35, 0x20000
  s_load_dwordx2 s[70:71], s[0:1], 16
  s_load_dwordx2 s[72:73], s[0:1], 48
  s_load_dwordx2 s[14:15], s[0:1], 56
  s_and_b32 s60, s2, 7
  s_lshr_b32 s61, s2, 3
  s_lshr_b32 s63, s61, 3
  s_lshl_b32 s69, s60, 2
  s_add_u32 s69, s69, s63
  s_and_b32 s74, s61, 7
  s_mov_b32 s54, 0
  s_mov_b32 s56, 0
  s_lshr_b32 s60, s40, 3
  s_lshl_b32 s60, 1, s60
  s_cmp_eq_u32 s45, 0
  s_cselect_b32 s57, s60, 0
  s_mov_b32 s59, 99
  s_cmp_eq_u32 s43, 0
  s_cselect_b32 s60, 0x110, 0
  s_cselect_b32 s59, 2, 99
  s_or_b32 s57, s57, s60
  v_mov_b32 v43, 9830400
  v_mov_b32 v47, 9830400
  v_mov_b32 v40, 0
  v_lshrrev_b32 v20, 3, v0
  v_lshrrev_b32 v21, 1, v20
  v_and_b32 v22, 7, v0
  v_xor_b32 v21, v21, v22
  s_lshl_b32 s60, s40, 7
  s_sub_u32 s60, s60, 16
  v_add_u32 v20, s60, v20
  v_max_i32 v20, 0, v20
  v_lshlrev_b32 v20, 10, v20
  v_lshl_add_u32 v33, v21, 4, v20
  v_lshrrev_b32 v20, 3, v0
  v_add_u32 v20, 8, v20
  v_lshrrev_b32 v21, 1, v20
  v_and_b32 v22, 7, v0
  v_xor_b32 v21, v21, v22
  s_lshl_b32 s60, s40, 7
  s_sub_u32 s60, s60, 16
  v_add_u32 v20, s60, v20
  v_max_i32 v20, 0, v20
  v_lshlrev_b32 v20, 10, v20
  v_lshl_add_u32 v34, v21, 4, v20
  v_lshrrev_b32 v20, 3, v0
  v_lshrrev_b32 v21, 4, v0
  v_and_b32 v25, 15, v0
  v_lshrrev_b32 v26, 1, v25
  v_xor_b32 v26, v26, v21
  v_lshlrev_b32 v26, 4, v26
  v_lshl_add_u32 v26, v25, 7, v26
  v_add_u32 v8, 131072, v26
  v_xor_b32 v9, 64, v8
  v_add_u32 v6, 90112, v26
  v_xor_b32 v7, 64, v6
  v_bfe_u32 v27, v0, 2, 2
  v_lshl_add_u32 v27, v21, 3, v27
  v_and_b32 v28, 3, v20
  v_xor_b32 v28, s44, v28
  v_lshlrev_b32 v28, 5, v28
  v_lshl_add_u32 v28, v27, 7, v28
  v_and_b32 v29, 3, v0
  v_lshl_add_u32 v10, v29, 3, v28
  v_add_u32 v11, 61440, v10
  v_mov_b32 v16, 0x3f803f80
  v_mov_b32 v17, 0x3f803f80
  v_mov_b32 v18, 0x3f803f80
  v_mov_b32 v19, 0x3f803f80
  v_mov_b32 v128, 0
  v_mov_b32 v129, 0
  v_mov_b32 v130, 0
  v_mov_b32 v131, 0
  v_mov_b32 v132, 0
  v_mov_b32 v133, 0
  v_mov_b32 v134, 0
  v_mov_b32 v135, 0
  v_mov_b32 v136, 0
  v_mov_b32 v137, 0
  v_mov_b32 v138, 0
  v_mov_b32 v139, 0
  v_mov_b32 v140, 0
  v_mov_b32 v141, 0
  v_mov_b32 v142, 0
  v_mov_b32 v143, 0
  v_mov_b32 v144, 0
  v_mov_b32 v145, 0
  v_mov_b32 v146, 0
  v_mov_b32 v147, 0
  v_mov_b32 v148, 0
  v_mov_b32 v149, 0
  v_mov_b32 v150, 0
  v_mov_b32 v151, 0
  v_mov_b32 v152, 0
  v_mov_b32 v153, 0
  v_mov_b32 v154, 0
  v_mov_b32 v155, 0
  v_mov_b32 v156, 0
  v_mov_b32 v157, 0
  v_mov_b32 v158, 0
  v_mov_b32 v159, 0
  v_mov_b32 v160, 0
  v_mov_b32 v161, 0
  v_mov_b32 v162, 0
  v_mov_b32 v163, 0
  v_mov_b32 v164, 0
  v_mov_b32 v165, 0
  v_mov_b32 v166, 0
  v_mov_b32 v167, 0
  v_mov_b32 v168, 0
  v_mov_b32 v169, 0
  v_mov_b32 v170, 0
  v_mov_b32 v171, 0
  v_mov_b32 v172, 0
  v_mov_b32 v173, 0
  v_mov_b32 v174, 0
  v_mov_b32 v175, 0
  v_mov_b32 v176, 0
  v_mov_b32 v177, 0
  v_mov_b32 v178, 0
  v_mov_b32 v179, 0
  v_mov_b32 v180, 0
  v_mov_b32 v181, 0
  v_mov_b32 v182, 0
  v_mov_b32 v183, 0
  v_mov_b32 v184, 0
  v_mov_b32 v185, 0
  v_mov_b32 v186, 0
  v_mov_b32 v187, 0
  v_mov_b32 v188, 0
  v_mov_b32 v189, 0
  v_mov_b32 v190, 0
  v_mov_b32 v191, 0
  v_mov_b32 v192, 0
  v_mov_b32 v193, 0
  v_mov_b32 v194, 0
  v_mov_b32 v195, 0
  v_mov_b32 v196, 0
  v_mov_b32 v197, 0
  v_mov_b32 v198, 0
  v_mov_b32 v199, 0
  v_mov_b32 v200, 0
  v_mov_b32 v201, 0
  v_mov_b32 v202, 0
  v_mov_b32 v203, 0
  v_mov_b32 v204, 0
  v_mov_b32 v205, 0
  v_mov_b32 v206, 0
  v_mov_b32 v207, 0
  v_mov_b32 v208, 0
  v_mov_b32 v209, 0
  v_mov_b32 v210, 0
  v_mov_b32 v211, 0
  v_lshlrev_b32 v24, 4, v0
  v_add_u32 v24, 149888, v24
  v_and_b32 v25, 48, v0
  s_lshl_b32 s60, s43, 6
  s_add_u32 s60, s60, 148608
  v_add_u32 v25, s60, v25
  v_and_b32 v26, 15, v0
  v_cmp_eq_u32 vcc, 0, v26
  s_lshl_b32 s61, s43, 6
  v_add_u32 v27, s61, v0
  v_cndmask_b32 v36, v24, v25, vcc
  s_cmp_lt_u32 s43, 4
  s_cselect_b64 s[64:65], vcc, 0
  v_add_u32 v25, 1024, v25
  v_cndmask_b32 v37, v24, v25, s[64:65]
  v_cmp_gt_u32 vcc, 144, v27
  v_lshlrev_b32 v27, 2, v27
  v_add_u32 v27, 147456, v27
  s_nop 0
  v_cndmask_b32 v38, v24, v27, vcc
  s_lshl_b32 s68, s45, 12
  s_lshl_b32 s60, s44, 10
  s_add_u32 s68, s68, s60
  v_lshrrev_b32 v24, 3, v0
  s_lshl_b32 s60, s44, 3
  v_add_u32 v24, s60, v24
  v_lshlrev_b32 v24, 10, v24
  v_bfe_u32 v25, v0, 4, 1
  s_and_b32 s60, s44, 1
  s_lshl_b32 s60, s60, 1
  v_or_b32 v25, s60, v25
  v_bfe_u32 v26, v0, 1, 2
  v_xor_b32 v25, v25, v26
  v_lshl_add_u32 v24, v25, 5, v24
  v_and_b32 v26, 1, v0
  v_lshl_add_u32 v24, v26, 4, v24
  s_lshl_b32 s60, s74, 7
  v_add_u32 v41, s60, v24
  s_add_u32 m0, s53, 0
  s_nop 0
  buffer_load_dwordx4 v4, s[16:19], s52 offen lds
  s_add_u32 m0, s53, 8192
  s_nop 0
  buffer_load_dwordx4 v5, s[16:19], s52 offen lds
  s_add_u32 s60, s52, 128
  s_and_b32 s60, s60, 0x380
  s_or_b32 s52, s60, s46
  s_add_u32 s53, s53, 0x4000
  s_cmp_eq_u32 s53, s75
  s_cselect_b32 s53, s48, s53
  s_waitcnt vmcnt(8)
  v_lshlrev_b32 v20, 16, v212
  v_and_b32 v21, 0xffff0000, v212
  v_lshlrev_b32 v22, 16, v213
  v_and_b32 v23, 0xffff0000, v213
  v_lshlrev_b32 v24, 16, v214
  v_and_b32 v25, 0xffff0000, v214
  v_lshlrev_b32 v26, 16, v215
  v_and_b32 v27, 0xffff0000, v215
  v_add_f32 v28, v20, v21
  v_add_f32 v29, v22, v23
  v_add_f32 v30, v24, v25
  v_add_f32 v31, v26, v27
  v_add_f32 v28, v28, v29
  v_add_f32 v30, v30, v31
  v_add_f32 v28, v28, v30
  s_nop 1
  v_add_f32_dpp v28, v28, v28 row_ror:8 row_mask:0xf bank_mask:0xf
  s_nop 1
  v_add_f32_dpp v28, v28, v28 row_ror:4 row_mask:0xf bank_mask:0xf
  s_nop 1
  v_add_f32_dpp v28, v28, v28 row_ror:2 row_mask:0xf bank_mask:0xf
  s_nop 1
  v_add_f32_dpp v28, v28, v28 row_ror:1 row_mask:0xf bank_mask:0xf
  s_nop 1
  v_mov_b32 v29, v28
  s_nop 1
  v_permlane16_swap_b32 v28, v29
  s_nop 1
  v_add_f32 v28, v28, v29
  s_nop 0
  v_mov_b32 v29, v28
  s_nop 1
  v_permlane32_swap_b32 v28, v29
  s_nop 1
  v_add_f32 v28, v28, v29
  s_nop 0
  v_mul_f32 v28, 0x3b000000, v28
  v_sub_f32 v20, v20, v28
  v_sub_f32 v21, v21, v28
  v_sub_f32 v22, v22, v28
  v_sub_f32 v23, v23, v28
  v_sub_f32 v24, v24, v28
  v_sub_f32 v25, v25, v28
  v_sub_f32 v26, v26, v28
  v_sub_f32 v27, v27, v28
  v_mul_f32 v29, v20, v20
  v_mul_f32 v30, v21, v21
  v_fmac_f32 v29, v22, v22
  v_fmac_f32 v30, v23, v23
  v_fmac_f32 v29, v24, v24
  v_fmac_f32 v30, v25, v25
  v_fmac_f32 v29, v26, v26
  v_fmac_f32 v30, v27, v27
  v_add_f32 v29, v29, v30
  s_nop 1
  v_add_f32_dpp v29, v29, v29 row_ror:8 row_mask:0xf bank_mask:0xf
  s_nop 1
  v_add_f32_dpp v29, v29, v29 row_ror:4 row_mask:0xf bank_mask:0xf
  s_nop 1
  v_add_f32_dpp v29, v29, v29 row_ror:2 row_mask:0xf bank_mask:0xf
  s_nop 1
  v_add_f32_dpp v29, v29, v29 row_ror:1 row_mask:0xf bank_mask:0xf
  s_nop 1
  v_mov_b32 v30, v29
  s_nop 1
  v_permlane16_swap_b32 v29, v30
  s_nop 1
  v_add_f32 v29, v29, v30
  s_nop 0
  v_mov_b32 v30, v29
  s_nop 1
  v_permlane32_swap_b32 v29, v30
  s_nop 1
  v_add_f32 v29, v29, v30
  s_nop 0
  v_mov_b32 v30, 0x3727c5ac
  v_fmac_f32 v30, 0x3b000000, v29
  v_rsq_f32 v29, v30
  s_lshl_b32 s60, s41, 3
  s_add_u32 s60, s60, s43
  s_lshl_b32 s61, s40, 7
  s_add_u32 s60, s60, s61
  s_lshl_b32 s60, s60, 3
  s_add_u32 s60, s60, 9437184
  v_mov_b32 v30, 0x7fffff00
  v_writelane_b32 v30, s60, 0
  s_nop 1
  buffer_store_dwordx2 v[28:29], v30, s[32:35], 0 offen sc1
  s_waitcnt vmcnt(3)
  s_barrier
  v_add_u32 v14, s54, v6
  v_add_u32 v15, s55, v8
  ds_read_b64_tr_b16 v[48:49], v10 offset:0
  ds_read_b64_tr_b16 v[50:51], v10 offset:512
  ds_read_b64_tr_b16 v[52:53], v10 offset:4096
  ds_read_b64_tr_b16 v[54:55], v10 offset:4608
  ds_read_b128 v[88:91], v14 offset:0
  ds_read_b64_tr_b16 v[56:57], v10 offset:8192
  ds_read_b64_tr_b16 v[58:59], v10 offset:8704
  ds_read_b128 v[92:95], v14 offset:2048
  ds_read_b64_tr_b16 v[60:61], v10 offset:12288
  ds_read_b64_tr_b16 v[62:63], v10 offset:12800
  ds_read_b128 v[96:99], v14 offset:4096
  ds_read_b64_tr_b16 v[64:65], v10 offset:16384
  ds_read_b64_tr_b16 v[66:67], v10 offset:16896
  ds_read_b128 v[100:103], v14 offset:6144
  ds_read_b128 v[104:107], v15
  s_add_u32 m0, s58, 53248
  s_nop 0
  buffer_load_dwordx4 v1, s[24:27], s47 offen lds
  s_add_u32 m0, s58, 57344
  s_nop 0
  buffer_load_dwordx4 v1, s[28:31], s47 offen lds
  s_add_u32 s47, s47, 114688
  s_cmp_eq_u32 s47, 1835008
  s_cselect_b32 s47, 0, s47
  s_lshr_b32 s60, s55, 11
  s_add_u32 s60, s60, s43
  s_and_b32 s60, s60, 7
  s_lshl_b32 s61, s60, 11
  s_add_u32 m0, s61, 131072
  s_lshl_b32 s61, s60, 7
  buffer_load_dwordx4 v33, s[16:19], s61 offen lds
  s_lshl_b32 s61, s60, 11
  s_add_u32 m0, s61, 132096
  s_lshl_b32 s61, s60, 7
  buffer_load_dwordx4 v34, s[16:19], s61 offen lds
  s_add_u32 m0, s58, 73728
  s_nop 0
  buffer_load_dwordx4 v1, s[24:27], s47 offen lds
  s_add_u32 m0, s58, 77824
  s_nop 0
  buffer_load_dwordx4 v1, s[28:31], s47 offen lds
  s_add_u32 s47, s47, 114688
  s_cmp_eq_u32 s47, 1835008
  s_cselect_b32 s47, 0, s47
  s_add_u32 m0, s53, 0
  s_nop 0
  buffer_load_dwordx4 v4, s[16:19], s52 offen lds
P1_X1_loop:
  s_waitcnt vmcnt(6) lgkmcnt(0)
  s_barrier
  v_mfma_f32_16x16x32_bf16 v[128:131], v[48:51], v[88:91], v[128:131]
  v_add_u32 v14, s54, v7
  ds_read_b64_tr_b16 v[68:69], v10 offset:20480
  v_mfma_f32_16x16x32_bf16 v[144:147], v[52:55], v[88:91], v[144:147]
  v_add_u32 v15, s55, v9
  ds_read_b64_tr_b16 v[70:71], v10 offset:20992
  v_mfma_f32_16x16x32_bf16 v[160:163], v[88:91], v[56:59], v[160:163]
  ds_read_b64_tr_b16 v[72:73], v10 offset:24576
  v_mfma_f32_16x16x32_bf16 v[176:179], v[60:63], v[88:91], v[176:179]
  ds_read_b64_tr_b16 v[74:75], v10 offset:25088
  v_mfma_f32_16x16x32_bf16 v[192:195], v[64:67], v[88:91], v[192:195]
  ds_read_b128 v[108:111], v14 offset:0
  s_add_u32 m0, s58, 12288
  v_mfma_f32_16x16x32_bf16 v[132:135], v[48:51], v[92:95], v[132:135]
  ds_read_b64_tr_b16 v[76:77], v10 offset:28672
  buffer_load_dwordx4 v1, s[24:27], s47 offen lds
  v_mfma_f32_16x16x32_bf16 v[148:151], v[52:55], v[92:95], v[148:151]
  ds_read_b64_tr_b16 v[78:79], v10 offset:29184
  v_mfma_f32_16x16x32_bf16 v[164:167], v[92:95], v[56:59], v[164:167]
  ds_read_b128 v[112:115], v14 offset:2048
  v_mfma_f32_16x16x32_bf16 v[180:183], v[60:63], v[92:95], v[180:183]
  ds_read_b64_tr_b16 v[80:81], v10 offset:32768
  v_mfma_f32_16x16x32_bf16 v[196:199], v[64:67], v[92:95], v[196:199]
  ds_read_b64_tr_b16 v[82:83], v10 offset:33280
  s_add_u32 m0, s58, 16384
  v_mfma_f32_16x16x32_bf16 v[136:139], v[48:51], v[96:99], v[136:139]
  ds_read_b128 v[116:119], v14 offset:4096
  buffer_load_dwordx4 v1, s[28:31], s47 offen lds
  v_mfma_f32_16x16x32_bf16 v[152:155], v[52:55], v[96:99], v[152:155]
  ds_read_b64_tr_b16 v[84:85], v10 offset:36864
  s_add_u32 s47, s47, 114688
  s_cmp_eq_u32 s47, 1835008
  s_cselect_b32 s47, 0, s47
  v_mfma_f32_16x16x32_bf16 v[168:171], v[96:99], v[56:59], v[168:171]
  ds_read_b64_tr_b16 v[86:87], v10 offset:37376
  v_mfma_f32_16x16x32_bf16 v[184:187], v[60:63], v[96:99], v[184:187]
  ds_read_b128 v[120:123], v14 offset:6144
  v_mfma_f32_16x16x32_bf16 v[200:203], v[64:67], v[96:99], v[200:203]
  ds_read_b128 v[124:127], v15
  s_add_u32 m0, s53, 8192
  v_mfma_f32_16x16x32_bf16 v[140:143], v[48:51], v[100:103], v[140:143]
  buffer_load_dwordx4 v5, s[16:19], s52 offen lds
  v_mfma_f32_16x16x32_bf16 v[156:159], v[52:55], v[100:103], v[156:159]
  s_add_u32 s60, s52, 128
  s_and_b32 s60, s60, 0x380
  s_or_b32 s52, s60, s46
  v_mfma_f32_16x16x32_bf16 v[172:175], v[100:103], v[56:59], v[172:175]
  s_add_u32 s53, s53, 0x4000
  s_cmp_eq_u32 s53, s75
  s_cselect_b32 s53, s48, s53
  v_mfma_f32_16x16x32_bf16 v[188:191], v[60:63], v[100:103], v[188:191]
  v_mfma_f32_16x16x32_bf16 v[204:207], v[64:67], v[100:103], v[204:207]
  v_mfma_f32_16x16x32_bf16 v[208:211], v[104:107], v[56:59], v[208:211]
  s_waitcnt vmcnt(6) lgkmcnt(0)
  s_barrier
  v_mfma_f32_16x16x32_bf16 v[128:131], v[68:71], v[108:111], v[128:131]
  s_add_u32 s54, s54, 0x4000
  s_cmp_eq_u32 s54, 0xc000
  s_cselect_b32 s54, 0, s54
  ds_read_b64_tr_b16 v[48:49], v10 offset:40960
  v_mfma_f32_16x16x32_bf16 v[144:147], v[72:75], v[108:111], v[144:147]
  v_add_u32 v14, s54, v6
  ds_read_b64_tr_b16 v[50:51], v10 offset:41472
  v_mfma_f32_16x16x32_bf16 v[160:163], v[108:111], v[76:79], v[160:163]
  s_add_u32 s55, s55, 0x800
  s_and_b32 s55, s55, 0x3fff
  v_add_u32 v15, s55, v8
  ds_read_b64_tr_b16 v[52:53], v10 offset:45056
  v_mfma_f32_16x16x32_bf16 v[176:179], v[80:83], v[108:111], v[176:179]
  ds_read_b64_tr_b16 v[54:55], v10 offset:45568
  v_mfma_f32_16x16x32_bf16 v[192:195], v[84:87], v[108:111], v[192:195]
  ds_read_b128 v[88:91], v14 offset:0
  s_add_u32 m0, s58, 32768
  v_mfma_f32_16x16x32_bf16 v[132:135], v[68:71], v[112:115], v[132:135]
  ds_read_b64_tr_b16 v[56:57], v10 offset:49152
  buffer_load_dwordx4 v1, s[24:27], s47 offen lds
  v_mfma_f32_16x16x32_bf16 v[148:151], v[72:75], v[112:115], v[148:151]
  ds_read_b64_tr_b16 v[58:59], v10 offset:49664
  v_mfma_f32_16x16x32_bf16 v[164:167], v[112:115], v[76:79], v[164:167]
  ds_read_b128 v[92:95], v14 offset:2048
  v_mfma_f32_16x16x32_bf16 v[180:183], v[80:83], v[112:115], v[180:183]
  ds_read_b64_tr_b16 v[60:61], v10 offset:53248
  v_mfma_f32_16x16x32_bf16 v[196:199], v[84:87], v[112:115], v[196:199]
  ds_read_b64_tr_b16 v[62:63], v10 offset:53760
  s_add_u32 m0, s58, 36864
  v_mfma_f32_16x16x32_bf16 v[136:139], v[68:71], v[116:119], v[136:139]
  ds_read_b128 v[96:99], v14 offset:4096
  buffer_load_dwordx4 v1, s[28:31], s47 offen lds
  v_mfma_f32_16x16x32_bf16 v[152:155], v[72:75], v[116:119], v[152:155]
  ds_read_b64_tr_b16 v[64:65], v10 offset:57344
  s_add_u32 s47, s47, 114688
  s_cmp_eq_u32 s47, 1835008
  s_cselect_b32 s47, 0, s47
  v_mfma_f32_16x16x32_bf16 v[168:171], v[116:119], v[76:79], v[168:171]
  ds_read_b64_tr_b16 v[66:67], v10 offset:57856
  v_mfma_f32_16x16x32_bf16 v[184:187], v[80:83], v[116:119], v[184:187]
  ds_read_b128 v[100:103], v14 offset:6144
  v_mfma_f32_16x16x32_bf16 v[200:203], v[84:87], v[116:119], v[200:203]
  ds_read_b128 v[104:107], v15
  s_add_u32 m0, s53, 0
  v_mfma_f32_16x16x32_bf16 v[140:143], v[68:71], v[120:123], v[140:143]
  buffer_load_dwordx4 v4, s[16:19], s52 offen lds
  v_mfma_f32_16x16x32_bf16 v[156:159], v[72:75], v[120:123], v[156:159]
  v_mfma_f32_16x16x32_bf16 v[172:175], v[120:123], v[76:79], v[172:175]
  v_mfma_f32_16x16x32_bf16 v[188:191], v[80:83], v[120:123], v[188:191]
  v_mfma_f32_16x16x32_bf16 v[204:207], v[84:87], v[120:123], v[204:207]
  v_mfma_f32_16x16x32_bf16 v[208:211], v[124:127], v[76:79], v[208:211]
  s_waitcnt vmcnt(6) lgkmcnt(0)
  s_barrier
  v_mfma_f32_16x16x32_bf16 v[128:131], v[48:51], v[88:91], v[128:131]
  v_add_u32 v14, s54, v7
  ds_read_b64_tr_b16 v[68:69], v11 offset:0
  v_mfma_f32_16x16x32_bf16 v[144:147], v[52:55], v[88:91], v[144:147]
  v_add_u32 v15, s55, v9
  ds_read_b64_tr_b16 v[70:71], v11 offset:512
  v_mfma_f32_16x16x32_bf16 v[160:163], v[88:91], v[56:59], v[160:163]
  ds_read_b64_tr_b16 v[72:73], v11 offset:4096
  v_mfma_f32_16x16x32_bf16 v[176:179], v[60:63], v[88:91], v[176:179]
  ds_read_b64_tr_b16 v[74:75], v11 offset:4608
  v_mfma_f32_16x16x32_bf16 v[192:195], v[64:67], v[88:91], v[192:195]
  ds_read_b128 v[108:111], v14 offset:0
  s_add_u32 m0, s58, 53248
  v_mfma_f32_16x16x32_bf16 v[132:135], v[48:51], v[92:95], v[132:135]
  ds_read_b64_tr_b16 v[76:77], v11 offset:8192
  buffer_load_dwordx4 v1, s[24:27], s47 offen lds
  v_mfma_f32_16x16x32_bf16 v[148:151], v[52:55], v[92:95], v[148:151]
  ds_read_b64_tr_b16 v[78:79], v11 offset:8704
  v_mfma_f32_16x16x32_bf16 v[164:167], v[92:95], v[56:59], v[164:167]
  ds_read_b128 v[112:115], v14 offset:2048
  v_mfma_f32_16x16x32_bf16 v[180:183], v[60:63], v[92:95], v[180:183]
  ds_read_b64_tr_b16 v[80:81], v11 offset:12288
  v_mfma_f32_16x16x32_bf16 v[196:199], v[64:67], v[92:95], v[196:199]
  ds_read_b64_tr_b16 v[82:83], v11 offset:12800
  s_add_u32 m0, s58, 57344
  v_mfma_f32_16x16x32_bf16 v[136:139], v[48:51], v[96:99], v[136:139]
  ds_read_b128 v[116:119], v14 offset:4096
  buffer_load_dwordx4 v1, s[28:31], s47 offen lds
  v_mfma_f32_16x16x32_bf16 v[152:155], v[52:55], v[96:99], v[152:155]
  ds_read_b64_tr_b16 v[84:85], v11 offset:16384
  s_add_u32 s47, s47, 114688
  s_cmp_eq_u32 s47, 1835008
  s_cselect_b32 s47, 0, s47
  v_mfma_f32_16x16x32_bf16 v[168:171], v[96:99], v[56:59], v[168:171]
  ds_read_b64_tr_b16 v[86:87], v11 offset:16896
  v_mfma_f32_16x16x32_bf16 v[184:187], v[60:63], v[96:99], v[184:187]
  ds_read_b128 v[120:123], v14 offset:6144
  v_mfma_f32_16x16x32_bf16 v[200:203], v[64:67], v[96:99], v[200:203]
  ds_read_b128 v[124:127], v15
  s_add_u32 m0, s53, 8192
  v_mfma_f32_16x16x32_bf16 v[140:143], v[48:51], v[100:103], v[140:143]
  buffer_load_dwordx4 v5, s[16:19], s52 offen lds
  v_mfma_f32_16x16x32_bf16 v[156:159], v[52:55], v[100:103], v[156:159]
  s_add_u32 s60, s52, 128
  s_and_b32 s60, s60, 0x380
  s_or_b32 s52, s60, s46
  v_mfma_f32_16x16x32_bf16 v[172:175], v[100:103], v[56:59], v[172:175]
  s_add_u32 s53, s53, 0x4000
  s_cmp_eq_u32 s53, s75
  s_cselect_b32 s53, s48, s53
  v_mfma_f32_16x16x32_bf16 v[188:191], v[60:63], v[100:103], v[188:191]
  v_mfma_f32_16x16x32_bf16 v[204:207], v[64:67], v[100:103], v[204:207]
  v_mfma_f32_16x16x32_bf16 v[208:211], v[104:107], v[56:59], v[208:211]
  s_waitcnt vmcnt(6) lgkmcnt(0)
  s_barrier
  v_mfma_f32_16x16x32_bf16 v[128:131], v[68:71], v[108:111], v[128:131]
  s_add_u32 s54, s54, 0x4000
  s_cmp_eq_u32 s54, 0xc000
  s_cselect_b32 s54, 0, s54
  ds_read_b64_tr_b16 v[48:49], v10 offset:0
  v_mfma_f32_16x16x32_bf16 v[144:147], v[72:75], v[108:111], v[144:147]
  v_add_u32 v14, s54, v6
  ds_read_b64_tr_b16 v[50:51], v10 offset:512
  v_mfma_f32_16x16x32_bf16 v[160:163], v[108:111], v[76:79], v[160:163]
  s_add_u32 s55, s55, 0x800
  s_and_b32 s55, s55, 0x3fff
  v_add_u32 v15, s55, v8
  ds_read_b64_tr_b16 v[52:53], v10 offset:4096
  v_mfma_f32_16x16x32_bf16 v[176:179], v[80:83], v[108:111], v[176:179]
  ds_read_b64_tr_b16 v[54:55], v10 offset:4608
  v_mfma_f32_16x16x32_bf16 v[192:195], v[84:87], v[108:111], v[192:195]
  ds_read_b128 v[88:91], v14 offset:0
  s_add_u32 m0, s58, 73728
  v_mfma_f32_16x16x32_bf16 v[132:135], v[68:71], v[112:115], v[132:135]
  ds_read_b64_tr_b16 v[56:57], v10 offset:8192
  buffer_load_dwordx4 v1, s[24:27], s47 offen lds
  v_mfma_f32_16x16x32_bf16 v[148:151], v[72:75], v[112:115], v[148:151]
  ds_read_b64_tr_b16 v[58:59], v10 offset:8704
  v_mfma_f32_16x16x32_bf16 v[164:167], v[112:115], v[76:79], v[164:167]
  ds_read_b128 v[92:95], v14 offset:2048
  v_mfma_f32_16x16x32_bf16 v[180:183], v[80:83], v[112:115], v[180:183]
  ds_read_b64_tr_b16 v[60:61], v10 offset:12288
  v_mfma_f32_16x16x32_bf16 v[196:199], v[84:87], v[112:115], v[196:199]
  ds_read_b64_tr_b16 v[62:63], v10 offset:12800
  s_add_u32 m0, s58, 77824
  v_mfma_f32_16x16x32_bf16 v[136:139], v[68:71], v[116:119], v[136:139]
  ds_read_b128 v[96:99], v14 offset:4096
  buffer_load_dwordx4 v1, s[28:31], s47 offen lds
  v_mfma_f32_16x16x32_bf16 v[152:155], v[72:75], v[116:119], v[152:155]
  ds_read_b64_tr_b16 v[64:65], v10 offset:16384
  s_add_u32 s47, s47, 114688
  s_cmp_eq_u32 s47, 1835008
  s_cselect_b32 s47, 0, s47
  v_mfma_f32_16x16x32_bf16 v[168:171], v[116:119], v[76:79], v[168:171]
  ds_read_b64_tr_b16 v[66:67], v10 offset:16896
  v_mfma_f32_16x16x32_bf16 v[184:187], v[80:83], v[116:119], v[184:187]
  ds_read_b128 v[100:103], v14 offset:6144
  v_mfma_f32_16x16x32_bf16 v[200:203], v[84:87], v[116:119], v[200:203]
  ds_read_b128 v[104:107], v15
  s_add_u32 m0, s53, 0
  v_mfma_f32_16x16x32_bf16 v[140:143], v[68:71], v[120:123], v[140:143]
  buffer_load_dwordx4 v4, s[16:19], s52 offen lds
  v_mfma_f32_16x16x32_bf16 v[156:159], v[72:75], v[120:123], v[156:159]
  v_mfma_f32_16x16x32_bf16 v[172:175], v[120:123], v[76:79], v[172:175]
  v_mfma_f32_16x16x32_bf16 v[188:191], v[80:83], v[120:123], v[188:191]
  v_mfma_f32_16x16x32_bf16 v[204:207], v[84:87], v[120:123], v[204:207]
  v_mfma_f32_16x16x32_bf16 v[208:211], v[124:127], v[76:79], v[208:211]
  s_lshr_b32 s57, s57, 4
  s_add_u32 s56, s56, 1
  s_cmp_lt_u32 s56, 3
  s_cbranch_scc1 P1_X1_loop
  s_waitcnt vmcnt(6) lgkmcnt(0)
  s_barrier
  v_mfma_f32_16x16x32_bf16 v[128:131], v[48:51], v[88:91], v[128:131]
  v_add_u32 v14, s54, v7
  ds_read_b64_tr_b16 v[68:69], v10 offset:20480
  s_mul_i32 s60, s41, 20480
  s_lshl_b32 s61, s43, 6
  s_add_u32 s60, s60, s61
  v_mfma_f32_16x16x32_bf16 v[144:147], v[52:55], v[88:91], v[144:147]
  v_add_u32 v15, s55, v9
  ds_read_b64_tr_b16 v[70:71], v10 offset:20992
  s_add_u32 s60, s60, 9453568
  v_and_b32 v20, 15, v0
  v_mfma_f32_16x16x32_bf16 v[160:163], v[88:91], v[56:59], v[160:163]
  ds_read_b64_tr_b16 v[72:73], v10 offset:24576
  v_mul_u32_u24 v20, 1280, v20
  v_lshrrev_b32 v21, 4, v0
  v_mfma_f32_16x16x32_bf16 v[176:179], v[60:63], v[88:91], v[176:179]
  ds_read_b64_tr_b16 v[74:75], v10 offset:25088
  v_lshl_add_u32 v20, v21, 4, v20
  v_add_u32 v20, s60, v20
  buffer_load_dwordx4 v[212:215], v20, s[32:35], 0 offen sc1
  v_mfma_f32_16x16x32_bf16 v[192:195], v[64:67], v[88:91], v[192:195]
  ds_read_b128 v[108:111], v14 offset:0
  buffer_load_dwordx4 v[216:219], v20, s[32:35], 0 offen offset:512 sc1
  s_lshl_b32 s60, s43, 6
  v_mfma_f32_16x16x32_bf16 v[132:135], v[48:51], v[92:95], v[132:135]
  ds_read_b64_tr_b16 v[76:77], v10 offset:28672
  s_lshl_b32 s61, s40, 7
  s_add_u32 s60, s60, s61
  v_mfma_f32_16x16x32_bf16 v[148:151], v[52:55], v[92:95], v[148:151]
  ds_read_b64_tr_b16 v[78:79], v10 offset:29184
  s_sub_u32 s60, s60, 16
  v_add_u32 v22, s60, v0
  v_max_i32 v22, 0, v22
  v_mfma_f32_16x16x32_bf16 v[164:167], v[92:95], v[56:59], v[164:167]
  ds_read_b128 v[112:115], v14 offset:2048
  v_min_i32 v22, 2047, v22
  v_lshlrev_b32 v22, 3, v22
  v_mfma_f32_16x16x32_bf16 v[180:183], v[60:63], v[92:95], v[180:183]
  ds_read_b64_tr_b16 v[80:81], v10 offset:32768
  v_add_u32 v22, 9437184, v22
  buffer_load_dwordx2 v[224:225], v22, s[32:35], 0 offen sc1
  v_mfma_f32_16x16x32_bf16 v[196:199], v[64:67], v[92:95], v[196:199]
  ds_read_b64_tr_b16 v[82:83], v10 offset:33280
  v_mfma_f32_16x16x32_bf16 v[136:139], v[48:51], v[96:99], v[136:139]
  ds_read_b128 v[116:119], v14 offset:4096
  v_mfma_f32_16x16x32_bf16 v[152:155], v[52:55], v[96:99], v[152:155]
  ds_read_b64_tr_b16 v[84:85], v10 offset:36864
  v_mfma_f32_16x16x32_bf16 v[168:171], v[96:99], v[56:59], v[168:171]
  ds_read_b64_tr_b16 v[86:87], v10 offset:37376
  v_mfma_f32_16x16x32_bf16 v[184:187], v[60:63], v[96:99], v[184:187]
  ds_read_b128 v[120:123], v14 offset:6144
  v_mfma_f32_16x16x32_bf16 v[200:203], v[64:67], v[96:99], v[200:203]
  ds_read_b128 v[124:127], v15
  v_mfma_f32_16x16x32_bf16 v[140:143], v[48:51], v[100:103], v[140:143]
  v_mfma_f32_16x16x32_bf16 v[156:159], v[52:55], v[100:103], v[156:159]
  v_mfma_f32_16x16x32_bf16 v[172:175], v[100:103], v[56:59], v[172:175]
  v_mfma_f32_16x16x32_bf16 v[188:191], v[60:63], v[100:103], v[188:191]
  v_mfma_f32_16x16x32_bf16 v[204:207], v[64:67], v[100:103], v[204:207]
  v_mfma_f32_16x16x32_bf16 v[208:211], v[104:107], v[56:59], v[208:211]
  s_cmp_lt_u32 s43, 5
  s_cbranch_scc0 L_tch_3024
  s_mov_b32 s61, s43
  s_lshr_b32 s60, s2, 3
  s_mul_i32 s60, s60, 5
  s_add_u32 s60, s60, s61
  s_min_u32 s60, s60, 143
  s_add_u32 s61, s60, 64
  s_add_u32 s62, s60, 72
  s_cmp_lt_u32 s60, 72
  s_cselect_b32 s60, s61, s62
  s_lshl_b32 s60, s60, 13
  v_lshlrev_b32 v23, 7, v0
  v_add_u32 v23, s60, v23
  global_load_dword v45, v23, s[72:73]
L_tch_3024:
  s_waitcnt vmcnt(6) lgkmcnt(0)
  s_barrier
  v_mfma_f32_16x16x32_bf16 v[128:131], v[68:71], v[108:111], v[128:131]
  s_add_u32 s54, s54, 0x4000
  s_cmp_eq_u32 s54, 0xc000
  s_cselect_b32 s54, 0, s54
  ds_read_b64_tr_b16 v[48:49], v10 offset:40960
  v_mfma_f32_16x16x32_bf16 v[144:147], v[72:75], v[108:111], v[144:147]
  v_add_u32 v14, s54, v6
  ds_read_b64_tr_b16 v[50:51], v10 offset:41472
  v_mfma_f32_16x16x32_bf16 v[160:163], v[108:111], v[76:79], v[160:163]
  s_add_u32 s55, s55, 0x800
  s_and_b32 s55, s55, 0x3fff
  v_add_u32 v15, s55, v8
  ds_read_b64_tr_b16 v[52:53], v10 offset:45056
  v_mfma_f32_16x16x32_bf16 v[176:179], v[80:83], v[108:111], v[176:179]
  ds_read_b64_tr_b16 v[54:55], v10 offset:45568
  s_mov_b32 s20, s72
  v_mfma_f32_16x16x32_bf16 v[192:195], v[84:87], v[108:111], v[192:195]
  ds_read_b128 v[88:91], v14 offset:0
  v_mfma_f32_16x16x32_bf16 v[132:135], v[68:71], v[112:115], v[132:135]
  ds_read_b64_tr_b16 v[56:57], v10 offset:49152
  v_mfma_f32_16x16x32_bf16 v[148:151], v[72:75], v[112:115], v[148:151]
  ds_read_b64_tr_b16 v[58:59], v10 offset:49664
  s_and_b32 s21, s73, 0xffff
  v_mfma_f32_16x16x32_bf16 v[164:167], v[112:115], v[76:79], v[164:167]
  ds_read_b128 v[92:95], v14 offset:2048
  v_mfma_f32_16x16x32_bf16 v[180:183], v[80:83], v[112:115], v[180:183]
  ds_read_b64_tr_b16 v[60:61], v10 offset:53248
  v_mfma_f32_16x16x32_bf16 v[196:199], v[84:87], v[112:115], v[196:199]
  ds_read_b64_tr_b16 v[62:63], v10 offset:53760
  s_mov_b32 s22, 0x1c0000
  v_mfma_f32_16x16x32_bf16 v[136:139], v[68:71], v[116:119], v[136:139]
  ds_read_b128 v[96:99], v14 offset:4096
  v_mfma_f32_16x16x32_bf16 v[152:155], v[72:75], v[116:119], v[152:155]
  ds_read_b64_tr_b16 v[64:65], v10 offset:57344
  v_mfma_f32_16x16x32_bf16 v[168:171], v[116:119], v[76:79], v[168:171]
  ds_read_b64_tr_b16 v[66:67], v10 offset:57856
  s_mov_b32 s23, 0x20000
  v_mfma_f32_16x16x32_bf16 v[184:187], v[80:83], v[116:119], v[184:187]
  ds_read_b128 v[100:103], v14 offset:6144
  v_mfma_f32_16x16x32_bf16 v[200:203], v[84:87], v[116:119], v[200:203]
  ds_read_b128 v[104:107], v15
  v_mfma_f32_16x16x32_bf16 v[140:143], v[68:71], v[120:123], v[140:143]
  s_mul_i32 s66, s45, 655360
  v_mfma_f32_16x16x32_bf16 v[156:159], v[72:75], v[120:123], v[156:159]
  v_mfma_f32_16x16x32_bf16 v[172:175], v[120:123], v[76:79], v[172:175]
  v_mfma_f32_16x16x32_bf16 v[188:191], v[80:83], v[120:123], v[188:191]
  s_add_u32 s66, s66, 524288
  v_mfma_f32_16x16x32_bf16 v[204:207], v[84:87], v[120:123], v[204:207]
  v_mfma_f32_16x16x32_bf16 v[208:211], v[124:127], v[76:79], v[208:211]
  s_cmp_eq_u32 s43, 4
  s_cbranch_scc0 L_wbn_3026
  s_waitcnt vmcnt(4)
  s_branch L_wbw_3025
L_wbn_3026:
  s_waitcnt vmcnt(3)
L_wbw_3025:
  s_waitcnt vmcnt(63) lgkmcnt(0)
  s_barrier
  v_mfma_f32_16x16x32_bf16 v[128:131], v[48:51], v[88:91], v[128:131]
  v_add_u32 v14, s54, v7
  ds_read_b64_tr_b16 v[68:69], v11 offset:0
  v_mfma_f32_16x16x32_bf16 v[144:147], v[52:55], v[88:91], v[144:147]
  v_add_u32 v15, s55, v9
  ds_read_b64_tr_b16 v[70:71], v11 offset:512
  v_mfma_f32_16x16x32_bf16 v[160:163], v[88:91], v[56:59], v[160:163]
  ds_read_b64_tr_b16 v[72:73], v11 offset:4096
  v_mfma_f32_16x16x32_bf16 v[176:179], v[60:63], v[88:91], v[176:179]
  ds_read_b64_tr_b16 v[74:75], v11 offset:4608
  v_mfma_f32_16x16x32_bf16 v[192:195], v[64:67], v[88:91], v[192:195]
  ds_read_b128 v[108:111], v14 offset:0
  v_mfma_f32_16x16x32_bf16 v[132:135], v[48:51], v[92:95], v[132:135]
  ds_read_b64_tr_b16 v[76:77], v11 offset:8192
  v_mfma_f32_16x16x32_bf16 v[148:151], v[52:55], v[92:95], v[148:151]
  ds_read_b64_tr_b16 v[78:79], v11 offset:8704
  v_mfma_f32_16x16x32_bf16 v[164:167], v[92:95], v[56:59], v[164:167]
  ds_read_b128 v[112:115], v14 offset:2048
  v_mfma_f32_16x16x32_bf16 v[180:183], v[60:63], v[92:95], v[180:183]
  ds_read_b64_tr_b16 v[80:81], v11 offset:12288
  v_mfma_f32_16x16x32_bf16 v[196:199], v[64:67], v[92:95], v[196:199]
  ds_read_b64_tr_b16 v[82:83], v11 offset:12800
  v_mfma_f32_16x16x32_bf16 v[136:139], v[48:51], v[96:99], v[136:139]
  ds_read_b128 v[116:119], v14 offset:4096
  v_mfma_f32_16x16x32_bf16 v[152:155], v[52:55], v[96:99], v[152:155]
  ds_read_b64_tr_b16 v[84:85], v11 offset:16384
  v_mfma_f32_16x16x32_bf16 v[168:171], v[96:99], v[56:59], v[168:171]
  ds_read_b64_tr_b16 v[86:87], v11 offset:16896
  v_mfma_f32_16x16x32_bf16 v[184:187], v[60:63], v[96:99], v[184:187]
  ds_read_b128 v[120:123], v14 offset:6144
  v_mfma_f32_16x16x32_bf16 v[200:203], v[64:67], v[96:99], v[200:203]
  ds_read_b128 v[124:127], v15
  v_mfma_f32_16x16x32_bf16 v[140:143], v[48:51], v[100:103], v[140:143]
  v_mfma_f32_16x16x32_bf16 v[156:159], v[52:55], v[100:103], v[156:159]
  v_mfma_f32_16x16x32_bf16 v[172:175], v[100:103], v[56:59], v[172:175]
  v_mfma_f32_16x16x32_bf16 v[188:191], v[60:63], v[100:103], v[188:191]
  v_mfma_f32_16x16x32_bf16 v[204:207], v[64:67], v[100:103], v[204:207]
  v_mfma_f32_16x16x32_bf16 v[208:211], v[104:107], v[56:59], v[208:211]
  s_cmp_ge_u32 s43, 3
  s_cbranch_scc0 L_tch_3027
  s_sub_u32 s61, s43, 3
  s_lshr_b32 s60, s2, 3
  s_mul_i32 s60, s60, 5
  s_add_u32 s60, s60, s61
  s_min_u32 s60, s60, 143
  s_add_u32 s61, s60, 136
  s_add_u32 s62, s60, 208
  s_cmp_lt_u32 s60, 8
  s_cselect_b32 s61, s61, s62
  s_sub_u32 s62, s60, 16
  s_cmp_lt_u32 s60, 16
  s_cselect_b32 s61, s61, s62
  s_sub_u32 s62, s60, 80
  s_cmp_lt_u32 s60, 80
  s_cselect_b32 s61, s61, s62
  s_sub_u32 s62, s60, 16
  s_cmp_lt_u32 s62, 64
  s_cselect_b32 s64, s70, s72
  s_cselect_b32 s65, s71, s73
  s_mov_b32 s60, s61
  s_lshl_b32 s60, s60, 13
  v_lshlrev_b32 v23, 7, v0
  v_add_u32 v23, s60, v23
  global_load_dword v46, v23, s[64:65]
L_tch_3027:
  s_cmp_eq_u32 s43, 4
  s_cbranch_scc0 L_wbn_3029
  s_waitcnt vmcnt(2)
  s_branch L_wbw_3028
L_wbn_3029:
  s_waitcnt vmcnt(1)
L_wbw_3028:
  s_waitcnt vmcnt(63) lgkmcnt(0)
  s_barrier
  v_mfma_f32_16x16x32_bf16 v[128:131], v[68:71], v[108:111], v[128:131]
  v_add_f32_dpp v212, v212, v212 row_ror:8 row_mask:0xf bank_mask:0xf
  v_add_f32_dpp v213, v213, v213 row_ror:8 row_mask:0xf bank_mask:0xf
  v_mfma_f32_16x16x32_bf16 v[144:147], v[72:75], v[108:111], v[144:147]
  v_add_f32_dpp v214, v214, v214 row_ror:8 row_mask:0xf bank_mask:0xf
  v_add_f32_dpp v215, v215, v215 row_ror:8 row_mask:0xf bank_mask:0xf
  v_mfma_f32_16x16x32_bf16 v[160:163], v[108:111], v[76:79], v[160:163]
  v_add_f32_dpp v216, v216, v216 row_ror:8 row_mask:0xf bank_mask:0xf
  v_add_f32_dpp v217, v217, v217 row_ror:8 row_mask:0xf bank_mask:0xf
  v_mfma_f32_16x16x32_bf16 v[176:179], v[80:83], v[108:111], v[176:179]
  v_add_f32_dpp v218, v218, v218 row_ror:8 row_mask:0xf bank_mask:0xf
  v_mfma_f32_16x16x32_bf16 v[192:195], v[84:87], v[108:111], v[192:195]
  v_add_f32_dpp v219, v219, v219 row_ror:8 row_mask:0xf bank_mask:0xf
  v_add_f32_dpp v212, v212, v212 row_ror:4 row_mask:0xf bank_mask:0xf
  v_mfma_f32_16x16x32_bf16 v[132:135], v[68:71], v[112:115], v[132:135]
  v_add_f32_dpp v213, v213, v213 row_ror:4 row_mask:0xf bank_mask:0xf
  v_add_f32_dpp v214, v214, v214 row_ror:4 row_mask:0xf bank_mask:0xf
  v_mfma_f32_16x16x32_bf16 v[148:151], v[72:75], v[112:115], v[148:151]
  v_add_f32_dpp v215, v215, v215 row_ror:4 row_mask:0xf bank_mask:0xf
  v_mfma_f32_16x16x32_bf16 v[164:167], v[112:115], v[76:79], v[164:167]
  v_add_f32_dpp v216, v216, v216 row_ror:4 row_mask:0xf bank_mask:0xf
  v_add_f32_dpp v217, v217, v217 row_ror:4 row_mask:0xf bank_mask:0xf
  v_mfma_f32_16x16x32_bf16 v[180:183], v[80:83], v[112:115], v[180:183]
  v_add_f32_dpp v218, v218, v218 row_ror:4 row_mask:0xf bank_mask:0xf
  v_add_f32_dpp v219, v219, v219 row_ror:4 row_mask:0xf bank_mask:0xf
  v_mfma_f32_16x16x32_bf16 v[196:199], v[84:87], v[112:115], v[196:199]
  v_add_f32_dpp v212, v212, v212 row_ror:2 row_mask:0xf bank_mask:0xf
  v_mfma_f32_16x16x32_bf16 v[136:139], v[68:71], v[116:119], v[136:139]
  v_add_f32_dpp v213, v213, v213 row_ror:2 row_mask:0xf bank_mask:0xf
  v_add_f32_dpp v214, v214, v214 row_ror:2 row_mask:0xf bank_mask:0xf
  v_mfma_f32_16x16x32_bf16 v[152:155], v[72:75], v[116:119], v[152:155]
  v_add_f32_dpp v215, v215, v215 row_ror:2 row_mask:0xf bank_mask:0xf
  v_add_f32_dpp v216, v216, v216 row_ror:2 row_mask:0xf bank_mask:0xf
  v_mfma_f32_16x16x32_bf16 v[168:171], v[116:119], v[76:79], v[168:171]
  v_add_f32_dpp v217, v217, v217 row_ror:2 row_mask:0xf bank_mask:0xf
  v_mfma_f32_16x16x32_bf16 v[184:187], v[80:83], v[116:119], v[184:187]
  v_add_f32_dpp v218, v218, v218 row_ror:2 row_mask:0xf bank_mask:0xf
  v_add_f32_dpp v219, v219, v219 row_ror:2 row_mask:0xf bank_mask:0xf
  v_mfma_f32_16x16x32_bf16 v[200:203], v[84:87], v[116:119], v[200:203]
  v_add_f32_dpp v212, v212, v212 row_ror:1 row_mask:0xf bank_mask:0xf
  v_add_f32_dpp v213, v213, v213 row_ror:1 row_mask:0xf bank_mask:0xf
  v_mfma_f32_16x16x32_bf16 v[140:143], v[68:71], v[120:123], v[140:143]
  v_add_f32_dpp v214, v214, v214 row_ror:1 row_mask:0xf bank_mask:0xf
  v_mfma_f32_16x16x32_bf16 v[156:159], v[72:75], v[120:123], v[156:159]
  v_add_f32_dpp v215, v215, v215 row_ror:1 row_mask:0xf bank_mask:0xf
  v_add_f32_dpp v216, v216, v216 row_ror:1 row_mask:0xf bank_mask:0xf
  v_mfma_f32_16x16x32_bf16 v[172:175], v[120:123], v[76:79], v[172:175]
  v_add_f32_dpp v217, v217, v217 row_ror:1 row_mask:0xf bank_mask:0xf
  v_add_f32_dpp v218, v218, v218 row_ror:1 row_mask:0xf bank_mask:0xf
  v_mfma_f32_16x16x32_bf16 v[188:191], v[80:83], v[120:123], v[188:191]
  v_add_f32_dpp v219, v219, v219 row_ror:1 row_mask:0xf bank_mask:0xf
  v_mfma_f32_16x16x32_bf16 v[204:207], v[84:87], v[120:123], v[204:207]
  v_mfma_f32_16x16x32_bf16 v[208:211], v[124:127], v[76:79], v[208:211]
  ds_write_b128 v36, v[212:215]
  ds_write_b128 v36, v[216:219] offset:512
  ds_write_b128 v37, v[220:223]
  ds_write_b32 v38, v224 offset:0
  ds_write_b32 v38, v225 offset:576
  s_waitcnt lgkmcnt(0)
  s_barrier
  v_and_b32 v20, 15, v0
  v_lshlrev_b32 v10, 2, v20
  v_add_u32 v10, 147456, v10
  v_and_b32 v11, 48, v0
  v_add_u32 v11, 147456, v11
  s_lshl_b32 s60, s44, 6
  v_add_u32 v22, s60, v11
  v_add_u32 v23, s60, v10
  ds_read_b128 v[64:67], v22 offset:1408
  ds_read_b32 v48, v10 offset:320
  ds_read_b32 v52, v10 offset:896
  ds_read_b32 v49, v10 offset:384
  ds_read_b32 v53, v10 offset:960
  ds_read_b32 v50, v10 offset:448
  ds_read_b32 v54, v10 offset:1024
  ds_read_b32 v51, v10 offset:512
  ds_read_b32 v55, v10 offset:1088
  ds_read_b32 v58, v23 offset:1664
  ds_read_b128 v[88:91], v11 offset:512
  ds_read_b128 v[104:107], v11 offset:1088
  ds_read_b128 v[108:111], v11 offset:0
  ds_read_b128 v[112:115], v11 offset:576
  v_mov_b32 v12, 0xbdd2d3e8
  s_mov_b32 s64, 0xc0135761
  s_mov_b32 s28, 0xaaaaaaaa
  s_mov_b32 s29, 0xaaaaaaaa
  s_mov_b32 s30, 0xfff0ffff
  s_mov_b32 s31, 0xf000ff00
  s_mov_b32 s36, 0xffc0fffc
  s_mov_b32 s37, 0xc000fc00
  v_mov_b32 v25, 0xffff
  v_mov_b32 v26, 0xffff0000
  v_cndmask_b32 v25, v25, v26, s[28:29]
  v_cndmask_b32 v232, v25, 0, s[30:31]
  v_cndmask_b32 v233, v25, 0, s[36:37]
  v_cndmask_b32 v234, 0, v25, s[30:31]
  v_cndmask_b32 v235, 0, v25, s[36:37]
  s_mul_i32 s60, s44, 1536
  s_add_u32 s60, s60, 147456
  v_lshlrev_b32 v24, 3, v0
  v_add_u32 v24, s60, v24
  s_waitcnt lgkmcnt(0)
  ds_read_b128 v[76:79], v11 offset:320
  ds_read_b128 v[92:95], v11 offset:896
  ds_read_b128 v[80:83], v11 offset:384
  ds_read_b128 v[96:99], v11 offset:960
  ds_read_b128 v[84:87], v11 offset:448
  ds_read_b128 v[100:103], v11 offset:1024
  ds_read_b128 v[68:71], v22 offset:1920
  ds_read_b128 v[72:75], v22 offset:2176
  ds_read_b128 v[60:63], v22 offset:1152
  v_pk_fma_f32 v[208:209], v[108:109], v[58:59], v[208:209] op_sel_hi:[1,0,1] neg_lo:[1,0,0] neg_hi:[1,0,0]
  v_pk_fma_f32 v[210:211], v[110:111], v[58:59], v[210:211] op_sel_hi:[1,0,1] neg_lo:[1,0,0] neg_hi:[1,0,0]
  v_pk_mul_f32 v[208:209], v[112:113], v[208:209]
  v_pk_mul_f32 v[210:211], v[114:115], v[210:211]
  v_cvt_pk_bf16_f32 v212, v208, v209
  v_cvt_pk_bf16_f32 v213, v210, v211
  ds_write_b64 v24, v[212:213] offset:3456
  s_waitcnt lgkmcnt(0)
  s_barrier
  ds_read_b64 v[116:117], v24 offset:2432
  ds_read_b64 v[212:213], v24 offset:2944
  s_add_u32 m0, s68, 0
  s_nop 0
  buffer_load_dwordx4 v41, s[20:23], s66 offen lds
  s_add_u32 s66, s66, 32768
  s_add_u32 m0, s68, 8192
  s_nop 0
  buffer_load_dwordx4 v41, s[20:23], s66 offen lds
  s_add_u32 s66, s66, 32768
  s_add_u32 m0, s68, 16384
  s_nop 0
  buffer_load_dwordx4 v41, s[20:23], s66 offen lds
  s_add_u32 s66, s66, 32768
  s_add_u32 m0, s68, 24576
  s_nop 0
  buffer_load_dwordx4 v41, s[20:23], s66 offen lds
  s_add_u32 s66, s66, 32768
  s_add_u32 m0, s68, 32768
  s_nop 0
  buffer_load_dwordx4 v41, s[20:23], s66 offen lds
  s_add_u32 s66, s66, 32768
  s_add_u32 m0, s68, 40960
  s_nop 0
  buffer_load_dwordx4 v41, s[20:23], s66 offen lds
  s_add_u32 s66, s66, 32768
  s_add_u32 m0, s68, 49152
  s_nop 0
  buffer_load_dwordx4 v41, s[20:23], s66 offen lds
  s_add_u32 s66, s66, 32768
  s_add_u32 m0, s68, 57344
  s_nop 0
  buffer_load_dwordx4 v41, s[20:23], s66 offen lds
  s_add_u32 s66, s66, 32768
  s_add_u32 m0, s68, 65536
  s_nop 0
  buffer_load_dwordx4 v41, s[20:23], s66 offen lds
  s_add_u32 s66, s66, 32768
  s_add_u32 m0, s68, 73728
  s_nop 0
  buffer_load_dwordx4 v41, s[20:23], s66 offen lds
  s_add_u32 s66, s66, 32768
  s_add_u32 m0, s68, 81920
  s_nop 0
  buffer_load_dwordx4 v41, s[20:23], s66 offen lds
  s_add_u32 s66, s66, 32768
  s_add_u32 m0, s68, 90112
  s_nop 0
  buffer_load_dwordx4 v41, s[20:23], s66 offen lds
  s_add_u32 s66, s66, 32768
  s_add_u32 m0, s68, 98304
  s_nop 0
  buffer_load_dwordx4 v41, s[20:23], s66 offen lds
  s_add_u32 s66, s66, 32768
  s_add_u32 m0, s68, 106496
  s_nop 0
  buffer_load_dwordx4 v41, s[20:23], s66 offen lds
  s_add_u32 s66, s66, 32768
  s_add_u32 m0, s68, 114688
  s_nop 0
  buffer_load_dwordx4 v41, s[20:23], s66 offen lds
  s_add_u32 s66, s66, 32768
  s_add_u32 m0, s68, 122880
  s_nop 0
  buffer_load_dwordx4 v41, s[20:23], s66 offen lds
  s_add_u32 s66, s66, 32768
  s_add_u32 m0, s68, 131072
  s_nop 0
  buffer_load_dwordx4 v41, s[20:23], s66 offen lds
  s_add_u32 s66, s66, 32768
  s_add_u32 m0, s68, 139264
  s_nop 0
  buffer_load_dwordx4 v41, s[20:23], s66 offen lds
  s_add_u32 s66, s66, 32768
  v_pk_fma_f32 v[144:145], v[48:49], v[64:65], v[144:145] op_sel_hi:[0,1,1] neg_lo:[1,0,0] neg_hi:[1,0,0]
  v_pk_fma_f32 v[146:147], v[48:49], v[66:67], v[146:147] op_sel_hi:[0,1,1] neg_lo:[1,0,0] neg_hi:[1,0,0]
  v_pk_fma_f32 v[148:149], v[48:49], v[64:65], v[148:149] op_sel:[1,0,0] neg_lo:[1,0,0] neg_hi:[1,0,0]
  v_pk_fma_f32 v[150:151], v[48:49], v[66:67], v[150:151] op_sel:[1,0,0] neg_lo:[1,0,0] neg_hi:[1,0,0]
  v_pk_fma_f32 v[152:153], v[50:51], v[64:65], v[152:153] op_sel_hi:[0,1,1] neg_lo:[1,0,0] neg_hi:[1,0,0]
  v_pk_fma_f32 v[154:155], v[50:51], v[66:67], v[154:155] op_sel_hi:[0,1,1] neg_lo:[1,0,0] neg_hi:[1,0,0]
  v_pk_fma_f32 v[156:157], v[50:51], v[64:65], v[156:157] op_sel:[1,0,0] neg_lo:[1,0,0] neg_hi:[1,0,0]
  v_pk_fma_f32 v[158:159], v[50:51], v[66:67], v[158:159] op_sel:[1,0,0] neg_lo:[1,0,0] neg_hi:[1,0,0]
  v_pk_mul_f32 v[144:145], v[52:53], v[144:145] op_sel_hi:[0,1]
  v_pk_mul_f32 v[146:147], v[52:53], v[146:147] op_sel_hi:[0,1]
  v_pk_mul_f32 v[148:149], v[52:53], v[148:149] op_sel:[1,0]
  v_pk_mul_f32 v[150:151], v[52:53], v[150:151] op_sel:[1,0]
  v_pk_mul_f32 v[152:153], v[54:55], v[152:153] op_sel_hi:[0,1]
  v_pk_mul_f32 v[154:155], v[54:55], v[154:155] op_sel_hi:[0,1]
  v_pk_mul_f32 v[156:157], v[54:55], v[156:157] op_sel:[1,0]
  v_pk_mul_f32 v[158:159], v[54:55], v[158:159] op_sel:[1,0]
  v_cvt_pk_bf16_f32 v118, v144, v145
  v_cvt_pk_bf16_f32 v119, v146, v147
  v_cvt_pk_bf16_f32 v120, v148, v149
  v_cvt_pk_bf16_f32 v121, v150, v151
  v_cvt_pk_bf16_f32 v122, v152, v153
  v_cvt_pk_bf16_f32 v123, v154, v155
  v_cvt_pk_bf16_f32 v124, v156, v157
  v_cvt_pk_bf16_f32 v125, v158, v159
  v_pk_fma_f32 v[172:173], v[88:89], v[58:59], v[172:173] op_sel_hi:[1,0,1] neg_lo:[1,0,0] neg_hi:[1,0,0]
  v_pk_fma_f32 v[174:175], v[90:91], v[58:59], v[174:175] op_sel_hi:[1,0,1] neg_lo:[1,0,0] neg_hi:[1,0,0]
  v_pk_mul_f32 v[172:173], v[104:105], v[172:173]
  v_pk_mul_f32 v[174:175], v[106:107], v[174:175]
  v_cvt_pk_bf16_f32 v220, v172, v173
  v_cvt_pk_bf16_f32 v221, v174, v175
  v_mul_f32 v252, 0x3eb8aa3b, v52
  v_mul_f32 v253, 0x3eb8aa3b, v53
  v_mul_f32 v254, 0x3eb8aa3b, v54
  v_mul_f32 v255, 0x3eb8aa3b, v55
  v_pk_fma_f32 v[160:161], v[76:77], v[58:59], v[160:161] op_sel_hi:[1,0,1] neg_lo:[1,0,0] neg_hi:[1,0,0]
  v_pk_fma_f32 v[162:163], v[78:79], v[58:59], v[162:163] op_sel_hi:[1,0,1] neg_lo:[1,0,0] neg_hi:[1,0,0]
  v_pk_mul_f32 v[160:161], v[92:93], v[160:161]
  v_pk_mul_f32 v[162:163], v[94:95], v[162:163]
  v_cvt_pk_bf16_f32 v214, v160, v161
  v_cvt_pk_bf16_f32 v215, v162, v163
  v_pk_fma_f32 v[164:165], v[80:81], v[58:59], v[164:165] op_sel_hi:[1,0,1] neg_lo:[1,0,0] neg_hi:[1,0,0]
  v_pk_fma_f32 v[166:167], v[82:83], v[58:59], v[166:167] op_sel_hi:[1,0,1] neg_lo:[1,0,0] neg_hi:[1,0,0]
  v_pk_mul_f32 v[164:165], v[96:97], v[164:165]
  v_pk_mul_f32 v[166:167], v[98:99], v[166:167]
  v_cvt_pk_bf16_f32 v216, v164, v165
  v_cvt_pk_bf16_f32 v217, v166, v167
  v_pk_fma_f32 v[168:169], v[84:85], v[58:59], v[168:169] op_sel_hi:[1,0,1] neg_lo:[1,0,0] neg_hi:[1,0,0]
  v_pk_fma_f32 v[170:171], v[86:87], v[58:59], v[170:171] op_sel_hi:[1,0,1] neg_lo:[1,0,0] neg_hi:[1,0,0]
  v_pk_mul_f32 v[168:169], v[100:101], v[168:169]
  v_pk_mul_f32 v[170:171], v[102:103], v[170:171]
  v_cvt_pk_bf16_f32 v218, v168, v169
  v_cvt_pk_bf16_f32 v219, v170, v171
  v_pk_fma_f32 v[128:129], v[48:49], v[60:61], v[128:129] op_sel_hi:[0,1,1] neg_lo:[1,0,0] neg_hi:[1,0,0]
  v_pk_fma_f32 v[130:131], v[48:49], v[62:63], v[130:131] op_sel_hi:[0,1,1] neg_lo:[1,0,0] neg_hi:[1,0,0]
  v_pk_fma_f32 v[132:133], v[48:49], v[60:61], v[132:133] op_sel:[1,0,0] neg_lo:[1,0,0] neg_hi:[1,0,0]
  v_pk_fma_f32 v[134:135], v[48:49], v[62:63], v[134:135] op_sel:[1,0,0] neg_lo:[1,0,0] neg_hi:[1,0,0]
  v_pk_fma_f32 v[136:137], v[50:51], v[60:61], v[136:137] op_sel_hi:[0,1,1] neg_lo:[1,0,0] neg_hi:[1,0,0]
  v_pk_fma_f32 v[138:139], v[50:51], v[62:63], v[138:139] op_sel_hi:[0,1,1] neg_lo:[1,0,0] neg_hi:[1,0,0]
  v_pk_fma_f32 v[140:141], v[50:51], v[60:61], v[140:141] op_sel:[1,0,0] neg_lo:[1,0,0] neg_hi:[1,0,0]
  v_pk_fma_f32 v[142:143], v[50:51], v[62:63], v[142:143] op_sel:[1,0,0] neg_lo:[1,0,0] neg_hi:[1,0,0]
  v_pk_mul_f32 v[128:129], v[252:253], v[128:129] op_sel_hi:[0,1]
  v_pk_mul_f32 v[130:131], v[252:253], v[130:131] op_sel_hi:[0,1]
  v_pk_mul_f32 v[132:133], v[252:253], v[132:133] op_sel:[1,0]
  v_pk_mul_f32 v[134:135], v[252:253], v[134:135] op_sel:[1,0]
  v_pk_mul_f32 v[136:137], v[254:255], v[136:137] op_sel_hi:[0,1]
  v_pk_mul_f32 v[138:139], v[254:255], v[138:139] op_sel_hi:[0,1]
  v_pk_mul_f32 v[140:141], v[254:255], v[140:141] op_sel:[1,0]
  v_pk_mul_f32 v[142:143], v[254:255], v[142:143] op_sel:[1,0]
  v_cvt_pk_bf16_f32 v222, v128, v129
  v_cvt_pk_bf16_f32 v223, v130, v131
  v_cvt_pk_bf16_f32 v224, v132, v133
  v_cvt_pk_bf16_f32 v225, v134, v135
  v_cvt_pk_bf16_f32 v226, v136, v137
  v_cvt_pk_bf16_f32 v227, v138, v139
  v_cvt_pk_bf16_f32 v228, v140, v141
  v_cvt_pk_bf16_f32 v229, v142, v143
  v_bfe_u32 v27, v0, 4, 1
  s_lshl_b32 s60, s40, 3
  s_add_u32 s60, s60, 4
  v_add_u32 v27, s60, v27
  v_mul_u32_u24 v27, 73728, v27
  v_lshrrev_b32 v26, 5, v0
  v_lshl_add_u32 v27, v26, 8, v27
  v_and_b32 v26, 15, v0
  v_lshl_add_u32 v13, v26, 4, v27
  s_lshl_b32 s60, s42, 11
  s_lshl_b32 s61, s44, 9
  s_add_u32 s60, s60, s61
  v_add_u32 v13, s60, v13
  v_add_u32 v14, 16384, v13
  s_waitcnt lgkmcnt(0)
  v_mfma_f32_16x16x16_bf16 v[144:147], v[118:119], v[222:223], 0
  v_mfma_f32_16x16x16_bf16 v[128:131], v[116:117], v[222:223], 0
  v_mfma_f32_16x16x16_bf16 v[148:151], v[120:121], v[224:225], 0
  v_mfma_f32_16x16x16_bf16 v[132:135], v[118:119], v[224:225], 0
  v_mfma_f32_16x16x16_bf16 v[152:155], v[122:123], v[226:227], 0
  v_mfma_f32_16x16x16_bf16 v[136:139], v[120:121], v[226:227], 0
  v_mfma_f32_16x16x16_bf16 v[156:159], v[124:125], v[228:229], 0
  v_mfma_f32_16x16x16_bf16 v[140:143], v[122:123], v[228:229], 0
  v_pk_fma_f32 v[176:177], v[48:49], v[68:69], v[176:177] op_sel_hi:[0,1,1] neg_lo:[1,0,0] neg_hi:[1,0,0]
  v_pk_fma_f32 v[178:179], v[48:49], v[70:71], v[178:179] op_sel_hi:[0,1,1] neg_lo:[1,0,0] neg_hi:[1,0,0]
  v_pk_fma_f32 v[180:181], v[48:49], v[68:69], v[180:181] op_sel:[1,0,0] neg_lo:[1,0,0] neg_hi:[1,0,0]
  v_pk_fma_f32 v[182:183], v[48:49], v[70:71], v[182:183] op_sel:[1,0,0] neg_lo:[1,0,0] neg_hi:[1,0,0]
  v_pk_mul_f32 v[176:177], v[52:53], v[176:177] op_sel_hi:[0,1]
  v_pk_mul_f32 v[178:179], v[52:53], v[178:179] op_sel_hi:[0,1]
  v_pk_mul_f32 v[180:181], v[52:53], v[180:181] op_sel:[1,0]
  v_pk_mul_f32 v[182:183], v[52:53], v[182:183] op_sel:[1,0]
  v_pk_mul_f32 v[28:29], v[176:177], v[176:177]
  v_pk_mul_f32 v[30:31], v[178:179], v[178:179]
  v_pk_mul_f32 v[32:33], v[180:181], v[180:181]
  v_pk_mul_f32 v[34:35], v[182:183], v[182:183]
  v_pk_fma_f32 v[192:193], v[48:49], v[72:73], v[192:193] op_sel_hi:[0,1,1] neg_lo:[1,0,0] neg_hi:[1,0,0]
  v_pk_fma_f32 v[194:195], v[48:49], v[74:75], v[194:195] op_sel_hi:[0,1,1] neg_lo:[1,0,0] neg_hi:[1,0,0]
  v_pk_fma_f32 v[196:197], v[48:49], v[72:73], v[196:197] op_sel:[1,0,0] neg_lo:[1,0,0] neg_hi:[1,0,0]
  v_pk_fma_f32 v[198:199], v[48:49], v[74:75], v[198:199] op_sel:[1,0,0] neg_lo:[1,0,0] neg_hi:[1,0,0]
  v_pk_fma_f32 v[28:29], v[28:29], v[12:13], s[64:65] op_sel_hi:[1,0,0]
  v_pk_fma_f32 v[30:31], v[30:31], v[12:13], s[64:65] op_sel_hi:[1,0,0]
  v_pk_fma_f32 v[32:33], v[32:33], v[12:13], s[64:65] op_sel_hi:[1,0,0]
  v_pk_fma_f32 v[34:35], v[34:35], v[12:13], s[64:65] op_sel_hi:[1,0,0]
  v_pk_mul_f32 v[192:193], v[52:53], v[192:193] op_sel_hi:[0,1]
  v_pk_mul_f32 v[194:195], v[52:53], v[194:195] op_sel_hi:[0,1]
  v_pk_mul_f32 v[196:197], v[52:53], v[196:197] op_sel:[1,0]
  v_pk_mul_f32 v[198:199], v[52:53], v[198:199] op_sel:[1,0]
  v_pk_mul_f32 v[28:29], v[28:29], v[176:177]
  v_pk_mul_f32 v[30:31], v[30:31], v[178:179]
  v_pk_mul_f32 v[32:33], v[32:33], v[180:181]
  v_pk_mul_f32 v[34:35], v[34:35], v[182:183]
  v_exp_f32 v28, v28
  v_exp_f32 v29, v29
  v_exp_f32 v30, v30
  v_exp_f32 v31, v31
  v_exp_f32 v32, v32
  v_exp_f32 v33, v33
  v_exp_f32 v34, v34
  v_exp_f32 v35, v35
  v_pk_mul_f32 v[192:193], v[176:177], v[192:193]
  v_pk_mul_f32 v[194:195], v[178:179], v[194:195]
  v_pk_mul_f32 v[196:197], v[180:181], v[196:197]
  v_pk_mul_f32 v[198:199], v[182:183], v[198:199]
  v_pk_add_f32 v[28:29], v[28:29], 1.0 op_sel_hi:[1,0]
  v_pk_add_f32 v[30:31], v[30:31], 1.0 op_sel_hi:[1,0]
  v_pk_add_f32 v[32:33], v[32:33], 1.0 op_sel_hi:[1,0]
  v_pk_add_f32 v[34:35], v[34:35], 1.0 op_sel_hi:[1,0]
  v_rcp_f32 v28, v28
  v_rcp_f32 v29, v29
  v_rcp_f32 v30, v30
  v_rcp_f32 v31, v31
  v_rcp_f32 v32, v32
  v_rcp_f32 v33, v33
  v_rcp_f32 v34, v34
  v_rcp_f32 v35, v35
  s_nop 0
  v_pk_mul_f32 v[192:193], v[28:29], v[192:193]
  v_pk_mul_f32 v[194:195], v[30:31], v[194:195]
  v_pk_mul_f32 v[196:197], v[32:33], v[196:197]
  v_pk_mul_f32 v[198:199], v[34:35], v[198:199]
  v_cvt_pk_bf16_f32 v244, v192, v193
  v_cvt_pk_bf16_f32 v245, v194, v195
  v_cvt_pk_bf16_f32 v246, v196, v197
  v_cvt_pk_bf16_f32 v247, v198, v199
  v_mov_b32 v28, 0xf149f2ca
  v_cndmask_b32 v76, v144, v145, s[28:29]
  v_cndmask_b32 v77, v146, v147, s[28:29]
  v_cndmask_b32 v80, v148, v149, s[28:29]
  v_cndmask_b32 v81, v150, v151, s[28:29]
  v_cndmask_b32 v84, v152, v153, s[28:29]
  v_cndmask_b32 v85, v154, v155, s[28:29]
  v_cndmask_b32 v88, v156, v157, s[28:29]
  v_cndmask_b32 v89, v158, v159, s[28:29]
  v_cndmask_b32 v78, v128, v129, s[28:29]
  v_cndmask_b32 v79, v130, v131, s[28:29]
  v_cndmask_b32 v82, v132, v133, s[28:29]
  v_cndmask_b32 v83, v134, v135, s[28:29]
  v_cndmask_b32 v86, v136, v137, s[28:29]
  v_cndmask_b32 v87, v138, v139, s[28:29]
  v_cndmask_b32 v90, v140, v141, s[28:29]
  v_cndmask_b32 v91, v142, v143, s[28:29]
  v_cndmask_b32 v76, v78, v76, s[30:31]
  v_cndmask_b32 v77, v79, v77, s[36:37]
  v_cndmask_b32 v80, v82, v80, s[30:31]
  v_cndmask_b32 v81, v83, v81, s[36:37]
  v_cndmask_b32 v84, v86, v84, s[30:31]
  v_cndmask_b32 v85, v87, v85, s[36:37]
  v_cndmask_b32 v88, v90, v88, s[30:31]
  v_cndmask_b32 v89, v91, v89, s[36:37]
  v_max_f32 v20, v76, v77
  v_max_f32 v21, v80, v81
  v_max_f32 v22, v84, v85
  v_max_f32 v23, v88, v89
  v_mov_b32 v24, v20
  v_mov_b32 v25, v21
  v_mov_b32 v26, v22
  v_mov_b32 v27, v23
  v_permlane16_swap_b32 v20, v24
  v_permlane16_swap_b32 v21, v25
  v_permlane16_swap_b32 v22, v26
  v_permlane16_swap_b32 v23, v27
  v_max_f32 v20, v20, v24
  v_max_f32 v21, v21, v25
  v_max_f32 v22, v22, v26
  v_max_f32 v23, v23, v27
  v_mov_b32 v24, v20
  v_mov_b32 v25, v21
  v_mov_b32 v26, v22
  v_mov_b32 v27, v23
  v_permlane32_swap_b32 v20, v24
  v_permlane32_swap_b32 v21, v25
  v_permlane32_swap_b32 v22, v26
  v_permlane32_swap_b32 v23, v27
  v_max_f32 v20, v20, v24
  v_max_f32 v21, v21, v25
  v_max_f32 v22, v22, v26
  v_max_f32 v23, v23, v27
  v_sub_f32 v76, v76, v20
  v_sub_f32 v77, v77, v20
  v_sub_f32 v80, v80, v21
  v_sub_f32 v81, v81, v21
  v_sub_f32 v84, v84, v22
  v_sub_f32 v85, v85, v22
  v_sub_f32 v88, v88, v23
  v_sub_f32 v89, v89, v23
  v_exp_f32 v76, v76
  v_exp_f32 v77, v77
  v_exp_f32 v80, v80
  v_exp_f32 v81, v81
  v_exp_f32 v84, v84
  v_exp_f32 v85, v85
  v_exp_f32 v88, v88
  v_exp_f32 v89, v89
  v_cvt_pk_bf16_f32 v78, v76, v76
  v_cvt_pk_bf16_f32 v79, v77, v77
  v_cvt_pk_bf16_f32 v82, v80, v80
  v_cvt_pk_bf16_f32 v83, v81, v81
  v_cvt_pk_bf16_f32 v86, v84, v84
  v_cvt_pk_bf16_f32 v87, v85, v85
  v_cvt_pk_bf16_f32 v90, v88, v88
  v_cvt_pk_bf16_f32 v91, v89, v89
  v_and_b32 v160, v78, v232
  v_and_b32 v161, v79, v233
  v_and_b32 v162, v78, v234
  v_and_b32 v163, v79, v235
  v_and_b32 v164, v82, v232
  v_and_b32 v165, v83, v233
  v_and_b32 v166, v82, v234
  v_and_b32 v167, v83, v235
  v_and_b32 v168, v86, v232
  v_and_b32 v169, v87, v233
  v_and_b32 v170, v86, v234
  v_and_b32 v171, v87, v235
  v_and_b32 v172, v90, v232
  v_and_b32 v173, v91, v233
  v_and_b32 v174, v90, v234
  v_and_b32 v175, v91, v235
  s_nop 1
  v_mfma_f32_16x16x32_bf16 v[144:147], v[16:19], v[160:163], 0
  v_mfma_f32_16x16x32_bf16 v[148:151], v[16:19], v[164:167], 0
  v_mfma_f32_16x16x32_bf16 v[152:155], v[16:19], v[168:171], 0
  v_mfma_f32_16x16x32_bf16 v[156:159], v[16:19], v[172:175], 0
  v_mfma_f32_16x16x32_bf16 v[128:131], v[212:215], v[160:163], 0
  v_mfma_f32_16x16x32_bf16 v[132:135], v[214:217], v[164:167], 0
  v_mfma_f32_16x16x32_bf16 v[136:139], v[216:219], v[168:171], 0
  v_mfma_f32_16x16x32_bf16 v[140:143], v[218:221], v[172:175], 0
  v_pk_fma_f32 v[184:185], v[50:51], v[68:69], v[184:185] op_sel_hi:[0,1,1] neg_lo:[1,0,0] neg_hi:[1,0,0]
  v_pk_fma_f32 v[186:187], v[50:51], v[70:71], v[186:187] op_sel_hi:[0,1,1] neg_lo:[1,0,0] neg_hi:[1,0,0]
  v_pk_fma_f32 v[188:189], v[50:51], v[68:69], v[188:189] op_sel:[1,0,0] neg_lo:[1,0,0] neg_hi:[1,0,0]
  v_pk_fma_f32 v[190:191], v[50:51], v[70:71], v[190:191] op_sel:[1,0,0] neg_lo:[1,0,0] neg_hi:[1,0,0]
  v_pk_mul_f32 v[184:185], v[54:55], v[184:185] op_sel_hi:[0,1]
  v_pk_mul_f32 v[186:187], v[54:55], v[186:187] op_sel_hi:[0,1]
  v_pk_mul_f32 v[188:189], v[54:55], v[188:189] op_sel:[1,0]
  v_pk_mul_f32 v[190:191], v[54:55], v[190:191] op_sel:[1,0]
  v_pk_mul_f32 v[28:29], v[184:185], v[184:185]
  v_pk_mul_f32 v[30:31], v[186:187], v[186:187]
  v_pk_mul_f32 v[32:33], v[188:189], v[188:189]
  v_pk_mul_f32 v[34:35], v[190:191], v[190:191]
  v_pk_fma_f32 v[200:201], v[50:51], v[72:73], v[200:201] op_sel_hi:[0,1,1] neg_lo:[1,0,0] neg_hi:[1,0,0]
  v_pk_fma_f32 v[202:203], v[50:51], v[74:75], v[202:203] op_sel_hi:[0,1,1] neg_lo:[1,0,0] neg_hi:[1,0,0]
  v_pk_fma_f32 v[204:205], v[50:51], v[72:73], v[204:205] op_sel:[1,0,0] neg_lo:[1,0,0] neg_hi:[1,0,0]
  v_pk_fma_f32 v[206:207], v[50:51], v[74:75], v[206:207] op_sel:[1,0,0] neg_lo:[1,0,0] neg_hi:[1,0,0]
  v_pk_fma_f32 v[28:29], v[28:29], v[12:13], s[64:65] op_sel_hi:[1,0,0]
  v_pk_fma_f32 v[30:31], v[30:31], v[12:13], s[64:65] op_sel_hi:[1,0,0]
  v_pk_fma_f32 v[32:33], v[32:33], v[12:13], s[64:65] op_sel_hi:[1,0,0]
  v_pk_fma_f32 v[34:35], v[34:35], v[12:13], s[64:65] op_sel_hi:[1,0,0]
  v_pk_mul_f32 v[200:201], v[54:55], v[200:201] op_sel_hi:[0,1]
  v_pk_mul_f32 v[202:203], v[54:55], v[202:203] op_sel_hi:[0,1]
  v_pk_mul_f32 v[204:205], v[54:55], v[204:205] op_sel:[1,0]
  v_pk_mul_f32 v[206:207], v[54:55], v[206:207] op_sel:[1,0]
  v_pk_mul_f32 v[28:29], v[28:29], v[184:185]
  v_pk_mul_f32 v[30:31], v[30:31], v[186:187]
  v_pk_mul_f32 v[32:33], v[32:33], v[188:189]
  v_pk_mul_f32 v[34:35], v[34:35], v[190:191]
  v_exp_f32 v28, v28
  v_exp_f32 v29, v29
  v_exp_f32 v30, v30
  v_exp_f32 v31, v31
  v_exp_f32 v32, v32
  v_exp_f32 v33, v33
  v_exp_f32 v34, v34
  v_exp_f32 v35, v35
  v_pk_mul_f32 v[200:201], v[184:185], v[200:201]
  v_pk_mul_f32 v[202:203], v[186:187], v[202:203]
  v_pk_mul_f32 v[204:205], v[188:189], v[204:205]
  v_pk_mul_f32 v[206:207], v[190:191], v[206:207]
  v_pk_add_f32 v[28:29], v[28:29], 1.0 op_sel_hi:[1,0]
  v_pk_add_f32 v[30:31], v[30:31], 1.0 op_sel_hi:[1,0]
  v_pk_add_f32 v[32:33], v[32:33], 1.0 op_sel_hi:[1,0]
  v_pk_add_f32 v[34:35], v[34:35], 1.0 op_sel_hi:[1,0]
  v_rcp_f32 v28, v28
  v_rcp_f32 v29, v29
  v_rcp_f32 v30, v30
  v_rcp_f32 v31, v31
  v_rcp_f32 v32, v32
  v_rcp_f32 v33, v33
  v_rcp_f32 v34, v34
  v_rcp_f32 v35, v35
  s_nop 0
  v_pk_mul_f32 v[200:201], v[28:29], v[200:201]
  v_pk_mul_f32 v[202:203], v[30:31], v[202:203]
  v_pk_mul_f32 v[204:205], v[32:33], v[204:205]
  v_pk_mul_f32 v[206:207], v[34:35], v[206:207]
  v_cvt_pk_bf16_f32 v248, v200, v201
  v_cvt_pk_bf16_f32 v249, v202, v203
  v_cvt_pk_bf16_f32 v250, v204, v205
  v_cvt_pk_bf16_f32 v251, v206, v207
  s_nop 1
  v_permlane16_swap_b32 v244, v246
  v_permlane16_swap_b32 v245, v247
  v_permlane16_swap_b32 v248, v250
  v_permlane16_swap_b32 v249, v251
  s_mov_b32 s63, 147456
  buffer_store_dwordx4 v[244:247], v14, s[32:35], 0 offen sc1
  buffer_store_dwordx4 v[248:251], v14, s[32:35], s63 offen sc1
  v_rcp_f32 v20, v144
  v_rcp_f32 v21, v148
  v_rcp_f32 v22, v152
  v_rcp_f32 v23, v156
  s_nop 1
  v_mul_f32 v128, v20, v128
  v_mul_f32 v129, v20, v129
  v_mul_f32 v130, v20, v130
  v_mul_f32 v131, v20, v131
  v_mul_f32 v132, v21, v132
  v_mul_f32 v133, v21, v133
  v_mul_f32 v134, v21, v134
  v_mul_f32 v135, v21, v135
  v_mul_f32 v136, v22, v136
  v_mul_f32 v137, v22, v137
  v_mul_f32 v138, v22, v138
  v_mul_f32 v139, v22, v139
  v_mul_f32 v140, v23, v140
  v_mul_f32 v141, v23, v141
  v_mul_f32 v142, v23, v142
  v_mul_f32 v143, v23, v143
  v_cvt_pk_bf16_f32 v116, v128, v129
  v_cvt_pk_bf16_f32 v117, v130, v131
  v_cvt_pk_bf16_f32 v118, v132, v133
  v_cvt_pk_bf16_f32 v119, v134, v135
  v_cvt_pk_bf16_f32 v120, v136, v137
  v_cvt_pk_bf16_f32 v121, v138, v139
  v_cvt_pk_bf16_f32 v122, v140, v141
  v_cvt_pk_bf16_f32 v123, v142, v143
  s_nop 1
  v_permlane16_swap_b32 v116, v118
  v_permlane16_swap_b32 v117, v119
  v_permlane16_swap_b32 v120, v122
  v_permlane16_swap_b32 v121, v123
  s_mov_b32 s63, 147456
  buffer_store_dwordx4 v[116:119], v13, s[32:35], 0 offen sc1
  buffer_store_dwordx4 v[120:123], v13, s[32:35], s63 offen sc1
  s_branch P1_done
P1_Y0:
  s_mul_i32 s60, s42, 320
  s_add_u32 s60, s60, 1024
  s_and_b32 s61, s42, 1
  s_lshl_b32 s61, s61, 6
  s_add_u32 s49, s60, s61
  s_add_u32 s50, s49, 128
  s_cmp_eq_u32 s61, 0
  s_cselect_b32 s61, 256, 0
  s_add_u32 s51, s60, s61
  v_lshrrev_b32 v20, 3, v0
  s_lshl_b32 s60, s44, 3
  v_add_u32 v20, s60, v20
  v_mul_u32_u24 v20, 3584, v20
  v_bfe_u32 v21, v0, 4, 1
  s_and_b32 s60, s44, 1
  s_lshl_b32 s60, s60, 1
  v_or_b32 v21, s60, v21
  v_bfe_u32 v22, v0, 1, 2
  v_xor_b32 v21, v21, v22
  v_lshl_add_u32 v20, v21, 5, v20
  v_and_b32 v22, 1, v0
  v_lshl_add_u32 v1, v22, 4, v20
  v_add_u32 v2, s50, v1
  v_add_u32 v1, s49, v1
  s_mul_i32 s47, s47, 114688
  s_mov_b32 s24, s8
  s_and_b32 s25, s9, 0xffff
  s_mov_b32 s26, 0x1c0000
  s_mov_b32 s27, 0x20000
  s_mov_b32 s28, s10
  s_and_b32 s29, s11, 0xffff
  s_mov_b32 s30, 0x1c0000
  s_mov_b32 s31, 0x20000
  s_add_u32 m0, s58, 0
  s_nop 0
  buffer_load_dwordx4 v1, s[24:27], s47 offen lds
  s_add_u32 m0, s58, 4096
  s_nop 0
  buffer_load_dwordx4 v1, s[28:31], s47 offen lds
  s_add_u32 m0, s58, 8192
  s_nop 0
  buffer_load_dwordx4 v2, s[24:27], s47 offen lds
  s_add_u32 s47, s47, 114688
  s_cmp_eq_u32 s47, 1835008
  s_cselect_b32 s47, 0, s47
  s_add_u32 m0, s58, 20480
  s_nop 0
  buffer_load_dwordx4 v1, s[24:27], s47 offen lds
  s_add_u32 m0, s58, 24576
  s_nop 0
  buffer_load_dwordx4 v1, s[28:31], s47 offen lds
  s_add_u32 m0, s58, 28672
  s_nop 0
  buffer_load_dwordx4 v2, s[24:27], s47 offen lds
  s_add_u32 s47, s47, 114688
  s_cmp_eq_u32 s47, 1835008
  s_cselect_b32 s47, 0, s47
  s_mov_b32 s32, s12
  s_and_b32 s33, s13, 0xffff
  s_mov_b32 s34, 0x970000
  s_mov_b32 s35, 0x20000
  s_load_dwordx2 s[70:71], s[0:1], 16
  s_load_dwordx2 s[72:73], s[0:1], 48
  s_load_dwordx2 s[14:15], s[0:1], 56
  s_and_b32 s60, s2, 7
  s_lshr_b32 s61, s2, 3
  s_lshr_b32 s63, s61, 3
  s_lshl_b32 s69, s60, 2
  s_add_u32 s69, s69, s63
  s_and_b32 s74, s61, 7
  s_mov_b32 s54, 0
  s_mov_b32 s56, 0
  s_lshr_b32 s60, s40, 3
  s_lshl_b32 s60, 1, s60
  s_cmp_eq_u32 s45, 0
  s_cselect_b32 s57, s60, 0
  s_mov_b32 s59, 99
  s_cmp_eq_u32 s43, 0
  s_cselect_b32 s60, 0x110, 0
  s_cselect_b32 s59, 2, 99
  s_or_b32 s57, s57, s60
  v_mov_b32 v43, 9830400
  v_mov_b32 v47, 9830400
  v_mov_b32 v40, 0
  s_cmp_eq_u32 s43, 0
  s_cbranch_scc0 L_noep_3030
  v_mov_b32 v35, 9838592
  buffer_load_dword v40, v35, s[32:35], 0 offen sc1
L_noep_3030:
  v_lshrrev_b32 v20, 3, v0
  v_lshrrev_b32 v21, 4, v0
  v_and_b32 v25, 15, v0
  v_lshrrev_b32 v26, 1, v25
  v_xor_b32 v26, v26, v21
  v_lshlrev_b32 v26, 4, v26
  v_lshl_add_u32 v26, v25, 7, v26
  v_add_u32 v6, 81920, v26
  v_xor_b32 v7, 64, v6
  v_bfe_u32 v27, v0, 2, 2
  v_lshl_add_u32 v27, v21, 3, v27
  v_and_b32 v28, 3, v20
  v_xor_b32 v28, s44, v28
  v_lshlrev_b32 v28, 5, v28
  v_lshl_add_u32 v28, v27, 7, v28
  v_and_b32 v29, 3, v0
  v_lshl_add_u32 v10, v29, 3, v28
  v_add_u32 v11, 61440, v10
  v_and_b32 v30, 1, v21
  v_and_b32 v31, 2, v29
  v_or_b32 v30, v30, v31
  v_xor_b32 v30, s44, v30
  v_lshlrev_b32 v30, 4, v30
  v_lshl_add_u32 v30, v27, 6, v30
  v_lshl_add_u32 v30, v31, 10, v30
  v_and_b32 v31, 1, v29
  v_lshl_add_u32 v30, v31, 3, v30
  v_add_u32 v12, 16384, v30
  v_add_u32 v13, 61440, v12
  v_mov_b32 v16, 0x3f803f80
  v_mov_b32 v17, 0x3f803f80
  v_mov_b32 v18, 0x3f803f80
  v_mov_b32 v19, 0x3f803f80
  s_mul_i32 s60, s41, 20480
  s_mul_i32 s61, s40, 1280
  s_add_u32 s60, s60, s61
  s_lshl_b32 s61, s44, 6
  s_add_u32 s60, s60, s61
  s_add_u32 s60, s60, 9453568
  v_lshlrev_b32 v42, 4, v21
  v_add_u32 v42, s60, v42
  v_cmp_eq_u32 vcc, 0, v25
  v_mov_b32 v31, 0x7fffff00
  s_nop 0
  v_cndmask_b32 v42, v31, v42, vcc
  v_mov_b32 v128, 0
  v_mov_b32 v129, 0
  v_mov_b32 v130, 0
  v_mov_b32 v131, 0
  v_mov_b32 v132, 0
  v_mov_b32 v133, 0
  v_mov_b32 v134, 0
  v_mov_b32 v135, 0
  v_mov_b32 v136, 0
  v_mov_b32 v137, 0
  v_mov_b32 v138, 0
  v_mov_b32 v139, 0
  v_mov_b32 v140, 0
  v_mov_b32 v141, 0
  v_mov_b32 v142, 0
  v_mov_b32 v143, 0
  v_mov_b32 v144, 0
  v_mov_b32 v145, 0
  v_mov_b32 v146, 0
  v_mov_b32 v147, 0
  v_mov_b32 v148, 0
  v_mov_b32 v149, 0
  v_mov_b32 v150, 0
  v_mov_b32 v151, 0
  v_mov_b32 v152, 0
  v_mov_b32 v153, 0
  v_mov_b32 v154, 0
  v_mov_b32 v155, 0
  v_mov_b32 v156, 0
  v_mov_b32 v157, 0
  v_mov_b32 v158, 0
  v_mov_b32 v159, 0
  v_mov_b32 v160, 0
  v_mov_b32 v161, 0
  v_mov_b32 v162, 0
  v_mov_b32 v163, 0
  v_mov_b32 v164, 0
  v_mov_b32 v165, 0
  v_mov_b32 v166, 0
  v_mov_b32 v167, 0
  v_mov_b32 v168, 0
  v_mov_b32 v169, 0
  v_mov_b32 v170, 0
  v_mov_b32 v171, 0
  v_mov_b32 v172, 0
  v_mov_b32 v173, 0
  v_mov_b32 v174, 0
  v_mov_b32 v175, 0
  v_mov_b32 v176, 0
  v_mov_b32 v177, 0
  v_mov_b32 v178, 0
  v_mov_b32 v179, 0
  v_mov_b32 v180, 0
  v_mov_b32 v181, 0
  v_mov_b32 v182, 0
  v_mov_b32 v183, 0
  v_mov_b32 v184, 0
  v_mov_b32 v185, 0
  v_mov_b32 v186, 0
  v_mov_b32 v187, 0
  v_mov_b32 v188, 0
  v_mov_b32 v189, 0
  v_mov_b32 v190, 0
  v_mov_b32 v191, 0
  v_mov_b32 v192, 0
  v_mov_b32 v193, 0
  v_mov_b32 v194, 0
  v_mov_b32 v195, 0
  v_mov_b32 v196, 0
  v_mov_b32 v197, 0
  v_mov_b32 v198, 0
  v_mov_b32 v199, 0
  v_mov_b32 v200, 0
  v_mov_b32 v201, 0
  v_mov_b32 v202, 0
  v_mov_b32 v203, 0
  v_mov_b32 v204, 0
  v_mov_b32 v205, 0
  v_mov_b32 v206, 0
  v_mov_b32 v207, 0
  v_lshlrev_b32 v24, 4, v0
  v_add_u32 v24, 149888, v24
  v_and_b32 v25, 48, v0
  s_lshl_b32 s60, s43, 6
  s_add_u32 s60, s60, 148608
  v_add_u32 v25, s60, v25
  v_and_b32 v26, 15, v0
  v_cmp_eq_u32 vcc, 0, v26
  s_lshl_b32 s61, s43, 6
  v_add_u32 v27, s61, v0
  v_cndmask_b32 v36, v24, v25, vcc
  s_cmp_lt_u32 s43, 4
  s_cselect_b64 s[64:65], vcc, 0
  v_add_u32 v25, 1024, v25
  v_cndmask_b32 v37, v24, v25, s[64:65]
  v_cmp_gt_u32 vcc, 144, v27
  v_lshlrev_b32 v27, 2, v27
  v_add_u32 v27, 147456, v27
  s_nop 0
  v_cndmask_b32 v38, v24, v27, vcc
  s_lshl_b32 s68, s45, 12
  s_lshl_b32 s60, s44, 10
  s_add_u32 s68, s68, s60
  v_lshrrev_b32 v24, 3, v0
  s_lshl_b32 s60, s44, 3
  v_add_u32 v24, s60, v24
  v_lshlrev_b32 v24, 10, v24
  v_bfe_u32 v25, v0, 4, 1
  s_and_b32 s60, s44, 1
  s_lshl_b32 s60, s60, 1
  v_or_b32 v25, s60, v25
  v_bfe_u32 v26, v0, 1, 2
  v_xor_b32 v25, v25, v26
  v_lshl_add_u32 v24, v25, 5, v24
  v_and_b32 v26, 1, v0
  v_lshl_add_u32 v24, v26, 4, v24
  s_lshl_b32 s60, s74, 7
  v_add_u32 v41, s60, v24
  s_add_u32 m0, s53, 0
  s_nop 0
  buffer_load_dwordx4 v4, s[16:19], s52 offen lds
  s_add_u32 m0, s53, 8192
  s_nop 0
  buffer_load_dwordx4 v5, s[16:19], s52 offen lds
  s_add_u32 s60, s52, 128
  s_and_b32 s60, s60, 0x380
  s_or_b32 s52, s60, s46
  s_add_u32 s53, s53, 0x4000
  s_cmp_eq_u32 s53, s75
  s_cselect_b32 s53, s48, s53
  s_waitcnt vmcnt(10)
  v_lshlrev_b32 v20, 16, v212
  v_and_b32 v21, 0xffff0000, v212
  v_lshlrev_b32 v22, 16, v213
  v_and_b32 v23, 0xffff0000, v213
  v_lshlrev_b32 v24, 16, v214
  v_and_b32 v25, 0xffff0000, v214
  v_lshlrev_b32 v26, 16, v215
  v_and_b32 v27, 0xffff0000, v215
  v_add_f32 v28, v20, v21
  v_add_f32 v29, v22, v23
  v_add_f32 v30, v24, v25
  v_add_f32 v31, v26, v27
  v_add_f32 v28, v28, v29
  v_add_f32 v30, v30, v31
  v_add_f32 v28, v28, v30
  s_nop 1
  v_add_f32_dpp v28, v28, v28 row_ror:8 row_mask:0xf bank_mask:0xf
  s_nop 1
  v_add_f32_dpp v28, v28, v28 row_ror:4 row_mask:0xf bank_mask:0xf
  s_nop 1
  v_add_f32_dpp v28, v28, v28 row_ror:2 row_mask:0xf bank_mask:0xf
  s_nop 1
  v_add_f32_dpp v28, v28, v28 row_ror:1 row_mask:0xf bank_mask:0xf
  s_nop 1
  v_mov_b32 v29, v28
  s_nop 1
  v_permlane16_swap_b32 v28, v29
  s_nop 1
  v_add_f32 v28, v28, v29
  s_nop 0
  v_mov_b32 v29, v28
  s_nop 1
  v_permlane32_swap_b32 v28, v29
  s_nop 1
  v_add_f32 v28, v28, v29
  s_nop 0
  v_mul_f32 v28, 0x3b000000, v28
  v_sub_f32 v20, v20, v28
  v_sub_f32 v21, v21, v28
  v_sub_f32 v22, v22, v28
  v_sub_f32 v23, v23, v28
  v_sub_f32 v24, v24, v28
  v_sub_f32 v25, v25, v28
  v_sub_f32 v26, v26, v28
  v_sub_f32 v27, v27, v28
  v_mul_f32 v29, v20, v20
  v_mul_f32 v30, v21, v21
  v_fmac_f32 v29, v22, v22
  v_fmac_f32 v30, v23, v23
  v_fmac_f32 v29, v24, v24
  v_fmac_f32 v30, v25, v25
  v_fmac_f32 v29, v26, v26
  v_fmac_f32 v30, v27, v27
  v_add_f32 v29, v29, v30
  s_nop 1
  v_add_f32_dpp v29, v29, v29 row_ror:8 row_mask:0xf bank_mask:0xf
  s_nop 1
  v_add_f32_dpp v29, v29, v29 row_ror:4 row_mask:0xf bank_mask:0xf
  s_nop 1
  v_add_f32_dpp v29, v29, v29 row_ror:2 row_mask:0xf bank_mask:0xf
  s_nop 1
  v_add_f32_dpp v29, v29, v29 row_ror:1 row_mask:0xf bank_mask:0xf
  s_nop 1
  v_mov_b32 v30, v29
  s_nop 1
  v_permlane16_swap_b32 v29, v30
  s_nop 1
  v_add_f32 v29, v29, v30
  s_nop 0
  v_mov_b32 v30, v29
  s_nop 1
  v_permlane32_swap_b32 v29, v30
  s_nop 1
  v_add_f32 v29, v29, v30
  s_nop 0
  v_mov_b32 v30, 0x3727c5ac
  v_fmac_f32 v30, 0x3b000000, v29
  v_rsq_f32 v29, v30
  s_lshl_b32 s60, s41, 3
  s_add_u32 s60, s60, s43
  s_lshl_b32 s61, s40, 7
  s_add_u32 s60, s60, s61
  s_lshl_b32 s60, s60, 3
  s_add_u32 s60, s60, 9437184
  v_mov_b32 v30, 0x7fffff00
  v_writelane_b32 v30, s60, 0
  s_nop 1
  buffer_store_dwordx2 v[28:29], v30, s[32:35], 0 offen sc1
  s_waitcnt vmcnt(3)
  s_barrier
  v_add_u32 v14, s54, v6
  ds_read_b64_tr_b16 v[48:49], v10 offset:0
  ds_read_b64_tr_b16 v[50:51], v10 offset:512
  ds_read_b64_tr_b16 v[52:53], v10 offset:4096
  ds_read_b64_tr_b16 v[54:55], v10 offset:4608
  ds_read_b128 v[88:91], v14 offset:0
  ds_read_b64_tr_b16 v[56:57], v10 offset:8192
  ds_read_b64_tr_b16 v[58:59], v10 offset:8704
  ds_read_b128 v[92:95], v14 offset:2048
  ds_read_b64_tr_b16 v[60:61], v10 offset:12288
  ds_read_b64_tr_b16 v[62:63], v10 offset:12800
  ds_read_b128 v[96:99], v14 offset:4096
  ds_read_b64_tr_b16 v[64:65], v12 offset:0
  ds_read_b64_tr_b16 v[66:67], v12 offset:256
  ds_read_b128 v[100:103], v14 offset:6144
  s_add_u32 m0, s58, 40960
  s_nop 0
  buffer_load_dwordx4 v1, s[24:27], s47 offen lds
  s_add_u32 m0, s58, 45056
  s_nop 0
  buffer_load_dwordx4 v1, s[28:31], s47 offen lds
  s_add_u32 m0, s58, 49152
  s_nop 0
  buffer_load_dwordx4 v2, s[24:27], s47 offen lds
  s_add_u32 s47, s47, 114688
  s_cmp_eq_u32 s47, 1835008
  s_cselect_b32 s47, 0, s47
  s_add_u32 m0, s58, 61440
  s_nop 0
  buffer_load_dwordx4 v1, s[24:27], s47 offen lds
  s_add_u32 m0, s58, 65536
  s_nop 0
  buffer_load_dwordx4 v1, s[28:31], s47 offen lds
  s_add_u32 m0, s58, 69632
  s_nop 0
  buffer_load_dwordx4 v2, s[24:27], s47 offen lds
  s_add_u32 s47, s47, 114688
  s_cmp_eq_u32 s47, 1835008
  s_cselect_b32 s47, 0, s47
  s_add_u32 m0, s53, 0
  s_nop 0
  buffer_load_dwordx4 v4, s[16:19], s52 offen lds
P1_Y0_loop:
  s_waitcnt vmcnt(8) lgkmcnt(0)
  s_barrier
  v_mfma_f32_16x16x32_bf16 v[128:131], v[48:51], v[88:91], v[128:131]
  v_add_u32 v14, s54, v7
  ds_read_b64_tr_b16 v[68:69], v10 offset:20480
  v_mfma_f32_16x16x32_bf16 v[144:147], v[52:55], v[88:91], v[144:147]
  ds_read_b64_tr_b16 v[70:71], v10 offset:20992
  v_mfma_f32_16x16x32_bf16 v[160:163], v[56:59], v[88:91], v[160:163]
  ds_read_b64_tr_b16 v[72:73], v10 offset:24576
  s_add_u32 m0, s58, 0
  v_mfma_f32_16x16x32_bf16 v[176:179], v[60:63], v[88:91], v[176:179]
  ds_read_b64_tr_b16 v[74:75], v10 offset:25088
  buffer_load_dwordx4 v1, s[24:27], s47 offen lds
  v_mfma_f32_16x16x32_bf16 v[192:195], v[64:67], v[88:91], v[192:195]
  ds_read_b128 v[108:111], v14 offset:0
  v_mfma_f32_16x16x32_bf16 v[132:135], v[48:51], v[92:95], v[132:135]
  ds_read_b64_tr_b16 v[76:77], v10 offset:28672
  v_mfma_f32_16x16x32_bf16 v[148:151], v[52:55], v[92:95], v[148:151]
  ds_read_b64_tr_b16 v[78:79], v10 offset:29184
  v_mfma_f32_16x16x32_bf16 v[164:167], v[56:59], v[92:95], v[164:167]
  ds_read_b128 v[112:115], v14 offset:2048
  s_add_u32 m0, s58, 4096
  v_mfma_f32_16x16x32_bf16 v[180:183], v[60:63], v[92:95], v[180:183]
  ds_read_b64_tr_b16 v[80:81], v10 offset:32768
  buffer_load_dwordx4 v1, s[28:31], s47 offen lds
  v_mfma_f32_16x16x32_bf16 v[196:199], v[64:67], v[92:95], v[196:199]
  ds_read_b64_tr_b16 v[82:83], v10 offset:33280
  v_mfma_f32_16x16x32_bf16 v[136:139], v[48:51], v[96:99], v[136:139]
  ds_read_b128 v[116:119], v14 offset:4096
  v_mfma_f32_16x16x32_bf16 v[152:155], v[52:55], v[96:99], v[152:155]
  ds_read_b64_tr_b16 v[84:85], v12 offset:20480
  v_mfma_f32_16x16x32_bf16 v[168:171], v[56:59], v[96:99], v[168:171]
  ds_read_b64_tr_b16 v[86:87], v12 offset:20736
  s_add_u32 m0, s58, 8192
  v_mfma_f32_16x16x32_bf16 v[184:187], v[60:63], v[96:99], v[184:187]
  ds_read_b128 v[120:123], v14 offset:6144
  buffer_load_dwordx4 v2, s[24:27], s47 offen lds
  v_mfma_f32_16x16x32_bf16 v[200:203], v[64:67], v[96:99], v[200:203]
  s_add_u32 s47, s47, 114688
  s_cmp_eq_u32 s47, 1835008
  s_cselect_b32 s47, 0, s47
  v_mfma_f32_16x16x32_bf16 v[140:143], v[48:51], v[100:103], v[140:143]
  v_mfma_f32_16x16x32_bf16 v[156:159], v[52:55], v[100:103], v[156:159]
  v_mfma_f32_16x16x32_bf16 v[172:175], v[56:59], v[100:103], v[172:175]
  s_add_u32 m0, s53, 8192
  v_mfma_f32_16x16x32_bf16 v[188:191], v[60:63], v[100:103], v[188:191]
  buffer_load_dwordx4 v5, s[16:19], s52 offen lds
  v_mfma_f32_16x16x32_bf16 v[204:207], v[64:67], v[100:103], v[204:207]
  s_add_u32 s60, s52, 128
  s_and_b32 s60, s60, 0x380
  s_or_b32 s52, s60, s46
  s_add_u32 s53, s53, 0x4000
  s_cmp_eq_u32 s53, s75
  s_cselect_b32 s53, s48, s53
  s_bitcmp1_b32 s57, 0
  s_cbranch_scc1 L_ev_3031
L_evback_3032:
  s_waitcnt vmcnt(8) lgkmcnt(0)
  s_barrier
  v_mfma_f32_16x16x32_bf16 v[128:131], v[68:71], v[108:111], v[128:131]
  s_add_u32 s54, s54, 0x4000
  s_cmp_eq_u32 s54, 0xc000
  s_cselect_b32 s54, 0, s54
  ds_read_b64_tr_b16 v[48:49], v10 offset:40960
  v_mfma_f32_16x16x32_bf16 v[144:147], v[72:75], v[108:111], v[144:147]
  v_add_u32 v14, s54, v6
  ds_read_b64_tr_b16 v[50:51], v10 offset:41472
  v_mfma_f32_16x16x32_bf16 v[160:163], v[76:79], v[108:111], v[160:163]
  ds_read_b64_tr_b16 v[52:53], v10 offset:45056
  s_add_u32 m0, s58, 20480
  v_mfma_f32_16x16x32_bf16 v[176:179], v[80:83], v[108:111], v[176:179]
  ds_read_b64_tr_b16 v[54:55], v10 offset:45568
  buffer_load_dwordx4 v1, s[24:27], s47 offen lds
  v_mfma_f32_16x16x32_bf16 v[192:195], v[84:87], v[108:111], v[192:195]
  ds_read_b128 v[88:91], v14 offset:0
  v_mfma_f32_16x16x32_bf16 v[132:135], v[68:71], v[112:115], v[132:135]
  ds_read_b64_tr_b16 v[56:57], v10 offset:49152
  v_mfma_f32_16x16x32_bf16 v[148:151], v[72:75], v[112:115], v[148:151]
  ds_read_b64_tr_b16 v[58:59], v10 offset:49664
  v_mfma_f32_16x16x32_bf16 v[164:167], v[76:79], v[112:115], v[164:167]
  ds_read_b128 v[92:95], v14 offset:2048
  s_add_u32 m0, s58, 24576
  v_mfma_f32_16x16x32_bf16 v[180:183], v[80:83], v[112:115], v[180:183]
  ds_read_b64_tr_b16 v[60:61], v10 offset:53248
  buffer_load_dwordx4 v1, s[28:31], s47 offen lds
  v_mfma_f32_16x16x32_bf16 v[196:199], v[84:87], v[112:115], v[196:199]
  ds_read_b64_tr_b16 v[62:63], v10 offset:53760
  v_mfma_f32_16x16x32_bf16 v[136:139], v[68:71], v[116:119], v[136:139]
  ds_read_b128 v[96:99], v14 offset:4096
  v_mfma_f32_16x16x32_bf16 v[152:155], v[72:75], v[116:119], v[152:155]
  ds_read_b64_tr_b16 v[64:65], v12 offset:40960
  v_mfma_f32_16x16x32_bf16 v[168:171], v[76:79], v[116:119], v[168:171]
  ds_read_b64_tr_b16 v[66:67], v12 offset:41216
  s_add_u32 m0, s58, 28672
  v_mfma_f32_16x16x32_bf16 v[184:187], v[80:83], v[116:119], v[184:187]
  ds_read_b128 v[100:103], v14 offset:6144
  buffer_load_dwordx4 v2, s[24:27], s47 offen lds
  v_mfma_f32_16x16x32_bf16 v[200:203], v[84:87], v[116:119], v[200:203]
  s_add_u32 s47, s47, 114688
  s_cmp_eq_u32 s47, 1835008
  s_cselect_b32 s47, 0, s47
  v_mfma_f32_16x16x32_bf16 v[140:143], v[68:71], v[120:123], v[140:143]
  v_mfma_f32_16x16x32_bf16 v[156:159], v[72:75], v[120:123], v[156:159]
  v_mfma_f32_16x16x32_bf16 v[172:175], v[76:79], v[120:123], v[172:175]
  s_add_u32 m0, s53, 0
  v_mfma_f32_16x16x32_bf16 v[188:191], v[80:83], v[120:123], v[188:191]
  buffer_load_dwordx4 v4, s[16:19], s52 offen lds
  v_mfma_f32_16x16x32_bf16 v[204:207], v[84:87], v[120:123], v[204:207]
  s_bitcmp1_b32 s57, 1
  s_cbranch_scc1 L_ev_4036
L_evback_4037:
  s_waitcnt vmcnt(8) lgkmcnt(0)
  s_barrier
  v_mfma_f32_16x16x32_bf16 v[128:131], v[48:51], v[88:91], v[128:131]
  v_add_u32 v14, s54, v7
  ds_read_b64_tr_b16 v[68:69], v11 offset:0
  v_mfma_f32_16x16x32_bf16 v[144:147], v[52:55], v[88:91], v[144:147]
  ds_read_b64_tr_b16 v[70:71], v11 offset:512
  v_mfma_f32_16x16x32_bf16 v[160:163], v[56:59], v[88:91], v[160:163]
  ds_read_b64_tr_b16 v[72:73], v11 offset:4096
  s_add_u32 m0, s58, 40960
  v_mfma_f32_16x16x32_bf16 v[176:179], v[60:63], v[88:91], v[176:179]
  ds_read_b64_tr_b16 v[74:75], v11 offset:4608
  buffer_load_dwordx4 v1, s[24:27], s47 offen lds
  v_mfma_f32_16x16x32_bf16 v[192:195], v[64:67], v[88:91], v[192:195]
  ds_read_b128 v[108:111], v14 offset:0
  v_mfma_f32_16x16x32_bf16 v[132:135], v[48:51], v[92:95], v[132:135]
  ds_read_b64_tr_b16 v[76:77], v11 offset:8192
  v_mfma_f32_16x16x32_bf16 v[148:151], v[52:55], v[92:95], v[148:151]
  ds_read_b64_tr_b16 v[78:79], v11 offset:8704
  v_mfma_f32_16x16x32_bf16 v[164:167], v[56:59], v[92:95], v[164:167]
  ds_read_b128 v[112:115], v14 offset:2048
  s_add_u32 m0, s58, 45056
  v_mfma_f32_16x16x32_bf16 v[180:183], v[60:63], v[92:95], v[180:183]
  ds_read_b64_tr_b16 v[80:81], v11 offset:12288
  buffer_load_dwordx4 v1, s[28:31], s47 offen lds
  v_mfma_f32_16x16x32_bf16 v[196:199], v[64:67], v[92:95], v[196:199]
  ds_read_b64_tr_b16 v[82:83], v11 offset:12800
  v_mfma_f32_16x16x32_bf16 v[136:139], v[48:51], v[96:99], v[136:139]
  ds_read_b128 v[116:119], v14 offset:4096
  v_mfma_f32_16x16x32_bf16 v[152:155], v[52:55], v[96:99], v[152:155]
  ds_read_b64_tr_b16 v[84:85], v13 offset:0
  v_mfma_f32_16x16x32_bf16 v[168:171], v[56:59], v[96:99], v[168:171]
  ds_read_b64_tr_b16 v[86:87], v13 offset:256
  s_add_u32 m0, s58, 49152
  v_mfma_f32_16x16x32_bf16 v[184:187], v[60:63], v[96:99], v[184:187]
  ds_read_b128 v[120:123], v14 offset:6144
  buffer_load_dwordx4 v2, s[24:27], s47 offen lds
  v_mfma_f32_16x16x32_bf16 v[200:203], v[64:67], v[96:99], v[200:203]
  s_add_u32 s47, s47, 114688
  s_cmp_eq_u32 s47, 1835008
  s_cselect_b32 s47, 0, s47
  v_mfma_f32_16x16x32_bf16 v[140:143], v[48:51], v[100:103], v[140:143]
  v_mfma_f32_16x16x32_bf16 v[156:159], v[52:55], v[100:103], v[156:159]
  v_mfma_f32_16x16x32_bf16 v[172:175], v[56:59], v[100:103], v[172:175]
  s_add_u32 m0, s53, 8192
  v_mfma_f32_16x16x32_bf16 v[188:191], v[60:63], v[100:103], v[188:191]
  buffer_load_dwordx4 v5, s[16:19], s52 offen lds
  v_mfma_f32_16x16x32_bf16 v[204:207], v[64:67], v[100:103], v[204:207]
  s_add_u32 s60, s52, 128
  s_and_b32 s60, s60, 0x380
  s_or_b32 s52, s60, s46
  s_add_u32 s53, s53, 0x4000
  s_cmp_eq_u32 s53, s75
  s_cselect_b32 s53, s48, s53
  s_waitcnt vmcnt(8) lgkmcnt(0)
  s_cmp_eq_u32 s56, s59
  s_cbranch_scc1 L_chk_5039
L_chkback_5040:
  s_barrier
  v_mfma_f32_16x16x32_bf16 v[128:131], v[68:71], v[108:111], v[128:131]
  s_add_u32 s54, s54, 0x4000
  s_cmp_eq_u32 s54, 0xc000
  s_cselect_b32 s54, 0, s54
  ds_read_b64_tr_b16 v[48:49], v10 offset:0
  v_mfma_f32_16x16x32_bf16 v[144:147], v[72:75], v[108:111], v[144:147]
  v_add_u32 v14, s54, v6
  ds_read_b64_tr_b16 v[50:51], v10 offset:512
  v_mfma_f32_16x16x32_bf16 v[160:163], v[76:79], v[108:111], v[160:163]
  ds_read_b64_tr_b16 v[52:53], v10 offset:4096
  s_add_u32 m0, s58, 61440
  v_mfma_f32_16x16x32_bf16 v[176:179], v[80:83], v[108:111], v[176:179]
  ds_read_b64_tr_b16 v[54:55], v10 offset:4608
  buffer_load_dwordx4 v1, s[24:27], s47 offen lds
  v_mfma_f32_16x16x32_bf16 v[192:195], v[84:87], v[108:111], v[192:195]
  ds_read_b128 v[88:91], v14 offset:0
  v_mfma_f32_16x16x32_bf16 v[132:135], v[68:71], v[112:115], v[132:135]
  ds_read_b64_tr_b16 v[56:57], v10 offset:8192
  v_mfma_f32_16x16x32_bf16 v[148:151], v[72:75], v[112:115], v[148:151]
  ds_read_b64_tr_b16 v[58:59], v10 offset:8704
  v_mfma_f32_16x16x32_bf16 v[164:167], v[76:79], v[112:115], v[164:167]
  ds_read_b128 v[92:95], v14 offset:2048
  s_add_u32 m0, s58, 65536
  v_mfma_f32_16x16x32_bf16 v[180:183], v[80:83], v[112:115], v[180:183]
  ds_read_b64_tr_b16 v[60:61], v10 offset:12288
  buffer_load_dwordx4 v1, s[28:31], s47 offen lds
  v_mfma_f32_16x16x32_bf16 v[196:199], v[84:87], v[112:115], v[196:199]
  ds_read_b64_tr_b16 v[62:63], v10 offset:12800
  v_mfma_f32_16x16x32_bf16 v[136:139], v[68:71], v[116:119], v[136:139]
  ds_read_b128 v[96:99], v14 offset:4096
  v_mfma_f32_16x16x32_bf16 v[152:155], v[72:75], v[116:119], v[152:155]
  ds_read_b64_tr_b16 v[64:65], v12 offset:0
  v_mfma_f32_16x16x32_bf16 v[168:171], v[76:79], v[116:119], v[168:171]
  ds_read_b64_tr_b16 v[66:67], v12 offset:256
  s_add_u32 m0, s58, 69632
  v_mfma_f32_16x16x32_bf16 v[184:187], v[80:83], v[116:119], v[184:187]
  ds_read_b128 v[100:103], v14 offset:6144
  buffer_load_dwordx4 v2, s[24:27], s47 offen lds
  v_mfma_f32_16x16x32_bf16 v[200:203], v[84:87], v[116:119], v[200:203]
  s_add_u32 s47, s47, 114688
  s_cmp_eq_u32 s47, 1835008
  s_cselect_b32 s47, 0, s47
  v_mfma_f32_16x16x32_bf16 v[140:143], v[68:71], v[120:123], v[140:143]
  v_mfma_f32_16x16x32_bf16 v[156:159], v[72:75], v[120:123], v[156:159]
  v_mfma_f32_16x16x32_bf16 v[172:175], v[76:79], v[120:123], v[172:175]
  s_add_u32 m0, s53, 0
  v_mfma_f32_16x16x32_bf16 v[188:191], v[80:83], v[120:123], v[188:191]
  buffer_load_dwordx4 v4, s[16:19], s52 offen lds
  v_mfma_f32_16x16x32_bf16 v[204:207], v[84:87], v[120:123], v[204:207]
  s_lshr_b32 s57, s57, 4
  s_add_u32 s56, s56, 1
  s_cmp_lt_u32 s56, 3
  s_cbranch_scc1 P1_Y0_loop
  s_waitcnt vmcnt(8) lgkmcnt(0)
  s_barrier
  v_mfma_f32_16x16x32_bf16 v[128:131], v[48:51], v[88:91], v[128:131]
  v_add_u32 v14, s54, v7
  ds_read_b64_tr_b16 v[68:69], v10 offset:20480
  s_mul_i32 s60, s41, 20480
  s_lshl_b32 s61, s43, 6
  s_add_u32 s60, s60, s61
  v_mfma_f32_16x16x32_bf16 v[144:147], v[52:55], v[88:91], v[144:147]
  ds_read_b64_tr_b16 v[70:71], v10 offset:20992
  s_add_u32 s60, s60, 9453568
  v_and_b32 v20, 15, v0
  v_mfma_f32_16x16x32_bf16 v[160:163], v[56:59], v[88:91], v[160:163]
  ds_read_b64_tr_b16 v[72:73], v10 offset:24576
  v_mul_u32_u24 v20, 1280, v20
  v_lshrrev_b32 v21, 4, v0
  v_lshl_add_u32 v20, v21, 4, v20
  v_mfma_f32_16x16x32_bf16 v[176:179], v[60:63], v[88:91], v[176:179]
  ds_read_b64_tr_b16 v[74:75], v10 offset:25088
  v_add_u32 v20, s60, v20
  buffer_load_dwordx4 v[212:215], v20, s[32:35], 0 offen sc1
  v_mfma_f32_16x16x32_bf16 v[192:195], v[64:67], v[88:91], v[192:195]
  ds_read_b128 v[108:111], v14 offset:0
  buffer_load_dwordx4 v[216:219], v20, s[32:35], 0 offen offset:512 sc1
  buffer_load_dwordx4 v[220:223], v20, s[32:35], 0 offen offset:1024 sc1
  s_lshl_b32 s60, s43, 6
  v_mfma_f32_16x16x32_bf16 v[132:135], v[48:51], v[92:95], v[132:135]
  ds_read_b64_tr_b16 v[76:77], v10 offset:28672
  s_lshl_b32 s61, s40, 7
  s_add_u32 s60, s60, s61
  v_mfma_f32_16x16x32_bf16 v[148:151], v[52:55], v[92:95], v[148:151]
  ds_read_b64_tr_b16 v[78:79], v10 offset:29184
  s_sub_u32 s60, s60, 16
  v_add_u32 v22, s60, v0
  v_max_i32 v22, 0, v22
  v_mfma_f32_16x16x32_bf16 v[164:167], v[56:59], v[92:95], v[164:167]
  ds_read_b128 v[112:115], v14 offset:2048
  v_min_i32 v22, 2047, v22
  v_lshlrev_b32 v22, 3, v22
  v_mfma_f32_16x16x32_bf16 v[180:183], v[60:63], v[92:95], v[180:183]
  ds_read_b64_tr_b16 v[80:81], v10 offset:32768
  v_add_u32 v22, 9437184, v22
  buffer_load_dwordx2 v[224:225], v22, s[32:35], 0 offen sc1
  v_mfma_f32_16x16x32_bf16 v[196:199], v[64:67], v[92:95], v[196:199]
  ds_read_b64_tr_b16 v[82:83], v10 offset:33280
  v_mfma_f32_16x16x32_bf16 v[136:139], v[48:51], v[96:99], v[136:139]
  ds_read_b128 v[116:119], v14 offset:4096
  v_mfma_f32_16x16x32_bf16 v[152:155], v[52:55], v[96:99], v[152:155]
  ds_read_b64_tr_b16 v[84:85], v12 offset:20480
  v_mfma_f32_16x16x32_bf16 v[168:171], v[56:59], v[96:99], v[168:171]
  ds_read_b64_tr_b16 v[86:87], v12 offset:20736
  v_mfma_f32_16x16x32_bf16 v[184:187], v[60:63], v[96:99], v[184:187]
  ds_read_b128 v[120:123], v14 offset:6144
  v_mfma_f32_16x16x32_bf16 v[200:203], v[64:67], v[96:99], v[200:203]
  v_mfma_f32_16x16x32_bf16 v[140:143], v[48:51], v[100:103], v[140:143]
  v_mfma_f32_16x16x32_bf16 v[156:159], v[52:55], v[100:103], v[156:159]
  v_mfma_f32_16x16x32_bf16 v[172:175], v[56:59], v[100:103], v[172:175]
  v_mfma_f32_16x16x32_bf16 v[188:191], v[60:63], v[100:103], v[188:191]
  v_mfma_f32_16x16x32_bf16 v[204:207], v[64:67], v[100:103], v[204:207]
  s_cmp_lt_u32 s43, 5
  s_cbranch_scc0 L_tch_6044
  s_mov_b32 s61, s43
  s_lshr_b32 s60, s2, 3
  s_mul_i32 s60, s60, 5
  s_add_u32 s60, s60, s61
  s_min_u32 s60, s60, 143
  s_add_u32 s61, s60, 64
  s_add_u32 s62, s60, 72
  s_cmp_lt_u32 s60, 72
  s_cselect_b32 s60, s61, s62
  s_lshl_b32 s60, s60, 13
  v_lshlrev_b32 v23, 7, v0
  v_add_u32 v23, s60, v23
  global_load_dword v45, v23, s[72:73]
L_tch_6044:
  s_waitcnt vmcnt(8) lgkmcnt(0)
  s_barrier
  v_mfma_f32_16x16x32_bf16 v[128:131], v[68:71], v[108:111], v[128:131]
  s_add_u32 s54, s54, 0x4000
  s_cmp_eq_u32 s54, 0xc000
  s_cselect_b32 s54, 0, s54
  ds_read_b64_tr_b16 v[48:49], v10 offset:40960
  v_mfma_f32_16x16x32_bf16 v[144:147], v[72:75], v[108:111], v[144:147]
  v_add_u32 v14, s54, v6
  ds_read_b64_tr_b16 v[50:51], v10 offset:41472
  v_mfma_f32_16x16x32_bf16 v[160:163], v[76:79], v[108:111], v[160:163]
  ds_read_b64_tr_b16 v[52:53], v10 offset:45056
  v_mfma_f32_16x16x32_bf16 v[176:179], v[80:83], v[108:111], v[176:179]
  ds_read_b64_tr_b16 v[54:55], v10 offset:45568
  s_mov_b32 s20, s72
  v_mfma_f32_16x16x32_bf16 v[192:195], v[84:87], v[108:111], v[192:195]
  ds_read_b128 v[88:91], v14 offset:0
  v_mfma_f32_16x16x32_bf16 v[132:135], v[68:71], v[112:115], v[132:135]
  ds_read_b64_tr_b16 v[56:57], v10 offset:49152
  s_and_b32 s21, s73, 0xffff
  v_mfma_f32_16x16x32_bf16 v[148:151], v[72:75], v[112:115], v[148:151]
  ds_read_b64_tr_b16 v[58:59], v10 offset:49664
  v_mfma_f32_16x16x32_bf16 v[164:167], v[76:79], v[112:115], v[164:167]
  ds_read_b128 v[92:95], v14 offset:2048
  v_mfma_f32_16x16x32_bf16 v[180:183], v[80:83], v[112:115], v[180:183]
  ds_read_b64_tr_b16 v[60:61], v10 offset:53248
  s_mov_b32 s22, 0x1c0000
  v_mfma_f32_16x16x32_bf16 v[196:199], v[84:87], v[112:115], v[196:199]
  ds_read_b64_tr_b16 v[62:63], v10 offset:53760
  v_mfma_f32_16x16x32_bf16 v[136:139], v[68:71], v[116:119], v[136:139]
  ds_read_b128 v[96:99], v14 offset:4096
  v_mfma_f32_16x16x32_bf16 v[152:155], v[72:75], v[116:119], v[152:155]
  ds_read_b64_tr_b16 v[64:65], v12 offset:40960
  s_mov_b32 s23, 0x20000
  v_mfma_f32_16x16x32_bf16 v[168:171], v[76:79], v[116:119], v[168:171]
  ds_read_b64_tr_b16 v[66:67], v12 offset:41216
  v_mfma_f32_16x16x32_bf16 v[184:187], v[80:83], v[116:119], v[184:187]
  ds_read_b128 v[100:103], v14 offset:6144
  v_mfma_f32_16x16x32_bf16 v[200:203], v[84:87], v[116:119], v[200:203]
  s_mul_i32 s66, s45, 655360
  v_mfma_f32_16x16x32_bf16 v[140:143], v[68:71], v[120:123], v[140:143]
  v_mfma_f32_16x16x32_bf16 v[156:159], v[72:75], v[120:123], v[156:159]
  v_mfma_f32_16x16x32_bf16 v[172:175], v[76:79], v[120:123], v[172:175]
  s_add_u32 s66, s66, 524288
  v_mfma_f32_16x16x32_bf16 v[188:191], v[80:83], v[120:123], v[188:191]
  v_mfma_f32_16x16x32_bf16 v[204:207], v[84:87], v[120:123], v[204:207]
  s_waitcnt vmcnt(5)
  s_waitcnt vmcnt(63) lgkmcnt(0)
  s_barrier
  v_mfma_f32_16x16x32_bf16 v[128:131], v[48:51], v[88:91], v[128:131]
  v_add_u32 v14, s54, v7
  ds_read_b64_tr_b16 v[68:69], v11 offset:0
  v_mfma_f32_16x16x32_bf16 v[144:147], v[52:55], v[88:91], v[144:147]
  ds_read_b64_tr_b16 v[70:71], v11 offset:512
  v_mfma_f32_16x16x32_bf16 v[160:163], v[56:59], v[88:91], v[160:163]
  ds_read_b64_tr_b16 v[72:73], v11 offset:4096
  v_mfma_f32_16x16x32_bf16 v[176:179], v[60:63], v[88:91], v[176:179]
  ds_read_b64_tr_b16 v[74:75], v11 offset:4608
  v_mfma_f32_16x16x32_bf16 v[192:195], v[64:67], v[88:91], v[192:195]
  ds_read_b128 v[108:111], v14 offset:0
  v_mfma_f32_16x16x32_bf16 v[132:135], v[48:51], v[92:95], v[132:135]
  ds_read_b64_tr_b16 v[76:77], v11 offset:8192
  v_mfma_f32_16x16x32_bf16 v[148:151], v[52:55], v[92:95], v[148:151]
  ds_read_b64_tr_b16 v[78:79], v11 offset:8704
  v_mfma_f32_16x16x32_bf16 v[164:167], v[56:59], v[92:95], v[164:167]
  ds_read_b128 v[112:115], v14 offset:2048
  v_mfma_f32_16x16x32_bf16 v[180:183], v[60:63], v[92:95], v[180:183]
  ds_read_b64_tr_b16 v[80:81], v11 offset:12288
  v_mfma_f32_16x16x32_bf16 v[196:199], v[64:67], v[92:95], v[196:199]
  ds_read_b64_tr_b16 v[82:83], v11 offset:12800
  v_mfma_f32_16x16x32_bf16 v[136:139], v[48:51], v[96:99], v[136:139]
  ds_read_b128 v[116:119], v14 offset:4096
  v_mfma_f32_16x16x32_bf16 v[152:155], v[52:55], v[96:99], v[152:155]
  ds_read_b64_tr_b16 v[84:85], v13 offset:0
  v_mfma_f32_16x16x32_bf16 v[168:171], v[56:59], v[96:99], v[168:171]
  ds_read_b64_tr_b16 v[86:87], v13 offset:256
  v_mfma_f32_16x16x32_bf16 v[184:187], v[60:63], v[96:99], v[184:187]
  ds_read_b128 v[120:123], v14 offset:6144
  v_mfma_f32_16x16x32_bf16 v[200:203], v[64:67], v[96:99], v[200:203]
  v_mfma_f32_16x16x32_bf16 v[140:143], v[48:51], v[100:103], v[140:143]
  v_mfma_f32_16x16x32_bf16 v[156:159], v[52:55], v[100:103], v[156:159]
  v_mfma_f32_16x16x32_bf16 v[172:175], v[56:59], v[100:103], v[172:175]
  v_mfma_f32_16x16x32_bf16 v[188:191], v[60:63], v[100:103], v[188:191]
  v_mfma_f32_16x16x32_bf16 v[204:207], v[64:67], v[100:103], v[204:207]
  s_cmp_ge_u32 s43, 3
  s_cbranch_scc0 L_tch_6045
  s_sub_u32 s61, s43, 3
  s_lshr_b32 s60, s2, 3
  s_mul_i32 s60, s60, 5
  s_add_u32 s60, s60, s61
  s_min_u32 s60, s60, 143
  s_add_u32 s61, s60, 136
  s_add_u32 s62, s60, 208
  s_cmp_lt_u32 s60, 8
  s_cselect_b32 s61, s61, s62
  s_sub_u32 s62, s60, 16
  s_cmp_lt_u32 s60, 16
  s_cselect_b32 s61, s61, s62
  s_sub_u32 s62, s60, 80
  s_cmp_lt_u32 s60, 80
  s_cselect_b32 s61, s61, s62
  s_sub_u32 s62, s60, 16
  s_cmp_lt_u32 s62, 64
  s_cselect_b32 s64, s70, s72
  s_cselect_b32 s65, s71, s73
  s_mov_b32 s60, s61
  s_lshl_b32 s60, s60, 13
  v_lshlrev_b32 v23, 7, v0
  v_add_u32 v23, s60, v23
  global_load_dword v46, v23, s[64:65]
L_tch_6045:
  s_cmp_eq_u32 s43, 3
  s_cbranch_scc0 L_wbn_6047
  s_waitcnt vmcnt(2)
  s_branch L_wbw_6046
L_wbn_6047:
  s_waitcnt vmcnt(1)
L_wbw_6046:
  s_waitcnt vmcnt(63) lgkmcnt(0)
  s_barrier
  v_mfma_f32_16x16x32_bf16 v[128:131], v[68:71], v[108:111], v[128:131]
  v_add_f32_dpp v212, v212, v212 row_ror:8 row_mask:0xf bank_mask:0xf
  v_add_f32_dpp v213, v213, v213 row_ror:8 row_mask:0xf bank_mask:0xf
  v_add_f32_dpp v214, v214, v214 row_ror:8 row_mask:0xf bank_mask:0xf
  v_mfma_f32_16x16x32_bf16 v[144:147], v[72:75], v[108:111], v[144:147]
  v_add_f32_dpp v215, v215, v215 row_ror:8 row_mask:0xf bank_mask:0xf
  v_add_f32_dpp v216, v216, v216 row_ror:8 row_mask:0xf bank_mask:0xf
  v_add_f32_dpp v217, v217, v217 row_ror:8 row_mask:0xf bank_mask:0xf
  v_mfma_f32_16x16x32_bf16 v[160:163], v[76:79], v[108:111], v[160:163]
  v_add_f32_dpp v218, v218, v218 row_ror:8 row_mask:0xf bank_mask:0xf
  v_add_f32_dpp v219, v219, v219 row_ror:8 row_mask:0xf bank_mask:0xf
  v_mfma_f32_16x16x32_bf16 v[176:179], v[80:83], v[108:111], v[176:179]
  v_add_f32_dpp v220, v220, v220 row_ror:8 row_mask:0xf bank_mask:0xf
  v_add_f32_dpp v221, v221, v221 row_ror:8 row_mask:0xf bank_mask:0xf
  v_add_f32_dpp v222, v222, v222 row_ror:8 row_mask:0xf bank_mask:0xf
  v_mfma_f32_16x16x32_bf16 v[192:195], v[84:87], v[108:111], v[192:195]
  v_add_f32_dpp v223, v223, v223 row_ror:8 row_mask:0xf bank_mask:0xf
  v_add_f32_dpp v212, v212, v212 row_ror:4 row_mask:0xf bank_mask:0xf
  v_add_f32_dpp v213, v213, v213 row_ror:4 row_mask:0xf bank_mask:0xf
  v_mfma_f32_16x16x32_bf16 v[132:135], v[68:71], v[112:115], v[132:135]
  v_add_f32_dpp v214, v214, v214 row_ror:4 row_mask:0xf bank_mask:0xf
  v_add_f32_dpp v215, v215, v215 row_ror:4 row_mask:0xf bank_mask:0xf
  v_mfma_f32_16x16x32_bf16 v[148:151], v[72:75], v[112:115], v[148:151]
  v_add_f32_dpp v216, v216, v216 row_ror:4 row_mask:0xf bank_mask:0xf
  v_add_f32_dpp v217, v217, v217 row_ror:4 row_mask:0xf bank_mask:0xf
  v_add_f32_dpp v218, v218, v218 row_ror:4 row_mask:0xf bank_mask:0xf
  v_mfma_f32_16x16x32_bf16 v[164:167], v[76:79], v[112:115], v[164:167]
  v_add_f32_dpp v219, v219, v219 row_ror:4 row_mask:0xf bank_mask:0xf
  v_add_f32_dpp v220, v220, v220 row_ror:4 row_mask:0xf bank_mask:0xf
  v_add_f32_dpp v221, v221, v221 row_ror:4 row_mask:0xf bank_mask:0xf
  v_mfma_f32_16x16x32_bf16 v[180:183], v[80:83], v[112:115], v[180:183]
  v_add_f32_dpp v222, v222, v222 row_ror:4 row_mask:0xf bank_mask:0xf
  v_add_f32_dpp v223, v223, v223 row_ror:4 row_mask:0xf bank_mask:0xf
  v_mfma_f32_16x16x32_bf16 v[196:199], v[84:87], v[112:115], v[196:199]
  v_add_f32_dpp v212, v212, v212 row_ror:2 row_mask:0xf bank_mask:0xf
  v_add_f32_dpp v213, v213, v213 row_ror:2 row_mask:0xf bank_mask:0xf
  v_add_f32_dpp v214, v214, v214 row_ror:2 row_mask:0xf bank_mask:0xf
  v_mfma_f32_16x16x32_bf16 v[136:139], v[68:71], v[116:119], v[136:139]
  v_add_f32_dpp v215, v215, v215 row_ror:2 row_mask:0xf bank_mask:0xf
  v_add_f32_dpp v216, v216, v216 row_ror:2 row_mask:0xf bank_mask:0xf
  v_add_f32_dpp v217, v217, v217 row_ror:2 row_mask:0xf bank_mask:0xf
  v_mfma_f32_16x16x32_bf16 v[152:155], v[72:75], v[116:119], v[152:155]
  v_add_f32_dpp v218, v218, v218 row_ror:2 row_mask:0xf bank_mask:0xf
  v_add_f32_dpp v219, v219, v219 row_ror:2 row_mask:0xf bank_mask:0xf
  v_mfma_f32_16x16x32_bf16 v[168:171], v[76:79], v[116:119], v[168:171]
  v_add_f32_dpp v220, v220, v220 row_ror:2 row_mask:0xf bank_mask:0xf
  v_add_f32_dpp v221, v221, v221 row_ror:2 row_mask:0xf bank_mask:0xf
  v_add_f32_dpp v222, v222, v222 row_ror:2 row_mask:0xf bank_mask:0xf
  v_mfma_f32_16x16x32_bf16 v[184:187], v[80:83], v[116:119], v[184:187]
  v_add_f32_dpp v223, v223, v223 row_ror:2 row_mask:0xf bank_mask:0xf
  v_add_f32_dpp v212, v212, v212 row_ror:1 row_mask:0xf bank_mask:0xf
  v_add_f32_dpp v213, v213, v213 row_ror:1 row_mask:0xf bank_mask:0xf
  v_mfma_f32_16x16x32_bf16 v[200:203], v[84:87], v[116:119], v[200:203]
  v_add_f32_dpp v214, v214, v214 row_ror:1 row_mask:0xf bank_mask:0xf
  v_add_f32_dpp v215, v215, v215 row_ror:1 row_mask:0xf bank_mask:0xf
  v_mfma_f32_16x16x32_bf16 v[140:143], v[68:71], v[120:123], v[140:143]
  v_add_f32_dpp v216, v216, v216 row_ror:1 row_mask:0xf bank_mask:0xf
  v_add_f32_dpp v217, v217, v217 row_ror:1 row_mask:0xf bank_mask:0xf
  v_add_f32_dpp v218, v218, v218 row_ror:1 row_mask:0xf bank_mask:0xf
  v_mfma_f32_16x16x32_bf16 v[156:159], v[72:75], v[120:123], v[156:159]
  v_add_f32_dpp v219, v219, v219 row_ror:1 row_mask:0xf bank_mask:0xf
  v_add_f32_dpp v220, v220, v220 row_ror:1 row_mask:0xf bank_mask:0xf
  v_add_f32_dpp v221, v221, v221 row_ror:1 row_mask:0xf bank_mask:0xf
  v_mfma_f32_16x16x32_bf16 v[172:175], v[76:79], v[120:123], v[172:175]
  v_add_f32_dpp v222, v222, v222 row_ror:1 row_mask:0xf bank_mask:0xf
  v_add_f32_dpp v223, v223, v223 row_ror:1 row_mask:0xf bank_mask:0xf
  v_mfma_f32_16x16x32_bf16 v[188:191], v[80:83], v[120:123], v[188:191]
  v_mfma_f32_16x16x32_bf16 v[204:207], v[84:87], v[120:123], v[204:207]
  ds_write_b128 v36, v[212:215]
  ds_write_b128 v36, v[216:219] offset:512
  ds_write_b128 v37, v[220:223]
  ds_write_b32 v38, v224 offset:0
  ds_write_b32 v38, v225 offset:576
  s_waitcnt lgkmcnt(0)
  s_barrier
  v_and_b32 v20, 15, v0
  v_lshlrev_b32 v10, 2, v20
  v_add_u32 v10, 147456, v10
  v_and_b32 v11, 48, v0
  v_add_u32 v11, 147456, v11
  s_lshl_b32 s60, s44, 6
  v_add_u32 v22, s60, v11
  ds_read_b128 v[60:63], v22 offset:1152
  ds_read_b128 v[64:67], v22 offset:1408
  ds_read_b32 v48, v10 offset:64
  ds_read_b32 v52, v10 offset:640
  ds_read_b32 v49, v10 offset:128
  ds_read_b32 v53, v10 offset:704
  ds_read_b32 v50, v10 offset:192
  ds_read_b32 v54, v10 offset:768
  ds_read_b32 v51, v10 offset:256
  ds_read_b32 v55, v10 offset:832
  ds_read_b128 v[68:71], v22 offset:1664
  ds_read_b128 v[72:75], v22 offset:1920
  v_lshrrev_b32 v23, 5, v0
  v_lshl_add_u32 v23, v23, 6, v10
  v_and_b32 v24, 16, v0
  v_add_u32 v24, s60, v24
  v_add_u32 v24, 147456, v24
  v_mov_b32 v12, 0xbdd2d3e8
  s_mov_b32 s64, 0xc0135761
  s_add_u32 m0, s68, 0
  s_nop 0
  buffer_load_dwordx4 v41, s[20:23], s66 offen lds
  s_add_u32 s66, s66, 32768
  s_waitcnt lgkmcnt(0)
  ds_read_b32 v56, v23 offset:64
  ds_read_b32 v58, v23 offset:640
  ds_read_b32 v57, v23 offset:192
  ds_read_b32 v59, v23 offset:768
  ds_read_b128 v[76:79], v24 offset:2176
  ds_read_b128 v[80:83], v24 offset:2208
  v_bfe_u32 v21, v0, 4, 1
  s_lshl_b32 s60, s40, 3
  s_add_u32 s60, s60, 0
  v_add_u32 v21, s60, v21
  v_mul_u32_u24 v21, 73728, v21
  v_lshrrev_b32 v20, 5, v0
  v_lshl_add_u32 v21, v20, 8, v21
  v_and_b32 v20, 15, v0
  v_lshl_add_u32 v25, v20, 4, v21
  s_lshl_b32 s60, s49, 4
  s_lshl_b32 s61, s44, 9
  s_add_u32 s60, s60, s61
  s_add_u32 s60, s60, 16384
  v_add_u32 v13, s60, v25
  v_add_u32 v14, 2048, v13
  v_pk_fma_f32 v[128:129], v[48:49], v[60:61], v[128:129] op_sel_hi:[0,1,1] neg_lo:[1,0,0] neg_hi:[1,0,0]
  v_pk_fma_f32 v[130:131], v[48:49], v[62:63], v[130:131] op_sel_hi:[0,1,1] neg_lo:[1,0,0] neg_hi:[1,0,0]
  v_pk_fma_f32 v[132:133], v[48:49], v[60:61], v[132:133] op_sel:[1,0,0] neg_lo:[1,0,0] neg_hi:[1,0,0]
  v_pk_fma_f32 v[134:135], v[48:49], v[62:63], v[134:135] op_sel:[1,0,0] neg_lo:[1,0,0] neg_hi:[1,0,0]
  v_pk_mul_f32 v[128:129], v[52:53], v[128:129] op_sel_hi:[0,1]
  v_pk_mul_f32 v[130:131], v[52:53], v[130:131] op_sel_hi:[0,1]
  v_pk_mul_f32 v[132:133], v[52:53], v[132:133] op_sel:[1,0]
  v_pk_mul_f32 v[134:135], v[52:53], v[134:135] op_sel:[1,0]
  v_pk_mul_f32 v[28:29], v[128:129], v[128:129]
  v_pk_mul_f32 v[30:31], v[130:131], v[130:131]
  v_pk_mul_f32 v[32:33], v[132:133], v[132:133]
  v_pk_mul_f32 v[34:35], v[134:135], v[134:135]
  v_pk_fma_f32 v[144:145], v[48:49], v[64:65], v[144:145] op_sel_hi:[0,1,1] neg_lo:[1,0,0] neg_hi:[1,0,0]
  v_pk_fma_f32 v[146:147], v[48:49], v[66:67], v[146:147] op_sel_hi:[0,1,1] neg_lo:[1,0,0] neg_hi:[1,0,0]
  v_pk_fma_f32 v[148:149], v[48:49], v[64:65], v[148:149] op_sel:[1,0,0] neg_lo:[1,0,0] neg_hi:[1,0,0]
  v_pk_fma_f32 v[150:151], v[48:49], v[66:67], v[150:151] op_sel:[1,0,0] neg_lo:[1,0,0] neg_hi:[1,0,0]
  v_pk_fma_f32 v[28:29], v[28:29], v[12:13], s[64:65] op_sel_hi:[1,0,0]
  v_pk_fma_f32 v[30:31], v[30:31], v[12:13], s[64:65] op_sel_hi:[1,0,0]
  v_pk_fma_f32 v[32:33], v[32:33], v[12:13], s[64:65] op_sel_hi:[1,0,0]
  v_pk_fma_f32 v[34:35], v[34:35], v[12:13], s[64:65] op_sel_hi:[1,0,0]
  v_pk_mul_f32 v[144:145], v[52:53], v[144:145] op_sel_hi:[0,1]
  v_pk_mul_f32 v[146:147], v[52:53], v[146:147] op_sel_hi:[0,1]
  v_pk_mul_f32 v[148:149], v[52:53], v[148:149] op_sel:[1,0]
  v_pk_mul_f32 v[150:151], v[52:53], v[150:151] op_sel:[1,0]
  v_pk_mul_f32 v[28:29], v[28:29], v[128:129]
  v_pk_mul_f32 v[30:31], v[30:31], v[130:131]
  v_pk_mul_f32 v[32:33], v[32:33], v[132:133]
  v_pk_mul_f32 v[34:35], v[34:35], v[134:135]
  v_exp_f32 v28, v28
  v_exp_f32 v29, v29
  v_exp_f32 v30, v30
  v_exp_f32 v31, v31
  v_exp_f32 v32, v32
  v_exp_f32 v33, v33
  v_exp_f32 v34, v34
  v_exp_f32 v35, v35
  v_pk_mul_f32 v[144:145], v[128:129], v[144:145]
  v_pk_mul_f32 v[146:147], v[130:131], v[146:147]
  v_pk_mul_f32 v[148:149], v[132:133], v[148:149]
  v_pk_mul_f32 v[150:151], v[134:135], v[150:151]
  v_pk_add_f32 v[28:29], v[28:29], 1.0 op_sel_hi:[1,0]
  v_pk_add_f32 v[30:31], v[30:31], 1.0 op_sel_hi:[1,0]
  v_pk_add_f32 v[32:33], v[32:33], 1.0 op_sel_hi:[1,0]
  v_pk_add_f32 v[34:35], v[34:35], 1.0 op_sel_hi:[1,0]
  v_rcp_f32 v28, v28
  v_rcp_f32 v29, v29
  v_rcp_f32 v30, v30
  v_rcp_f32 v31, v31
  v_rcp_f32 v32, v32
  v_rcp_f32 v33, v33
  v_rcp_f32 v34, v34
  v_rcp_f32 v35, v35
  s_nop 0
  v_pk_mul_f32 v[144:145], v[28:29], v[144:145]
  v_pk_mul_f32 v[146:147], v[30:31], v[146:147]
  v_pk_mul_f32 v[148:149], v[32:33], v[148:149]
  v_pk_mul_f32 v[150:151], v[34:35], v[150:151]
  v_cvt_pk_bf16_f32 v84, v144, v145
  v_cvt_pk_bf16_f32 v85, v146, v147
  v_cvt_pk_bf16_f32 v86, v148, v149
  v_cvt_pk_bf16_f32 v87, v150, v151
  s_add_u32 m0, s68, 8192
  s_nop 0
  buffer_load_dwordx4 v41, s[20:23], s66 offen lds
  s_add_u32 s66, s66, 32768
  s_add_u32 m0, s68, 16384
  s_nop 0
  buffer_load_dwordx4 v41, s[20:23], s66 offen lds
  s_add_u32 s66, s66, 32768
  s_add_u32 m0, s68, 24576
  s_nop 0
  buffer_load_dwordx4 v41, s[20:23], s66 offen lds
  s_add_u32 s66, s66, 32768
  s_add_u32 m0, s68, 32768
  s_nop 0
  buffer_load_dwordx4 v41, s[20:23], s66 offen lds
  s_add_u32 s66, s66, 32768
  v_pk_fma_f32 v[136:137], v[50:51], v[60:61], v[136:137] op_sel_hi:[0,1,1] neg_lo:[1,0,0] neg_hi:[1,0,0]
  v_pk_fma_f32 v[138:139], v[50:51], v[62:63], v[138:139] op_sel_hi:[0,1,1] neg_lo:[1,0,0] neg_hi:[1,0,0]
  v_pk_fma_f32 v[140:141], v[50:51], v[60:61], v[140:141] op_sel:[1,0,0] neg_lo:[1,0,0] neg_hi:[1,0,0]
  v_pk_fma_f32 v[142:143], v[50:51], v[62:63], v[142:143] op_sel:[1,0,0] neg_lo:[1,0,0] neg_hi:[1,0,0]
  v_pk_mul_f32 v[136:137], v[54:55], v[136:137] op_sel_hi:[0,1]
  v_pk_mul_f32 v[138:139], v[54:55], v[138:139] op_sel_hi:[0,1]
  v_pk_mul_f32 v[140:141], v[54:55], v[140:141] op_sel:[1,0]
  v_pk_mul_f32 v[142:143], v[54:55], v[142:143] op_sel:[1,0]
  v_pk_mul_f32 v[28:29], v[136:137], v[136:137]
  v_pk_mul_f32 v[30:31], v[138:139], v[138:139]
  v_pk_mul_f32 v[32:33], v[140:141], v[140:141]
  v_pk_mul_f32 v[34:35], v[142:143], v[142:143]
  v_pk_fma_f32 v[152:153], v[50:51], v[64:65], v[152:153] op_sel_hi:[0,1,1] neg_lo:[1,0,0] neg_hi:[1,0,0]
  v_pk_fma_f32 v[154:155], v[50:51], v[66:67], v[154:155] op_sel_hi:[0,1,1] neg_lo:[1,0,0] neg_hi:[1,0,0]
  v_pk_fma_f32 v[156:157], v[50:51], v[64:65], v[156:157] op_sel:[1,0,0] neg_lo:[1,0,0] neg_hi:[1,0,0]
  v_pk_fma_f32 v[158:159], v[50:51], v[66:67], v[158:159] op_sel:[1,0,0] neg_lo:[1,0,0] neg_hi:[1,0,0]
  v_pk_fma_f32 v[28:29], v[28:29], v[12:13], s[64:65] op_sel_hi:[1,0,0]
  v_pk_fma_f32 v[30:31], v[30:31], v[12:13], s[64:65] op_sel_hi:[1,0,0]
  v_pk_fma_f32 v[32:33], v[32:33], v[12:13], s[64:65] op_sel_hi:[1,0,0]
  v_pk_fma_f32 v[34:35], v[34:35], v[12:13], s[64:65] op_sel_hi:[1,0,0]
  v_pk_mul_f32 v[152:153], v[54:55], v[152:153] op_sel_hi:[0,1]
  v_pk_mul_f32 v[154:155], v[54:55], v[154:155] op_sel_hi:[0,1]
  v_pk_mul_f32 v[156:157], v[54:55], v[156:157] op_sel:[1,0]
  v_pk_mul_f32 v[158:159], v[54:55], v[158:159] op_sel:[1,0]
  v_pk_mul_f32 v[28:29], v[28:29], v[136:137]
  v_pk_mul_f32 v[30:31], v[30:31], v[138:139]
  v_pk_mul_f32 v[32:33], v[32:33], v[140:141]
  v_pk_mul_f32 v[34:35], v[34:35], v[142:143]
  v_exp_f32 v28, v28
  v_exp_f32 v29, v29
  v_exp_f32 v30, v30
  v_exp_f32 v31, v31
  v_exp_f32 v32, v32
  v_exp_f32 v33, v33
  v_exp_f32 v34, v34
  v_exp_f32 v35, v35
  v_pk_mul_f32 v[152:153], v[136:137], v[152:153]
  v_pk_mul_f32 v[154:155], v[138:139], v[154:155]
  v_pk_mul_f32 v[156:157], v[140:141], v[156:157]
  v_pk_mul_f32 v[158:159], v[142:143], v[158:159]
  v_pk_add_f32 v[28:29], v[28:29], 1.0 op_sel_hi:[1,0]
  v_pk_add_f32 v[30:31], v[30:31], 1.0 op_sel_hi:[1,0]
  v_pk_add_f32 v[32:33], v[32:33], 1.0 op_sel_hi:[1,0]
  v_pk_add_f32 v[34:35], v[34:35], 1.0 op_sel_hi:[1,0]
  v_rcp_f32 v28, v28
  v_rcp_f32 v29, v29
  v_rcp_f32 v30, v30
  v_rcp_f32 v31, v31
  v_rcp_f32 v32, v32
  v_rcp_f32 v33, v33
  v_rcp_f32 v34, v34
  v_rcp_f32 v35, v35
  s_nop 0
  v_pk_mul_f32 v[152:153], v[28:29], v[152:153]
  v_pk_mul_f32 v[154:155], v[30:31], v[154:155]
  v_pk_mul_f32 v[156:157], v[32:33], v[156:157]
  v_pk_mul_f32 v[158:159], v[34:35], v[158:159]
  v_cvt_pk_bf16_f32 v88, v152, v153
  v_cvt_pk_bf16_f32 v89, v154, v155
  v_cvt_pk_bf16_f32 v90, v156, v157
  v_cvt_pk_bf16_f32 v91, v158, v159
  s_add_u32 m0, s68, 40960
  s_nop 0
  buffer_load_dwordx4 v41, s[20:23], s66 offen lds
  s_add_u32 s66, s66, 32768
  s_add_u32 m0, s68, 49152
  s_nop 0
  buffer_load_dwordx4 v41, s[20:23], s66 offen lds
  s_add_u32 s66, s66, 32768
  s_add_u32 m0, s68, 57344
  s_nop 0
  buffer_load_dwordx4 v41, s[20:23], s66 offen lds
  s_add_u32 s66, s66, 32768
  s_add_u32 m0, s68, 65536
  s_nop 0
  buffer_load_dwordx4 v41, s[20:23], s66 offen lds
  s_add_u32 s66, s66, 32768
  s_nop 1
  v_permlane16_swap_b32 v84, v86
  v_permlane16_swap_b32 v85, v87
  v_permlane16_swap_b32 v88, v90
  v_permlane16_swap_b32 v89, v91
  s_mov_b32 s63, 147456
  buffer_store_dwordx4 v[84:87], v13, s[32:35], 0 offen sc1
  buffer_store_dwordx4 v[88:91], v13, s[32:35], s63 offen sc1
  v_pk_fma_f32 v[160:161], v[48:49], v[68:69], v[160:161] op_sel_hi:[0,1,1] neg_lo:[1,0,0] neg_hi:[1,0,0]
  v_pk_fma_f32 v[162:163], v[48:49], v[70:71], v[162:163] op_sel_hi:[0,1,1] neg_lo:[1,0,0] neg_hi:[1,0,0]
  v_pk_fma_f32 v[164:165], v[48:49], v[68:69], v[164:165] op_sel:[1,0,0] neg_lo:[1,0,0] neg_hi:[1,0,0]
  v_pk_fma_f32 v[166:167], v[48:49], v[70:71], v[166:167] op_sel:[1,0,0] neg_lo:[1,0,0] neg_hi:[1,0,0]
  v_pk_mul_f32 v[160:161], v[52:53], v[160:161] op_sel_hi:[0,1]
  v_pk_mul_f32 v[162:163], v[52:53], v[162:163] op_sel_hi:[0,1]
  v_pk_mul_f32 v[164:165], v[52:53], v[164:165] op_sel:[1,0]
  v_pk_mul_f32 v[166:167], v[52:53], v[166:167] op_sel:[1,0]
  v_pk_mul_f32 v[28:29], v[160:161], v[160:161]
  v_pk_mul_f32 v[30:31], v[162:163], v[162:163]
  v_pk_mul_f32 v[32:33], v[164:165], v[164:165]
  v_pk_mul_f32 v[34:35], v[166:167], v[166:167]
  v_pk_fma_f32 v[176:177], v[48:49], v[72:73], v[176:177] op_sel_hi:[0,1,1] neg_lo:[1,0,0] neg_hi:[1,0,0]
  v_pk_fma_f32 v[178:179], v[48:49], v[74:75], v[178:179] op_sel_hi:[0,1,1] neg_lo:[1,0,0] neg_hi:[1,0,0]
  v_pk_fma_f32 v[180:181], v[48:49], v[72:73], v[180:181] op_sel:[1,0,0] neg_lo:[1,0,0] neg_hi:[1,0,0]
  v_pk_fma_f32 v[182:183], v[48:49], v[74:75], v[182:183] op_sel:[1,0,0] neg_lo:[1,0,0] neg_hi:[1,0,0]
  v_pk_fma_f32 v[28:29], v[28:29], v[12:13], s[64:65] op_sel_hi:[1,0,0]
  v_pk_fma_f32 v[30:31], v[30:31], v[12:13], s[64:65] op_sel_hi:[1,0,0]
  v_pk_fma_f32 v[32:33], v[32:33], v[12:13], s[64:65] op_sel_hi:[1,0,0]
  v_pk_fma_f32 v[34:35], v[34:35], v[12:13], s[64:65] op_sel_hi:[1,0,0]
  v_pk_mul_f32 v[176:177], v[52:53], v[176:177] op_sel_hi:[0,1]
  v_pk_mul_f32 v[178:179], v[52:53], v[178:179] op_sel_hi:[0,1]
  v_pk_mul_f32 v[180:181], v[52:53], v[180:181] op_sel:[1,0]
  v_pk_mul_f32 v[182:183], v[52:53], v[182:183] op_sel:[1,0]
  v_pk_mul_f32 v[28:29], v[28:29], v[160:161]
  v_pk_mul_f32 v[30:31], v[30:31], v[162:163]
  v_pk_mul_f32 v[32:33], v[32:33], v[164:165]
  v_pk_mul_f32 v[34:35], v[34:35], v[166:167]
  v_exp_f32 v28, v28
  v_exp_f32 v29, v29
  v_exp_f32 v30, v30
  v_exp_f32 v31, v31
  v_exp_f32 v32, v32
  v_exp_f32 v33, v33
  v_exp_f32 v34, v34
  v_exp_f32 v35, v35
  v_pk_mul_f32 v[176:177], v[160:161], v[176:177]
  v_pk_mul_f32 v[178:179], v[162:163], v[178:179]
  v_pk_mul_f32 v[180:181], v[164:165], v[180:181]
  v_pk_mul_f32 v[182:183], v[166:167], v[182:183]
  v_pk_add_f32 v[28:29], v[28:29], 1.0 op_sel_hi:[1,0]
  v_pk_add_f32 v[30:31], v[30:31], 1.0 op_sel_hi:[1,0]
  v_pk_add_f32 v[32:33], v[32:33], 1.0 op_sel_hi:[1,0]
  v_pk_add_f32 v[34:35], v[34:35], 1.0 op_sel_hi:[1,0]
  v_rcp_f32 v28, v28
  v_rcp_f32 v29, v29
  v_rcp_f32 v30, v30
  v_rcp_f32 v31, v31
  v_rcp_f32 v32, v32
  v_rcp_f32 v33, v33
  v_rcp_f32 v34, v34
  v_rcp_f32 v35, v35
  s_nop 0
  v_pk_mul_f32 v[176:177], v[28:29], v[176:177]
  v_pk_mul_f32 v[178:179], v[30:31], v[178:179]
  v_pk_mul_f32 v[180:181], v[32:33], v[180:181]
  v_pk_mul_f32 v[182:183], v[34:35], v[182:183]
  v_cvt_pk_bf16_f32 v92, v176, v177
  v_cvt_pk_bf16_f32 v93, v178, v179
  v_cvt_pk_bf16_f32 v94, v180, v181
  v_cvt_pk_bf16_f32 v95, v182, v183
  s_add_u32 m0, s68, 73728
  s_nop 0
  buffer_load_dwordx4 v41, s[20:23], s66 offen lds
  s_add_u32 s66, s66, 32768
  s_add_u32 m0, s68, 81920
  s_nop 0
  buffer_load_dwordx4 v41, s[20:23], s66 offen lds
  s_add_u32 s66, s66, 32768
  s_add_u32 m0, s68, 90112
  s_nop 0
  buffer_load_dwordx4 v41, s[20:23], s66 offen lds
  s_add_u32 s66, s66, 32768
  s_add_u32 m0, s68, 98304
  s_nop 0
  buffer_load_dwordx4 v41, s[20:23], s66 offen lds
  s_add_u32 s66, s66, 32768
  v_pk_fma_f32 v[168:169], v[50:51], v[68:69], v[168:169] op_sel_hi:[0,1,1] neg_lo:[1,0,0] neg_hi:[1,0,0]
  v_pk_fma_f32 v[170:171], v[50:51], v[70:71], v[170:171] op_sel_hi:[0,1,1] neg_lo:[1,0,0] neg_hi:[1,0,0]
  v_pk_fma_f32 v[172:173], v[50:51], v[68:69], v[172:173] op_sel:[1,0,0] neg_lo:[1,0,0] neg_hi:[1,0,0]
  v_pk_fma_f32 v[174:175], v[50:51], v[70:71], v[174:175] op_sel:[1,0,0] neg_lo:[1,0,0] neg_hi:[1,0,0]
  v_pk_mul_f32 v[168:169], v[54:55], v[168:169] op_sel_hi:[0,1]
  v_pk_mul_f32 v[170:171], v[54:55], v[170:171] op_sel_hi:[0,1]
  v_pk_mul_f32 v[172:173], v[54:55], v[172:173] op_sel:[1,0]
  v_pk_mul_f32 v[174:175], v[54:55], v[174:175] op_sel:[1,0]
  v_pk_mul_f32 v[28:29], v[168:169], v[168:169]
  v_pk_mul_f32 v[30:31], v[170:171], v[170:171]
  v_pk_mul_f32 v[32:33], v[172:173], v[172:173]
  v_pk_mul_f32 v[34:35], v[174:175], v[174:175]
  v_pk_fma_f32 v[184:185], v[50:51], v[72:73], v[184:185] op_sel_hi:[0,1,1] neg_lo:[1,0,0] neg_hi:[1,0,0]
  v_pk_fma_f32 v[186:187], v[50:51], v[74:75], v[186:187] op_sel_hi:[0,1,1] neg_lo:[1,0,0] neg_hi:[1,0,0]
  v_pk_fma_f32 v[188:189], v[50:51], v[72:73], v[188:189] op_sel:[1,0,0] neg_lo:[1,0,0] neg_hi:[1,0,0]
  v_pk_fma_f32 v[190:191], v[50:51], v[74:75], v[190:191] op_sel:[1,0,0] neg_lo:[1,0,0] neg_hi:[1,0,0]
  v_pk_fma_f32 v[28:29], v[28:29], v[12:13], s[64:65] op_sel_hi:[1,0,0]
  v_pk_fma_f32 v[30:31], v[30:31], v[12:13], s[64:65] op_sel_hi:[1,0,0]
  v_pk_fma_f32 v[32:33], v[32:33], v[12:13], s[64:65] op_sel_hi:[1,0,0]
  v_pk_fma_f32 v[34:35], v[34:35], v[12:13], s[64:65] op_sel_hi:[1,0,0]
  v_pk_mul_f32 v[184:185], v[54:55], v[184:185] op_sel_hi:[0,1]
  v_pk_mul_f32 v[186:187], v[54:55], v[186:187] op_sel_hi:[0,1]
  v_pk_mul_f32 v[188:189], v[54:55], v[188:189] op_sel:[1,0]
  v_pk_mul_f32 v[190:191], v[54:55], v[190:191] op_sel:[1,0]
  v_pk_mul_f32 v[28:29], v[28:29], v[168:169]
  v_pk_mul_f32 v[30:31], v[30:31], v[170:171]
  v_pk_mul_f32 v[32:33], v[32:33], v[172:173]
  v_pk_mul_f32 v[34:35], v[34:35], v[174:175]
  v_exp_f32 v28, v28
  v_exp_f32 v29, v29
  v_exp_f32 v30, v30
  v_exp_f32 v31, v31
  v_exp_f32 v32, v32
  v_exp_f32 v33, v33
  v_exp_f32 v34, v34
  v_exp_f32 v35, v35
  v_pk_mul_f32 v[184:185], v[168:169], v[184:185]
  v_pk_mul_f32 v[186:187], v[170:171], v[186:187]
  v_pk_mul_f32 v[188:189], v[172:173], v[188:189]
  v_pk_mul_f32 v[190:191], v[174:175], v[190:191]
  v_pk_add_f32 v[28:29], v[28:29], 1.0 op_sel_hi:[1,0]
  v_pk_add_f32 v[30:31], v[30:31], 1.0 op_sel_hi:[1,0]
  v_pk_add_f32 v[32:33], v[32:33], 1.0 op_sel_hi:[1,0]
  v_pk_add_f32 v[34:35], v[34:35], 1.0 op_sel_hi:[1,0]
  v_rcp_f32 v28, v28
  v_rcp_f32 v29, v29
  v_rcp_f32 v30, v30
  v_rcp_f32 v31, v31
  v_rcp_f32 v32, v32
  v_rcp_f32 v33, v33
  v_rcp_f32 v34, v34
  v_rcp_f32 v35, v35
  s_nop 0
  v_pk_mul_f32 v[184:185], v[28:29], v[184:185]
  v_pk_mul_f32 v[186:187], v[30:31], v[186:187]
  v_pk_mul_f32 v[188:189], v[32:33], v[188:189]
  v_pk_mul_f32 v[190:191], v[34:35], v[190:191]
  v_cvt_pk_bf16_f32 v96, v184, v185
  v_cvt_pk_bf16_f32 v97, v186, v187
  v_cvt_pk_bf16_f32 v98, v188, v189
  v_cvt_pk_bf16_f32 v99, v190, v191
  s_add_u32 m0, s68, 106496
  s_nop 0
  buffer_load_dwordx4 v41, s[20:23], s66 offen lds
  s_add_u32 s66, s66, 32768
  s_add_u32 m0, s68, 114688
  s_nop 0
  buffer_load_dwordx4 v41, s[20:23], s66 offen lds
  s_add_u32 s66, s66, 32768
  s_add_u32 m0, s68, 122880
  s_nop 0
  buffer_load_dwordx4 v41, s[20:23], s66 offen lds
  s_add_u32 s66, s66, 32768
  s_add_u32 m0, s68, 131072
  s_nop 0
  buffer_load_dwordx4 v41, s[20:23], s66 offen lds
  s_add_u32 s66, s66, 32768
  s_add_u32 m0, s68, 139264
  s_nop 0
  buffer_load_dwordx4 v41, s[20:23], s66 offen lds
  s_add_u32 s66, s66, 32768
  s_nop 1
  v_permlane16_swap_b32 v92, v94
  v_permlane16_swap_b32 v93, v95
  v_permlane16_swap_b32 v96, v98
  v_permlane16_swap_b32 v97, v99
  s_mov_b32 s63, 147456
  buffer_store_dwordx4 v[92:95], v14, s[32:35], 0 offen sc1
  buffer_store_dwordx4 v[96:99], v14, s[32:35], s63 offen sc1
  s_waitcnt lgkmcnt(0)
  v_permlane32_swap_b32 v192, v196
  v_permlane32_swap_b32 v193, v197
  v_permlane32_swap_b32 v194, v198
  v_permlane32_swap_b32 v195, v199
  v_permlane32_swap_b32 v200, v204
  v_permlane32_swap_b32 v201, v205
  v_permlane32_swap_b32 v202, v206
  v_permlane32_swap_b32 v203, v207
  v_bfe_u32 v21, v0, 4, 1
  v_lshlrev_b32 v21, 1, v21
  v_lshrrev_b32 v20, 5, v0
  v_add_u32 v20, v20, v21
  s_lshl_b32 s60, s40, 3
  s_add_u32 s60, s60, 0
  v_add_u32 v20, s60, v20
  v_mul_u32_u24 v20, 73728, v20
  v_and_b32 v21, 15, v0
  v_lshl_add_u32 v20, v21, 4, v20
  s_lshl_b32 s60, s51, 4
  s_lshl_b32 s61, s44, 8
  s_add_u32 s60, s60, s61
  s_add_u32 s60, s60, 16384
  v_add_u32 v15, s60, v20
  v_pk_fma_f32 v[192:193], v[56:57], v[76:77], v[192:193] op_sel_hi:[0,1,1] neg_lo:[1,0,0] neg_hi:[1,0,0]
  v_pk_fma_f32 v[194:195], v[56:57], v[78:79], v[194:195] op_sel_hi:[0,1,1] neg_lo:[1,0,0] neg_hi:[1,0,0]
  v_pk_fma_f32 v[200:201], v[56:57], v[76:77], v[200:201] op_sel:[1,0,0] neg_lo:[1,0,0] neg_hi:[1,0,0]
  v_pk_fma_f32 v[202:203], v[56:57], v[78:79], v[202:203] op_sel:[1,0,0] neg_lo:[1,0,0] neg_hi:[1,0,0]
  v_pk_mul_f32 v[192:193], v[58:59], v[192:193] op_sel_hi:[0,1]
  v_pk_mul_f32 v[194:195], v[58:59], v[194:195] op_sel_hi:[0,1]
  v_pk_mul_f32 v[200:201], v[58:59], v[200:201] op_sel:[1,0]
  v_pk_mul_f32 v[202:203], v[58:59], v[202:203] op_sel:[1,0]
  v_pk_mul_f32 v[28:29], v[192:193], v[192:193]
  v_pk_mul_f32 v[30:31], v[194:195], v[194:195]
  v_pk_mul_f32 v[32:33], v[200:201], v[200:201]
  v_pk_mul_f32 v[34:35], v[202:203], v[202:203]
  v_pk_fma_f32 v[196:197], v[56:57], v[80:81], v[196:197] op_sel_hi:[0,1,1] neg_lo:[1,0,0] neg_hi:[1,0,0]
  v_pk_fma_f32 v[198:199], v[56:57], v[82:83], v[198:199] op_sel_hi:[0,1,1] neg_lo:[1,0,0] neg_hi:[1,0,0]
  v_pk_fma_f32 v[204:205], v[56:57], v[80:81], v[204:205] op_sel:[1,0,0] neg_lo:[1,0,0] neg_hi:[1,0,0]
  v_pk_fma_f32 v[206:207], v[56:57], v[82:83], v[206:207] op_sel:[1,0,0] neg_lo:[1,0,0] neg_hi:[1,0,0]
  v_pk_fma_f32 v[28:29], v[28:29], v[12:13], s[64:65] op_sel_hi:[1,0,0]
  v_pk_fma_f32 v[30:31], v[30:31], v[12:13], s[64:65] op_sel_hi:[1,0,0]
  v_pk_fma_f32 v[32:33], v[32:33], v[12:13], s[64:65] op_sel_hi:[1,0,0]
  v_pk_fma_f32 v[34:35], v[34:35], v[12:13], s[64:65] op_sel_hi:[1,0,0]
  v_pk_mul_f32 v[196:197], v[58:59], v[196:197] op_sel_hi:[0,1]
  v_pk_mul_f32 v[198:199], v[58:59], v[198:199] op_sel_hi:[0,1]
  v_pk_mul_f32 v[204:205], v[58:59], v[204:205] op_sel:[1,0]
  v_pk_mul_f32 v[206:207], v[58:59], v[206:207] op_sel:[1,0]
  v_pk_mul_f32 v[28:29], v[28:29], v[192:193]
  v_pk_mul_f32 v[30:31], v[30:31], v[194:195]
  v_pk_mul_f32 v[32:33], v[32:33], v[200:201]
  v_pk_mul_f32 v[34:35], v[34:35], v[202:203]
  v_exp_f32 v28, v28
  v_exp_f32 v29, v29
  v_exp_f32 v30, v30
  v_exp_f32 v31, v31
  v_exp_f32 v32, v32
  v_exp_f32 v33, v33
  v_exp_f32 v34, v34
  v_exp_f32 v35, v35
  v_pk_mul_f32 v[196:197], v[192:193], v[196:197]
  v_pk_mul_f32 v[198:199], v[194:195], v[198:199]
  v_pk_mul_f32 v[204:205], v[200:201], v[204:205]
  v_pk_mul_f32 v[206:207], v[202:203], v[206:207]
  v_pk_add_f32 v[28:29], v[28:29], 1.0 op_sel_hi:[1,0]
  v_pk_add_f32 v[30:31], v[30:31], 1.0 op_sel_hi:[1,0]
  v_pk_add_f32 v[32:33], v[32:33], 1.0 op_sel_hi:[1,0]
  v_pk_add_f32 v[34:35], v[34:35], 1.0 op_sel_hi:[1,0]
  v_rcp_f32 v28, v28
  v_rcp_f32 v29, v29
  v_rcp_f32 v30, v30
  v_rcp_f32 v31, v31
  v_rcp_f32 v32, v32
  v_rcp_f32 v33, v33
  v_rcp_f32 v34, v34
  v_rcp_f32 v35, v35
  s_nop 0
  v_pk_mul_f32 v[196:197], v[28:29], v[196:197]
  v_pk_mul_f32 v[198:199], v[30:31], v[198:199]
  v_pk_mul_f32 v[204:205], v[32:33], v[204:205]
  v_pk_mul_f32 v[206:207], v[34:35], v[206:207]
  v_cvt_pk_bf16_f32 v100, v196, v197
  v_cvt_pk_bf16_f32 v101, v198, v199
  v_cvt_pk_bf16_f32 v102, v204, v205
  v_cvt_pk_bf16_f32 v103, v206, v207
  s_nop 1
  v_permlane16_swap_b32 v100, v102
  v_permlane16_swap_b32 v101, v103
  buffer_store_dwordx4 v[100:103], v15, s[32:35], 0 offen sc1
  s_branch P1_done
L_ev_3031:
  s_cmp_eq_u32 s56, 0
  s_cbranch_scc0 L_evo_4033
  v_mfma_f32_16x16x32_bf16 v[226:229], v[48:51], v[16:19], 0
  v_mfma_f32_16x16x32_bf16 v[230:233], v[52:55], v[16:19], 0
  v_mfma_f32_16x16x32_bf16 v[234:237], v[56:59], v[16:19], 0
  v_mfma_f32_16x16x32_bf16 v[238:241], v[60:63], v[16:19], 0
  v_mfma_f32_16x16x32_bf16 v[242:245], v[64:67], v[16:19], 0
  s_nop 7
  s_nop 1
  buffer_store_dwordx4 v[226:229], v42, s[32:35], 0 offen offset:0 sc1
  buffer_store_dwordx4 v[230:233], v42, s[32:35], 0 offen offset:256 sc1
  buffer_store_dwordx4 v[234:237], v42, s[32:35], 0 offen offset:512 sc1
  buffer_store_dwordx4 v[238:241], v42, s[32:35], 0 offen offset:768 sc1
  buffer_store_dwordx4 v[242:245], v42, s[32:35], 0 offen offset:1024 sc1
  s_branch L_evback_3032
L_evo_4033:
  s_cmp_eq_u32 s56, 1
  s_cbranch_scc0 L_evp_4034
  v_add_u32 v40, 1, v40
  s_lshl_b32 s60, s40, 7
  s_lshl_b32 s61, s41, 2
  s_add_u32 s60, s60, s61
  s_add_u32 s60, s60, 9830400
  s_lshl_b32 s61, s41, 7
  s_lshl_b32 s62, s40, 2
  s_add_u32 s61, s61, s62
  s_add_u32 s61, s61, 9832448
  v_mov_b32 v20, 0x7fffff00
  v_writelane_b32 v20, s60, 0
  v_writelane_b32 v20, s61, 1
  s_nop 1
  buffer_store_dword v40, v20, s[32:35], 0 offen sc1
  s_branch L_evback_3032
L_evp_4034:
  v_and_b32 v20, 15, v0
  s_lshl_b32 s60, s40, 7
  s_add_u32 s60, s60, 9830400
  v_lshl_add_u32 v43, v20, 2, s60
  s_lshl_b32 s61, s41, 7
  s_add_u32 s61, s61, 9832448
  v_lshl_add_u32 v21, v20, 2, s61
  v_lshrrev_b32 v22, 4, v0
  v_cmp_eq_u32 vcc, 2, v22
  s_nop 1
  v_cndmask_b32 v43, v43, v21, vcc
  s_cmp_eq_u32 s40, 0
  s_cselect_b32 s61, 0, 128
  s_sub_u32 s60, s60, s61
  s_add_u32 s60, s60, 56
  s_add_u32 s61, s60, 4
  v_writelane_b32 v43, s60, 16
  v_writelane_b32 v43, s61, 17
  s_nop 1
  buffer_load_dword v44, v43, s[32:35], 0 offen sc1
  s_branch L_evback_3032

L_ev_4036:
  v_mfma_f32_16x16x32_bf16 v[226:229], v[68:71], v[16:19], 0
  v_mfma_f32_16x16x32_bf16 v[230:233], v[72:75], v[16:19], 0
  v_mfma_f32_16x16x32_bf16 v[234:237], v[76:79], v[16:19], 0
  v_mfma_f32_16x16x32_bf16 v[238:241], v[80:83], v[16:19], 0
  v_mfma_f32_16x16x32_bf16 v[242:245], v[84:87], v[16:19], 0
  s_nop 7
  s_nop 1
  buffer_store_dwordx4 v[226:229], v42, s[32:35], 0 offen offset:0 sc1
  buffer_store_dwordx4 v[230:233], v42, s[32:35], 0 offen offset:256 sc1
  buffer_store_dwordx4 v[234:237], v42, s[32:35], 0 offen offset:512 sc1
  buffer_store_dwordx4 v[238:241], v42, s[32:35], 0 offen offset:768 sc1
  buffer_store_dwordx4 v[242:245], v42, s[32:35], 0 offen offset:1024 sc1
  s_branch L_evback_4037

L_chk_5039:
  v_cmp_ne_u32 vcc, v40, v44
  s_nop 1
  s_cmp_lg_u64 vcc, 0
  s_cbranch_scc1 L_early_slow_6041
L_early_ok_6042:
  s_branch L_chkback_5040

L_early_slow_6041:
  s_mov_b32 s3, 0
L_early_slow_6041_loop:
  buffer_load_dword v44, v43, s[32:35], 0 offen sc1
  s_add_u32 s3, s3, 1
  s_waitcnt vmcnt(0)
  v_cmp_ne_u32 vcc, v40, v44
  s_nop 1
  s_cmp_lg_u64 vcc, 0
  s_cbranch_scc0 L_early_ok_6042
  s_cmp_lt_u32 s3, 262144
  s_cbranch_scc1 L_early_slow_6041_loop
  s_branch L_early_ok_6042

P1_Y1:
  s_mul_i32 s60, s42, 320
  s_add_u32 s60, s60, 1024
  s_and_b32 s61, s42, 1
  s_lshl_b32 s61, s61, 6
  s_add_u32 s49, s60, s61
  s_add_u32 s50, s49, 128
  s_cmp_eq_u32 s61, 0
  s_cselect_b32 s61, 256, 0
  s_add_u32 s51, s60, s61
  v_lshrrev_b32 v20, 3, v0
  s_lshl_b32 s60, s44, 3
  v_add_u32 v20, s60, v20
  v_mul_u32_u24 v20, 3584, v20
  v_bfe_u32 v21, v0, 4, 1
  s_and_b32 s60, s44, 1
  s_lshl_b32 s60, s60, 1
  v_or_b32 v21, s60, v21
  v_bfe_u32 v22, v0, 1, 2
  v_xor_b32 v21, v21, v22
  v_lshl_add_u32 v20, v21, 5, v20
  v_and_b32 v22, 1, v0
  v_lshl_add_u32 v1, v22, 4, v20
  v_add_u32 v2, s50, v1
  v_add_u32 v1, s49, v1
  v_lshrrev_b32 v20, 2, v0
  s_and_b32 s60, s44, 1
  s_lshl_b32 s60, s60, 4
  v_add_u32 v20, s60, v20
  v_mul_u32_u24 v20, 3584, v20
  v_lshrrev_b32 v21, 5, v0
  s_and_b32 s60, s44, 2
  v_or_b32 v21, s60, v21
  v_and_b32 v22, 3, v0
  v_xor_b32 v21, v21, v22
  v_lshl_add_u32 v3, v21, 4, v20
  v_add_u32 v3, s51, v3
  s_mul_i32 s47, s47, 114688
  s_mov_b32 s24, s8
  s_and_b32 s25, s9, 0xffff
  s_mov_b32 s26, 0x1c0000
  s_mov_b32 s27, 0x20000
  s_mov_b32 s28, s10
  s_and_b32 s29, s11, 0xffff
  s_mov_b32 s30, 0x1c0000
  s_mov_b32 s31, 0x20000
  s_cmp_lt_u32 s44, 2
  s_cselect_b32 s36, s24, s28
  s_cselect_b32 s37, s25, s29
  s_mov_b32 s38, 0x1c0000
  s_mov_b32 s39, 0x20000
  s_add_u32 m0, s58, 12288
  s_nop 0
  buffer_load_dwordx4 v2, s[28:31], s47 offen lds
  s_add_u32 m0, s58, 16384
  s_nop 0
  buffer_load_dwordx4 v3, s[36:39], s47 offen lds
  s_add_u32 s47, s47, 114688
  s_cmp_eq_u32 s47, 1835008
  s_cselect_b32 s47, 0, s47
  s_add_u32 m0, s58, 32768
  s_nop 0
  buffer_load_dwordx4 v2, s[28:31], s47 offen lds
  s_add_u32 m0, s58, 36864
  s_nop 0
  buffer_load_dwordx4 v3, s[36:39], s47 offen lds
  s_add_u32 s47, s47, 114688
  s_cmp_eq_u32 s47, 1835008
  s_cselect_b32 s47, 0, s47
  s_mov_b32 s32, s12
  s_and_b32 s33, s13, 0xffff
  s_mov_b32 s34, 0x970000
  s_mov_b32 s35, 0x20000
  s_load_dwordx2 s[70:71], s[0:1], 16
  s_load_dwordx2 s[72:73], s[0:1], 48
  s_load_dwordx2 s[14:15], s[0:1], 56
  s_and_b32 s60, s2, 7
  s_lshr_b32 s61, s2, 3
  s_lshr_b32 s63, s61, 3
  s_lshl_b32 s69, s60, 2
  s_add_u32 s69, s69, s63
  s_and_b32 s74, s61, 7
  s_mov_b32 s54, 0
  s_mov_b32 s56, 0
  s_lshr_b32 s60, s40, 3
  s_lshl_b32 s60, 1, s60
  s_cmp_eq_u32 s45, 0
  s_cselect_b32 s57, s60, 0
  s_mov_b32 s59, 99
  s_cmp_eq_u32 s43, 0
  s_cselect_b32 s60, 0x110, 0
  s_cselect_b32 s59, 2, 99
  s_or_b32 s57, s57, s60
  v_mov_b32 v43, 9830400
  v_mov_b32 v47, 9830400
  v_mov_b32 v40, 0
  v_lshrrev_b32 v20, 3, v0
  v_lshrrev_b32 v21, 4, v0
  v_and_b32 v25, 15, v0
  v_lshrrev_b32 v26, 1, v25
  v_xor_b32 v26, v26, v21
  v_lshlrev_b32 v26, 4, v26
  v_lshl_add_u32 v26, v25, 7, v26
  v_add_u32 v6, 90112, v26
  v_xor_b32 v7, 64, v6
  v_bfe_u32 v27, v0, 2, 2
  v_lshl_add_u32 v27, v21, 3, v27
  v_and_b32 v28, 3, v20
  v_xor_b32 v28, s44, v28
  v_lshlrev_b32 v28, 5, v28
  v_lshl_add_u32 v28, v27, 7, v28
  v_and_b32 v29, 3, v0
  v_lshl_add_u32 v10, v29, 3, v28
  v_add_u32 v11, 61440, v10
  v_and_b32 v30, 1, v21
  v_and_b32 v31, 2, v29
  v_or_b32 v30, v30, v31
  v_xor_b32 v30, s44, v30
  v_lshlrev_b32 v30, 4, v30
  v_lshl_add_u32 v30, v27, 6, v30
  v_lshl_add_u32 v30, v31, 10, v30
  v_and_b32 v31, 1, v29
  v_lshl_add_u32 v30, v31, 3, v30
  v_add_u32 v12, 16384, v30
  v_add_u32 v13, 61440, v12
  v_mov_b32 v16, 0x3f803f80
  v_mov_b32 v17, 0x3f803f80
  v_mov_b32 v18, 0x3f803f80
  v_mov_b32 v19, 0x3f803f80
  v_mov_b32 v128, 0
  v_mov_b32 v129, 0
  v_mov_b32 v130, 0
  v_mov_b32 v131, 0
  v_mov_b32 v132, 0
  v_mov_b32 v133, 0
  v_mov_b32 v134, 0
  v_mov_b32 v135, 0
  v_mov_b32 v136, 0
  v_mov_b32 v137, 0
  v_mov_b32 v138, 0
  v_mov_b32 v139, 0
  v_mov_b32 v140, 0
  v_mov_b32 v141, 0
  v_mov_b32 v142, 0
  v_mov_b32 v143, 0
  v_mov_b32 v144, 0
  v_mov_b32 v145, 0
  v_mov_b32 v146, 0
  v_mov_b32 v147, 0
  v_mov_b32 v148, 0
  v_mov_b32 v149, 0
  v_mov_b32 v150, 0
  v_mov_b32 v151, 0
  v_mov_b32 v152, 0
  v_mov_b32 v153, 0
  v_mov_b32 v154, 0
  v_mov_b32 v155, 0
  v_mov_b32 v156, 0
  v_mov_b32 v157, 0
  v_mov_b32 v158, 0
  v_mov_b32 v159, 0
  v_mov_b32 v160, 0
  v_mov_b32 v161, 0
  v_mov_b32 v162, 0
  v_mov_b32 v163, 0
  v_mov_b32 v164, 0
  v_mov_b32 v165, 0
  v_mov_b32 v166, 0
  v_mov_b32 v167, 0
  v_mov_b32 v168, 0
  v_mov_b32 v169, 0
  v_mov_b32 v170, 0
  v_mov_b32 v171, 0
  v_mov_b32 v172, 0
  v_mov_b32 v173, 0
  v_mov_b32 v174, 0
  v_mov_b32 v175, 0
  v_mov_b32 v176, 0
  v_mov_b32 v177, 0
  v_mov_b32 v178, 0
  v_mov_b32 v179, 0
  v_mov_b32 v180, 0
  v_mov_b32 v181, 0
  v_mov_b32 v182, 0
  v_mov_b32 v183, 0
  v_mov_b32 v184, 0
  v_mov_b32 v185, 0
  v_mov_b32 v186, 0
  v_mov_b32 v187, 0
  v_mov_b32 v188, 0
  v_mov_b32 v189, 0
  v_mov_b32 v190, 0
  v_mov_b32 v191, 0
  v_mov_b32 v192, 0
  v_mov_b32 v193, 0
  v_mov_b32 v194, 0
  v_mov_b32 v195, 0
  v_mov_b32 v196, 0
  v_mov_b32 v197, 0
  v_mov_b32 v198, 0
  v_mov_b32 v199, 0
  v_mov_b32 v200, 0
  v_mov_b32 v201, 0
  v_mov_b32 v202, 0
  v_mov_b32 v203, 0
  v_mov_b32 v204, 0
  v_mov_b32 v205, 0
  v_mov_b32 v206, 0
  v_mov_b32 v207, 0
  v_lshlrev_b32 v24, 4, v0
  v_add_u32 v24, 149888, v24
  v_and_b32 v25, 48, v0
  s_lshl_b32 s60, s43, 6
  s_add_u32 s60, s60, 148608
  v_add_u32 v25, s60, v25
  v_and_b32 v26, 15, v0
  v_cmp_eq_u32 vcc, 0, v26
  s_lshl_b32 s61, s43, 6
  v_add_u32 v27, s61, v0
  v_cndmask_b32 v36, v24, v25, vcc
  s_cmp_lt_u32 s43, 4
  s_cselect_b64 s[64:65], vcc, 0
  v_add_u32 v25, 1024, v25
  v_cndmask_b32 v37, v24, v25, s[64:65]
  v_cmp_gt_u32 vcc, 144, v27
  v_lshlrev_b32 v27, 2, v27
  v_add_u32 v27, 147456, v27
  s_nop 0
  v_cndmask_b32 v38, v24, v27, vcc
  s_lshl_b32 s68, s45, 12
  s_lshl_b32 s60, s44, 10
  s_add_u32 s68, s68, s60
  v_lshrrev_b32 v24, 3, v0
  s_lshl_b32 s60, s44, 3
  v_add_u32 v24, s60, v24
  v_lshlrev_b32 v24, 10, v24
  v_bfe_u32 v25, v0, 4, 1
  s_and_b32 s60, s44, 1
  s_lshl_b32 s60, s60, 1
  v_or_b32 v25, s60, v25
  v_bfe_u32 v26, v0, 1, 2
  v_xor_b32 v25, v25, v26
  v_lshl_add_u32 v24, v25, 5, v24
  v_and_b32 v26, 1, v0
  v_lshl_add_u32 v24, v26, 4, v24
  s_lshl_b32 s60, s74, 7
  v_add_u32 v41, s60, v24
  s_add_u32 m0, s53, 0
  s_nop 0
  buffer_load_dwordx4 v4, s[16:19], s52 offen lds
  s_add_u32 m0, s53, 8192
  s_nop 0
  buffer_load_dwordx4 v5, s[16:19], s52 offen lds
  s_add_u32 s60, s52, 128
  s_and_b32 s60, s60, 0x380
  s_or_b32 s52, s60, s46
  s_add_u32 s53, s53, 0x4000
  s_cmp_eq_u32 s53, s75
  s_cselect_b32 s53, s48, s53
  s_waitcnt vmcnt(8)
  v_lshlrev_b32 v20, 16, v212
  v_and_b32 v21, 0xffff0000, v212
  v_lshlrev_b32 v22, 16, v213
  v_and_b32 v23, 0xffff0000, v213
  v_lshlrev_b32 v24, 16, v214
  v_and_b32 v25, 0xffff0000, v214
  v_lshlrev_b32 v26, 16, v215
  v_and_b32 v27, 0xffff0000, v215
  v_add_f32 v28, v20, v21
  v_add_f32 v29, v22, v23
  v_add_f32 v30, v24, v25
  v_add_f32 v31, v26, v27
  v_add_f32 v28, v28, v29
  v_add_f32 v30, v30, v31
  v_add_f32 v28, v28, v30
  s_nop 1
  v_add_f32_dpp v28, v28, v28 row_ror:8 row_mask:0xf bank_mask:0xf
  s_nop 1
  v_add_f32_dpp v28, v28, v28 row_ror:4 row_mask:0xf bank_mask:0xf
  s_nop 1
  v_add_f32_dpp v28, v28, v28 row_ror:2 row_mask:0xf bank_mask:0xf
  s_nop 1
  v_add_f32_dpp v28, v28, v28 row_ror:1 row_mask:0xf bank_mask:0xf
  s_nop 1
  v_mov_b32 v29, v28
  s_nop 1
  v_permlane16_swap_b32 v28, v29
  s_nop 1
  v_add_f32 v28, v28, v29
  s_nop 0
  v_mov_b32 v29, v28
  s_nop 1
  v_permlane32_swap_b32 v28, v29
  s_nop 1
  v_add_f32 v28, v28, v29
  s_nop 0
  v_mul_f32 v28, 0x3b000000, v28
  v_sub_f32 v20, v20, v28
  v_sub_f32 v21, v21, v28
  v_sub_f32 v22, v22, v28
  v_sub_f32 v23, v23, v28
  v_sub_f32 v24, v24, v28
  v_sub_f32 v25, v25, v28
  v_sub_f32 v26, v26, v28
  v_sub_f32 v27, v27, v28
  v_mul_f32 v29, v20, v20
  v_mul_f32 v30, v21, v21
  v_fmac_f32 v29, v22, v22
  v_fmac_f32 v30, v23, v23
  v_fmac_f32 v29, v24, v24
  v_fmac_f32 v30, v25, v25
  v_fmac_f32 v29, v26, v26
  v_fmac_f32 v30, v27, v27
  v_add_f32 v29, v29, v30
  s_nop 1
  v_add_f32_dpp v29, v29, v29 row_ror:8 row_mask:0xf bank_mask:0xf
  s_nop 1
  v_add_f32_dpp v29, v29, v29 row_ror:4 row_mask:0xf bank_mask:0xf
  s_nop 1
  v_add_f32_dpp v29, v29, v29 row_ror:2 row_mask:0xf bank_mask:0xf
  s_nop 1
  v_add_f32_dpp v29, v29, v29 row_ror:1 row_mask:0xf bank_mask:0xf
  s_nop 1
  v_mov_b32 v30, v29
  s_nop 1
  v_permlane16_swap_b32 v29, v30
  s_nop 1
  v_add_f32 v29, v29, v30
  s_nop 0
  v_mov_b32 v30, v29
  s_nop 1
  v_permlane32_swap_b32 v29, v30
  s_nop 1
  v_add_f32 v29, v29, v30
  s_nop 0
  v_mov_b32 v30, 0x3727c5ac
  v_fmac_f32 v30, 0x3b000000, v29
  v_rsq_f32 v29, v30
  s_lshl_b32 s60, s41, 3
  s_add_u32 s60, s60, s43
  s_lshl_b32 s61, s40, 7
  s_add_u32 s60, s60, s61
  s_lshl_b32 s60, s60, 3
  s_add_u32 s60, s60, 9437184
  v_mov_b32 v30, 0x7fffff00
  v_writelane_b32 v30, s60, 0
  s_nop 1
  buffer_store_dwordx2 v[28:29], v30, s[32:35], 0 offen sc1
  s_waitcnt vmcnt(3)
  s_barrier
  v_add_u32 v14, s54, v6
  ds_read_b64_tr_b16 v[48:49], v10 offset:0
  ds_read_b64_tr_b16 v[50:51], v10 offset:512
  ds_read_b64_tr_b16 v[52:53], v10 offset:4096
  ds_read_b64_tr_b16 v[54:55], v10 offset:4608
  ds_read_b128 v[88:91], v14 offset:0
  ds_read_b64_tr_b16 v[56:57], v10 offset:8192
  ds_read_b64_tr_b16 v[58:59], v10 offset:8704
  ds_read_b128 v[92:95], v14 offset:2048
  ds_read_b64_tr_b16 v[60:61], v10 offset:12288
  ds_read_b64_tr_b16 v[62:63], v10 offset:12800
  ds_read_b128 v[96:99], v14 offset:4096
  ds_read_b64_tr_b16 v[64:65], v12 offset:0
  ds_read_b64_tr_b16 v[66:67], v12 offset:256
  ds_read_b128 v[100:103], v14 offset:6144
  s_add_u32 m0, s58, 53248
  s_nop 0
  buffer_load_dwordx4 v2, s[28:31], s47 offen lds
  s_add_u32 m0, s58, 57344
  s_nop 0
  buffer_load_dwordx4 v3, s[36:39], s47 offen lds
  s_add_u32 s47, s47, 114688
  s_cmp_eq_u32 s47, 1835008
  s_cselect_b32 s47, 0, s47
  s_add_u32 m0, s58, 73728
  s_nop 0
  buffer_load_dwordx4 v2, s[28:31], s47 offen lds
  s_add_u32 m0, s58, 77824
  s_nop 0
  buffer_load_dwordx4 v3, s[36:39], s47 offen lds
  s_add_u32 s47, s47, 114688
  s_cmp_eq_u32 s47, 1835008
  s_cselect_b32 s47, 0, s47
  s_add_u32 m0, s53, 0
  s_nop 0
  buffer_load_dwordx4 v4, s[16:19], s52 offen lds
P1_Y1_loop:
  s_waitcnt vmcnt(6) lgkmcnt(0)
  s_barrier
  v_mfma_f32_16x16x32_bf16 v[128:131], v[48:51], v[88:91], v[128:131]
  v_add_u32 v14, s54, v7
  ds_read_b64_tr_b16 v[68:69], v10 offset:20480
  v_mfma_f32_16x16x32_bf16 v[144:147], v[52:55], v[88:91], v[144:147]
  ds_read_b64_tr_b16 v[70:71], v10 offset:20992
  v_mfma_f32_16x16x32_bf16 v[160:163], v[56:59], v[88:91], v[160:163]
  ds_read_b64_tr_b16 v[72:73], v10 offset:24576
  v_mfma_f32_16x16x32_bf16 v[176:179], v[60:63], v[88:91], v[176:179]
  ds_read_b64_tr_b16 v[74:75], v10 offset:25088
  v_mfma_f32_16x16x32_bf16 v[192:195], v[64:67], v[88:91], v[192:195]
  ds_read_b128 v[108:111], v14 offset:0
  s_add_u32 m0, s58, 12288
  v_mfma_f32_16x16x32_bf16 v[132:135], v[48:51], v[92:95], v[132:135]
  ds_read_b64_tr_b16 v[76:77], v10 offset:28672
  buffer_load_dwordx4 v2, s[28:31], s47 offen lds
  v_mfma_f32_16x16x32_bf16 v[148:151], v[52:55], v[92:95], v[148:151]
  ds_read_b64_tr_b16 v[78:79], v10 offset:29184
  v_mfma_f32_16x16x32_bf16 v[164:167], v[56:59], v[92:95], v[164:167]
  ds_read_b128 v[112:115], v14 offset:2048
  v_mfma_f32_16x16x32_bf16 v[180:183], v[60:63], v[92:95], v[180:183]
  ds_read_b64_tr_b16 v[80:81], v10 offset:32768
  v_mfma_f32_16x16x32_bf16 v[196:199], v[64:67], v[92:95], v[196:199]
  ds_read_b64_tr_b16 v[82:83], v10 offset:33280
  s_add_u32 m0, s58, 16384
  v_mfma_f32_16x16x32_bf16 v[136:139], v[48:51], v[96:99], v[136:139]
  ds_read_b128 v[116:119], v14 offset:4096
  buffer_load_dwordx4 v3, s[36:39], s47 offen lds
  v_mfma_f32_16x16x32_bf16 v[152:155], v[52:55], v[96:99], v[152:155]
  ds_read_b64_tr_b16 v[84:85], v12 offset:20480
  s_add_u32 s47, s47, 114688
  s_cmp_eq_u32 s47, 1835008
  s_cselect_b32 s47, 0, s47
  v_mfma_f32_16x16x32_bf16 v[168:171], v[56:59], v[96:99], v[168:171]
  ds_read_b64_tr_b16 v[86:87], v12 offset:20736
  v_mfma_f32_16x16x32_bf16 v[184:187], v[60:63], v[96:99], v[184:187]
  ds_read_b128 v[120:123], v14 offset:6144
  v_mfma_f32_16x16x32_bf16 v[200:203], v[64:67], v[96:99], v[200:203]
  s_add_u32 m0, s53, 8192
  v_mfma_f32_16x16x32_bf16 v[140:143], v[48:51], v[100:103], v[140:143]
  buffer_load_dwordx4 v5, s[16:19], s52 offen lds
  v_mfma_f32_16x16x32_bf16 v[156:159], v[52:55], v[100:103], v[156:159]
  s_add_u32 s60, s52, 128
  s_and_b32 s60, s60, 0x380
  s_or_b32 s52, s60, s46
  v_mfma_f32_16x16x32_bf16 v[172:175], v[56:59], v[100:103], v[172:175]
  s_add_u32 s53, s53, 0x4000
  s_cmp_eq_u32 s53, s75
  s_cselect_b32 s53, s48, s53
  v_mfma_f32_16x16x32_bf16 v[188:191], v[60:63], v[100:103], v[188:191]
  v_mfma_f32_16x16x32_bf16 v[204:207], v[64:67], v[100:103], v[204:207]
  s_waitcnt vmcnt(6) lgkmcnt(0)
  s_barrier
  v_mfma_f32_16x16x32_bf16 v[128:131], v[68:71], v[108:111], v[128:131]
  s_add_u32 s54, s54, 0x4000
  s_cmp_eq_u32 s54, 0xc000
  s_cselect_b32 s54, 0, s54
  ds_read_b64_tr_b16 v[48:49], v10 offset:40960
  v_mfma_f32_16x16x32_bf16 v[144:147], v[72:75], v[108:111], v[144:147]
  v_add_u32 v14, s54, v6
  ds_read_b64_tr_b16 v[50:51], v10 offset:41472
  v_mfma_f32_16x16x32_bf16 v[160:163], v[76:79], v[108:111], v[160:163]
  ds_read_b64_tr_b16 v[52:53], v10 offset:45056
  v_mfma_f32_16x16x32_bf16 v[176:179], v[80:83], v[108:111], v[176:179]
  ds_read_b64_tr_b16 v[54:55], v10 offset:45568
  v_mfma_f32_16x16x32_bf16 v[192:195], v[84:87], v[108:111], v[192:195]
  ds_read_b128 v[88:91], v14 offset:0
  s_add_u32 m0, s58, 32768
  v_mfma_f32_16x16x32_bf16 v[132:135], v[68:71], v[112:115], v[132:135]
  ds_read_b64_tr_b16 v[56:57], v10 offset:49152
  buffer_load_dwordx4 v2, s[28:31], s47 offen lds
  v_mfma_f32_16x16x32_bf16 v[148:151], v[72:75], v[112:115], v[148:151]
  ds_read_b64_tr_b16 v[58:59], v10 offset:49664
  v_mfma_f32_16x16x32_bf16 v[164:167], v[76:79], v[112:115], v[164:167]
  ds_read_b128 v[92:95], v14 offset:2048
  v_mfma_f32_16x16x32_bf16 v[180:183], v[80:83], v[112:115], v[180:183]
  ds_read_b64_tr_b16 v[60:61], v10 offset:53248
  v_mfma_f32_16x16x32_bf16 v[196:199], v[84:87], v[112:115], v[196:199]
  ds_read_b64_tr_b16 v[62:63], v10 offset:53760
  s_add_u32 m0, s58, 36864
  v_mfma_f32_16x16x32_bf16 v[136:139], v[68:71], v[116:119], v[136:139]
  ds_read_b128 v[96:99], v14 offset:4096
  buffer_load_dwordx4 v3, s[36:39], s47 offen lds
  v_mfma_f32_16x16x32_bf16 v[152:155], v[72:75], v[116:119], v[152:155]
  ds_read_b64_tr_b16 v[64:65], v12 offset:40960
  s_add_u32 s47, s47, 114688
  s_cmp_eq_u32 s47, 1835008
  s_cselect_b32 s47, 0, s47
  v_mfma_f32_16x16x32_bf16 v[168:171], v[76:79], v[116:119], v[168:171]
  ds_read_b64_tr_b16 v[66:67], v12 offset:41216
  v_mfma_f32_16x16x32_bf16 v[184:187], v[80:83], v[116:119], v[184:187]
  ds_read_b128 v[100:103], v14 offset:6144
  v_mfma_f32_16x16x32_bf16 v[200:203], v[84:87], v[116:119], v[200:203]
  s_add_u32 m0, s53, 0
  v_mfma_f32_16x16x32_bf16 v[140:143], v[68:71], v[120:123], v[140:143]
  buffer_load_dwordx4 v4, s[16:19], s52 offen lds
  v_mfma_f32_16x16x32_bf16 v[156:159], v[72:75], v[120:123], v[156:159]
  v_mfma_f32_16x16x32_bf16 v[172:175], v[76:79], v[120:123], v[172:175]
  v_mfma_f32_16x16x32_bf16 v[188:191], v[80:83], v[120:123], v[188:191]
  v_mfma_f32_16x16x32_bf16 v[204:207], v[84:87], v[120:123], v[204:207]
  s_waitcnt vmcnt(6) lgkmcnt(0)
  s_barrier
  v_mfma_f32_16x16x32_bf16 v[128:131], v[48:51], v[88:91], v[128:131]
  v_add_u32 v14, s54, v7
  ds_read_b64_tr_b16 v[68:69], v11 offset:0
  v_mfma_f32_16x16x32_bf16 v[144:147], v[52:55], v[88:91], v[144:147]
  ds_read_b64_tr_b16 v[70:71], v11 offset:512
  v_mfma_f32_16x16x32_bf16 v[160:163], v[56:59], v[88:91], v[160:163]
  ds_read_b64_tr_b16 v[72:73], v11 offset:4096
  v_mfma_f32_16x16x32_bf16 v[176:179], v[60:63], v[88:91], v[176:179]
  ds_read_b64_tr_b16 v[74:75], v11 offset:4608
  v_mfma_f32_16x16x32_bf16 v[192:195], v[64:67], v[88:91], v[192:195]
  ds_read_b128 v[108:111], v14 offset:0
  s_add_u32 m0, s58, 53248
  v_mfma_f32_16x16x32_bf16 v[132:135], v[48:51], v[92:95], v[132:135]
  ds_read_b64_tr_b16 v[76:77], v11 offset:8192
  buffer_load_dwordx4 v2, s[28:31], s47 offen lds
  v_mfma_f32_16x16x32_bf16 v[148:151], v[52:55], v[92:95], v[148:151]
  ds_read_b64_tr_b16 v[78:79], v11 offset:8704
  v_mfma_f32_16x16x32_bf16 v[164:167], v[56:59], v[92:95], v[164:167]
  ds_read_b128 v[112:115], v14 offset:2048
  v_mfma_f32_16x16x32_bf16 v[180:183], v[60:63], v[92:95], v[180:183]
  ds_read_b64_tr_b16 v[80:81], v11 offset:12288
  v_mfma_f32_16x16x32_bf16 v[196:199], v[64:67], v[92:95], v[196:199]
  ds_read_b64_tr_b16 v[82:83], v11 offset:12800
  s_add_u32 m0, s58, 57344
  v_mfma_f32_16x16x32_bf16 v[136:139], v[48:51], v[96:99], v[136:139]
  ds_read_b128 v[116:119], v14 offset:4096
  buffer_load_dwordx4 v3, s[36:39], s47 offen lds
  v_mfma_f32_16x16x32_bf16 v[152:155], v[52:55], v[96:99], v[152:155]
  ds_read_b64_tr_b16 v[84:85], v13 offset:0
  s_add_u32 s47, s47, 114688
  s_cmp_eq_u32 s47, 1835008
  s_cselect_b32 s47, 0, s47
  v_mfma_f32_16x16x32_bf16 v[168:171], v[56:59], v[96:99], v[168:171]
  ds_read_b64_tr_b16 v[86:87], v13 offset:256
  v_mfma_f32_16x16x32_bf16 v[184:187], v[60:63], v[96:99], v[184:187]
  ds_read_b128 v[120:123], v14 offset:6144
  v_mfma_f32_16x16x32_bf16 v[200:203], v[64:67], v[96:99], v[200:203]
  s_add_u32 m0, s53, 8192
  v_mfma_f32_16x16x32_bf16 v[140:143], v[48:51], v[100:103], v[140:143]
  buffer_load_dwordx4 v5, s[16:19], s52 offen lds
  v_mfma_f32_16x16x32_bf16 v[156:159], v[52:55], v[100:103], v[156:159]
  s_add_u32 s60, s52, 128
  s_and_b32 s60, s60, 0x380
  s_or_b32 s52, s60, s46
  v_mfma_f32_16x16x32_bf16 v[172:175], v[56:59], v[100:103], v[172:175]
  s_add_u32 s53, s53, 0x4000
  s_cmp_eq_u32 s53, s75
  s_cselect_b32 s53, s48, s53
  v_mfma_f32_16x16x32_bf16 v[188:191], v[60:63], v[100:103], v[188:191]
  v_mfma_f32_16x16x32_bf16 v[204:207], v[64:67], v[100:103], v[204:207]
  s_waitcnt vmcnt(6) lgkmcnt(0)
  s_barrier
  v_mfma_f32_16x16x32_bf16 v[128:131], v[68:71], v[108:111], v[128:131]
  s_add_u32 s54, s54, 0x4000
  s_cmp_eq_u32 s54, 0xc000
  s_cselect_b32 s54, 0, s54
  ds_read_b64_tr_b16 v[48:49], v10 offset:0
  v_mfma_f32_16x16x32_bf16 v[144:147], v[72:75], v[108:111], v[144:147]
  v_add_u32 v14, s54, v6
  ds_read_b64_tr_b16 v[50:51], v10 offset:512
  v_mfma_f32_16x16x32_bf16 v[160:163], v[76:79], v[108:111], v[160:163]
  ds_read_b64_tr_b16 v[52:53], v10 offset:4096
  v_mfma_f32_16x16x32_bf16 v[176:179], v[80:83], v[108:111], v[176:179]
  ds_read_b64_tr_b16 v[54:55], v10 offset:4608
  v_mfma_f32_16x16x32_bf16 v[192:195], v[84:87], v[108:111], v[192:195]
  ds_read_b128 v[88:91], v14 offset:0
  s_add_u32 m0, s58, 73728
  v_mfma_f32_16x16x32_bf16 v[132:135], v[68:71], v[112:115], v[132:135]
  ds_read_b64_tr_b16 v[56:57], v10 offset:8192
  buffer_load_dwordx4 v2, s[28:31], s47 offen lds
  v_mfma_f32_16x16x32_bf16 v[148:151], v[72:75], v[112:115], v[148:151]
  ds_read_b64_tr_b16 v[58:59], v10 offset:8704
  v_mfma_f32_16x16x32_bf16 v[164:167], v[76:79], v[112:115], v[164:167]
  ds_read_b128 v[92:95], v14 offset:2048
  v_mfma_f32_16x16x32_bf16 v[180:183], v[80:83], v[112:115], v[180:183]
  ds_read_b64_tr_b16 v[60:61], v10 offset:12288
  v_mfma_f32_16x16x32_bf16 v[196:199], v[84:87], v[112:115], v[196:199]
  ds_read_b64_tr_b16 v[62:63], v10 offset:12800
  s_add_u32 m0, s58, 77824
  v_mfma_f32_16x16x32_bf16 v[136:139], v[68:71], v[116:119], v[136:139]
  ds_read_b128 v[96:99], v14 offset:4096
  buffer_load_dwordx4 v3, s[36:39], s47 offen lds
  v_mfma_f32_16x16x32_bf16 v[152:155], v[72:75], v[116:119], v[152:155]
  ds_read_b64_tr_b16 v[64:65], v12 offset:0
  s_add_u32 s47, s47, 114688
  s_cmp_eq_u32 s47, 1835008
  s_cselect_b32 s47, 0, s47
  v_mfma_f32_16x16x32_bf16 v[168:171], v[76:79], v[116:119], v[168:171]
  ds_read_b64_tr_b16 v[66:67], v12 offset:256
  v_mfma_f32_16x16x32_bf16 v[184:187], v[80:83], v[116:119], v[184:187]
  ds_read_b128 v[100:103], v14 offset:6144
  v_mfma_f32_16x16x32_bf16 v[200:203], v[84:87], v[116:119], v[200:203]
  s_add_u32 m0, s53, 0
  v_mfma_f32_16x16x32_bf16 v[140:143], v[68:71], v[120:123], v[140:143]
  buffer_load_dwordx4 v4, s[16:19], s52 offen lds
  v_mfma_f32_16x16x32_bf16 v[156:159], v[72:75], v[120:123], v[156:159]
  v_mfma_f32_16x16x32_bf16 v[172:175], v[76:79], v[120:123], v[172:175]
  v_mfma_f32_16x16x32_bf16 v[188:191], v[80:83], v[120:123], v[188:191]
  v_mfma_f32_16x16x32_bf16 v[204:207], v[84:87], v[120:123], v[204:207]
  s_lshr_b32 s57, s57, 4
  s_add_u32 s56, s56, 1
  s_cmp_lt_u32 s56, 3
  s_cbranch_scc1 P1_Y1_loop
  s_waitcnt vmcnt(6) lgkmcnt(0)
  s_barrier
  v_mfma_f32_16x16x32_bf16 v[128:131], v[48:51], v[88:91], v[128:131]
  v_add_u32 v14, s54, v7
  ds_read_b64_tr_b16 v[68:69], v10 offset:20480
  s_mul_i32 s60, s41, 20480
  s_lshl_b32 s61, s43, 6
  s_add_u32 s60, s60, s61
  v_mfma_f32_16x16x32_bf16 v[144:147], v[52:55], v[88:91], v[144:147]
  ds_read_b64_tr_b16 v[70:71], v10 offset:20992
  s_add_u32 s60, s60, 9453568
  v_and_b32 v20, 15, v0
  v_mfma_f32_16x16x32_bf16 v[160:163], v[56:59], v[88:91], v[160:163]
  ds_read_b64_tr_b16 v[72:73], v10 offset:24576
  v_mul_u32_u24 v20, 1280, v20
  v_lshrrev_b32 v21, 4, v0
  v_mfma_f32_16x16x32_bf16 v[176:179], v[60:63], v[88:91], v[176:179]
  ds_read_b64_tr_b16 v[74:75], v10 offset:25088
  v_lshl_add_u32 v20, v21, 4, v20
  v_add_u32 v20, s60, v20
  buffer_load_dwordx4 v[212:215], v20, s[32:35], 0 offen sc1
  v_mfma_f32_16x16x32_bf16 v[192:195], v[64:67], v[88:91], v[192:195]
  ds_read_b128 v[108:111], v14 offset:0
  buffer_load_dwordx4 v[216:219], v20, s[32:35], 0 offen offset:512 sc1
  s_lshl_b32 s60, s43, 6
  v_mfma_f32_16x16x32_bf16 v[132:135], v[48:51], v[92:95], v[132:135]
  ds_read_b64_tr_b16 v[76:77], v10 offset:28672
  s_lshl_b32 s61, s40, 7
  s_add_u32 s60, s60, s61
  v_mfma_f32_16x16x32_bf16 v[148:151], v[52:55], v[92:95], v[148:151]
  ds_read_b64_tr_b16 v[78:79], v10 offset:29184
  s_sub_u32 s60, s60, 16
  v_add_u32 v22, s60, v0
  v_max_i32 v22, 0, v22
  v_mfma_f32_16x16x32_bf16 v[164:167], v[56:59], v[92:95], v[164:167]
  ds_read_b128 v[112:115], v14 offset:2048
  v_min_i32 v22, 2047, v22
  v_lshlrev_b32 v22, 3, v22
  v_mfma_f32_16x16x32_bf16 v[180:183], v[60:63], v[92:95], v[180:183]
  ds_read_b64_tr_b16 v[80:81], v10 offset:32768
  v_add_u32 v22, 9437184, v22
  buffer_load_dwordx2 v[224:225], v22, s[32:35], 0 offen sc1
  v_mfma_f32_16x16x32_bf16 v[196:199], v[64:67], v[92:95], v[196:199]
  ds_read_b64_tr_b16 v[82:83], v10 offset:33280
  v_mfma_f32_16x16x32_bf16 v[136:139], v[48:51], v[96:99], v[136:139]
  ds_read_b128 v[116:119], v14 offset:4096
  v_mfma_f32_16x16x32_bf16 v[152:155], v[52:55], v[96:99], v[152:155]
  ds_read_b64_tr_b16 v[84:85], v12 offset:20480
  v_mfma_f32_16x16x32_bf16 v[168:171], v[56:59], v[96:99], v[168:171]
  ds_read_b64_tr_b16 v[86:87], v12 offset:20736
  v_mfma_f32_16x16x32_bf16 v[184:187], v[60:63], v[96:99], v[184:187]
  ds_read_b128 v[120:123], v14 offset:6144
  v_mfma_f32_16x16x32_bf16 v[200:203], v[64:67], v[96:99], v[200:203]
  v_mfma_f32_16x16x32_bf16 v[140:143], v[48:51], v[100:103], v[140:143]
  v_mfma_f32_16x16x32_bf16 v[156:159], v[52:55], v[100:103], v[156:159]
  v_mfma_f32_16x16x32_bf16 v[172:175], v[56:59], v[100:103], v[172:175]
  v_mfma_f32_16x16x32_bf16 v[188:191], v[60:63], v[100:103], v[188:191]
  v_mfma_f32_16x16x32_bf16 v[204:207], v[64:67], v[100:103], v[204:207]
  s_cmp_lt_u32 s43, 5
  s_cbranch_scc0 L_tch_6048
  s_mov_b32 s61, s43
  s_lshr_b32 s60, s2, 3
  s_mul_i32 s60, s60, 5
  s_add_u32 s60, s60, s61
  s_min_u32 s60, s60, 143
  s_add_u32 s61, s60, 64
  s_add_u32 s62, s60, 72
  s_cmp_lt_u32 s60, 72
  s_cselect_b32 s60, s61, s62
  s_lshl_b32 s60, s60, 13
  v_lshlrev_b32 v23, 7, v0
  v_add_u32 v23, s60, v23
  global_load_dword v45, v23, s[72:73]
L_tch_6048:
  s_waitcnt vmcnt(6) lgkmcnt(0)
  s_barrier
  v_mfma_f32_16x16x32_bf16 v[128:131], v[68:71], v[108:111], v[128:131]
  s_add_u32 s54, s54, 0x4000
  s_cmp_eq_u32 s54, 0xc000
  s_cselect_b32 s54, 0, s54
  ds_read_b64_tr_b16 v[48:49], v10 offset:40960
  v_mfma_f32_16x16x32_bf16 v[144:147], v[72:75], v[108:111], v[144:147]
  v_add_u32 v14, s54, v6
  ds_read_b64_tr_b16 v[50:51], v10 offset:41472
  v_mfma_f32_16x16x32_bf16 v[160:163], v[76:79], v[108:111], v[160:163]
  ds_read_b64_tr_b16 v[52:53], v10 offset:45056
  v_mfma_f32_16x16x32_bf16 v[176:179], v[80:83], v[108:111], v[176:179]
  ds_read_b64_tr_b16 v[54:55], v10 offset:45568
  s_mov_b32 s20, s72
  v_mfma_f32_16x16x32_bf16 v[192:195], v[84:87], v[108:111], v[192:195]
  ds_read_b128 v[88:91], v14 offset:0
  v_mfma_f32_16x16x32_bf16 v[132:135], v[68:71], v[112:115], v[132:135]
  ds_read_b64_tr_b16 v[56:57], v10 offset:49152
  s_and_b32 s21, s73, 0xffff
  v_mfma_f32_16x16x32_bf16 v[148:151], v[72:75], v[112:115], v[148:151]
  ds_read_b64_tr_b16 v[58:59], v10 offset:49664
  v_mfma_f32_16x16x32_bf16 v[164:167], v[76:79], v[112:115], v[164:167]
  ds_read_b128 v[92:95], v14 offset:2048
  v_mfma_f32_16x16x32_bf16 v[180:183], v[80:83], v[112:115], v[180:183]
  ds_read_b64_tr_b16 v[60:61], v10 offset:53248
  s_mov_b32 s22, 0x1c0000
  v_mfma_f32_16x16x32_bf16 v[196:199], v[84:87], v[112:115], v[196:199]
  ds_read_b64_tr_b16 v[62:63], v10 offset:53760
  v_mfma_f32_16x16x32_bf16 v[136:139], v[68:71], v[116:119], v[136:139]
  ds_read_b128 v[96:99], v14 offset:4096
  v_mfma_f32_16x16x32_bf16 v[152:155], v[72:75], v[116:119], v[152:155]
  ds_read_b64_tr_b16 v[64:65], v12 offset:40960
  s_mov_b32 s23, 0x20000
  v_mfma_f32_16x16x32_bf16 v[168:171], v[76:79], v[116:119], v[168:171]
  ds_read_b64_tr_b16 v[66:67], v12 offset:41216
  v_mfma_f32_16x16x32_bf16 v[184:187], v[80:83], v[116:119], v[184:187]
  ds_read_b128 v[100:103], v14 offset:6144
  v_mfma_f32_16x16x32_bf16 v[200:203], v[84:87], v[116:119], v[200:203]
  s_mul_i32 s66, s45, 655360
  v_mfma_f32_16x16x32_bf16 v[140:143], v[68:71], v[120:123], v[140:143]
  v_mfma_f32_16x16x32_bf16 v[156:159], v[72:75], v[120:123], v[156:159]
  v_mfma_f32_16x16x32_bf16 v[172:175], v[76:79], v[120:123], v[172:175]
  s_add_u32 s66, s66, 524288
  v_mfma_f32_16x16x32_bf16 v[188:191], v[80:83], v[120:123], v[188:191]
  v_mfma_f32_16x16x32_bf16 v[204:207], v[84:87], v[120:123], v[204:207]
  s_cmp_eq_u32 s43, 4
  s_cbranch_scc0 L_wbn_6050
  s_waitcnt vmcnt(4)
  s_branch L_wbw_6049
L_wbn_6050:
  s_waitcnt vmcnt(3)
L_wbw_6049:
  s_waitcnt vmcnt(63) lgkmcnt(0)
  s_barrier
  v_mfma_f32_16x16x32_bf16 v[128:131], v[48:51], v[88:91], v[128:131]
  v_add_u32 v14, s54, v7
  ds_read_b64_tr_b16 v[68:69], v11 offset:0
  v_mfma_f32_16x16x32_bf16 v[144:147], v[52:55], v[88:91], v[144:147]
  ds_read_b64_tr_b16 v[70:71], v11 offset:512
  v_mfma_f32_16x16x32_bf16 v[160:163], v[56:59], v[88:91], v[160:163]
  ds_read_b64_tr_b16 v[72:73], v11 offset:4096
  v_mfma_f32_16x16x32_bf16 v[176:179], v[60:63], v[88:91], v[176:179]
  ds_read_b64_tr_b16 v[74:75], v11 offset:4608
  v_mfma_f32_16x16x32_bf16 v[192:195], v[64:67], v[88:91], v[192:195]
  ds_read_b128 v[108:111], v14 offset:0
  v_mfma_f32_16x16x32_bf16 v[132:135], v[48:51], v[92:95], v[132:135]
  ds_read_b64_tr_b16 v[76:77], v11 offset:8192
  v_mfma_f32_16x16x32_bf16 v[148:151], v[52:55], v[92:95], v[148:151]
  ds_read_b64_tr_b16 v[78:79], v11 offset:8704
  v_mfma_f32_16x16x32_bf16 v[164:167], v[56:59], v[92:95], v[164:167]
  ds_read_b128 v[112:115], v14 offset:2048
  v_mfma_f32_16x16x32_bf16 v[180:183], v[60:63], v[92:95], v[180:183]
  ds_read_b64_tr_b16 v[80:81], v11 offset:12288
  v_mfma_f32_16x16x32_bf16 v[196:199], v[64:67], v[92:95], v[196:199]
  ds_read_b64_tr_b16 v[82:83], v11 offset:12800
  v_mfma_f32_16x16x32_bf16 v[136:139], v[48:51], v[96:99], v[136:139]
  ds_read_b128 v[116:119], v14 offset:4096
  v_mfma_f32_16x16x32_bf16 v[152:155], v[52:55], v[96:99], v[152:155]
  ds_read_b64_tr_b16 v[84:85], v13 offset:0
  v_mfma_f32_16x16x32_bf16 v[168:171], v[56:59], v[96:99], v[168:171]
  ds_read_b64_tr_b16 v[86:87], v13 offset:256
  v_mfma_f32_16x16x32_bf16 v[184:187], v[60:63], v[96:99], v[184:187]
  ds_read_b128 v[120:123], v14 offset:6144
  v_mfma_f32_16x16x32_bf16 v[200:203], v[64:67], v[96:99], v[200:203]
  v_mfma_f32_16x16x32_bf16 v[140:143], v[48:51], v[100:103], v[140:143]
  v_mfma_f32_16x16x32_bf16 v[156:159], v[52:55], v[100:103], v[156:159]
  v_mfma_f32_16x16x32_bf16 v[172:175], v[56:59], v[100:103], v[172:175]
  v_mfma_f32_16x16x32_bf16 v[188:191], v[60:63], v[100:103], v[188:191]
  v_mfma_f32_16x16x32_bf16 v[204:207], v[64:67], v[100:103], v[204:207]
  s_cmp_ge_u32 s43, 3
  s_cbranch_scc0 L_tch_6051
  s_sub_u32 s61, s43, 3
  s_lshr_b32 s60, s2, 3
  s_mul_i32 s60, s60, 5
  s_add_u32 s60, s60, s61
  s_min_u32 s60, s60, 143
  s_add_u32 s61, s60, 136
  s_add_u32 s62, s60, 208
  s_cmp_lt_u32 s60, 8
  s_cselect_b32 s61, s61, s62
  s_sub_u32 s62, s60, 16
  s_cmp_lt_u32 s60, 16
  s_cselect_b32 s61, s61, s62
  s_sub_u32 s62, s60, 80
  s_cmp_lt_u32 s60, 80
  s_cselect_b32 s61, s61, s62
  s_sub_u32 s62, s60, 16
  s_cmp_lt_u32 s62, 64
  s_cselect_b32 s64, s70, s72
  s_cselect_b32 s65, s71, s73
  s_mov_b32 s60, s61
  s_lshl_b32 s60, s60, 13
  v_lshlrev_b32 v23, 7, v0
  v_add_u32 v23, s60, v23
  global_load_dword v46, v23, s[64:65]
L_tch_6051:
  s_cmp_eq_u32 s43, 4
  s_cbranch_scc0 L_wbn_6053
  s_waitcnt vmcnt(2)
  s_branch L_wbw_6052
L_wbn_6053:
  s_waitcnt vmcnt(1)
L_wbw_6052:
  s_waitcnt vmcnt(63) lgkmcnt(0)
  s_barrier
  v_mfma_f32_16x16x32_bf16 v[128:131], v[68:71], v[108:111], v[128:131]
  v_add_f32_dpp v212, v212, v212 row_ror:8 row_mask:0xf bank_mask:0xf
  v_add_f32_dpp v213, v213, v213 row_ror:8 row_mask:0xf bank_mask:0xf
  v_mfma_f32_16x16x32_bf16 v[144:147], v[72:75], v[108:111], v[144:147]
  v_add_f32_dpp v214, v214, v214 row_ror:8 row_mask:0xf bank_mask:0xf
  v_add_f32_dpp v215, v215, v215 row_ror:8 row_mask:0xf bank_mask:0xf
  v_mfma_f32_16x16x32_bf16 v[160:163], v[76:79], v[108:111], v[160:163]
  v_add_f32_dpp v216, v216, v216 row_ror:8 row_mask:0xf bank_mask:0xf
  v_add_f32_dpp v217, v217, v217 row_ror:8 row_mask:0xf bank_mask:0xf
  v_mfma_f32_16x16x32_bf16 v[176:179], v[80:83], v[108:111], v[176:179]
  v_add_f32_dpp v218, v218, v218 row_ror:8 row_mask:0xf bank_mask:0xf
  v_add_f32_dpp v219, v219, v219 row_ror:8 row_mask:0xf bank_mask:0xf
  v_mfma_f32_16x16x32_bf16 v[192:195], v[84:87], v[108:111], v[192:195]
  v_add_f32_dpp v212, v212, v212 row_ror:4 row_mask:0xf bank_mask:0xf
  v_mfma_f32_16x16x32_bf16 v[132:135], v[68:71], v[112:115], v[132:135]
  v_add_f32_dpp v213, v213, v213 row_ror:4 row_mask:0xf bank_mask:0xf
  v_add_f32_dpp v214, v214, v214 row_ror:4 row_mask:0xf bank_mask:0xf
  v_mfma_f32_16x16x32_bf16 v[148:151], v[72:75], v[112:115], v[148:151]
  v_add_f32_dpp v215, v215, v215 row_ror:4 row_mask:0xf bank_mask:0xf
  v_add_f32_dpp v216, v216, v216 row_ror:4 row_mask:0xf bank_mask:0xf
  v_mfma_f32_16x16x32_bf16 v[164:167], v[76:79], v[112:115], v[164:167]
  v_add_f32_dpp v217, v217, v217 row_ror:4 row_mask:0xf bank_mask:0xf
  v_add_f32_dpp v218, v218, v218 row_ror:4 row_mask:0xf bank_mask:0xf
  v_mfma_f32_16x16x32_bf16 v[180:183], v[80:83], v[112:115], v[180:183]
  v_add_f32_dpp v219, v219, v219 row_ror:4 row_mask:0xf bank_mask:0xf
  v_mfma_f32_16x16x32_bf16 v[196:199], v[84:87], v[112:115], v[196:199]
  v_add_f32_dpp v212, v212, v212 row_ror:2 row_mask:0xf bank_mask:0xf
  v_add_f32_dpp v213, v213, v213 row_ror:2 row_mask:0xf bank_mask:0xf
  v_mfma_f32_16x16x32_bf16 v[136:139], v[68:71], v[116:119], v[136:139]
  v_add_f32_dpp v214, v214, v214 row_ror:2 row_mask:0xf bank_mask:0xf
  v_add_f32_dpp v215, v215, v215 row_ror:2 row_mask:0xf bank_mask:0xf
  v_mfma_f32_16x16x32_bf16 v[152:155], v[72:75], v[116:119], v[152:155]
  v_add_f32_dpp v216, v216, v216 row_ror:2 row_mask:0xf bank_mask:0xf
  v_add_f32_dpp v217, v217, v217 row_ror:2 row_mask:0xf bank_mask:0xf
  v_mfma_f32_16x16x32_bf16 v[168:171], v[76:79], v[116:119], v[168:171]
  v_add_f32_dpp v218, v218, v218 row_ror:2 row_mask:0xf bank_mask:0xf
  v_add_f32_dpp v219, v219, v219 row_ror:2 row_mask:0xf bank_mask:0xf
  v_mfma_f32_16x16x32_bf16 v[184:187], v[80:83], v[116:119], v[184:187]
  v_add_f32_dpp v212, v212, v212 row_ror:1 row_mask:0xf bank_mask:0xf
  v_mfma_f32_16x16x32_bf16 v[200:203], v[84:87], v[116:119], v[200:203]
  v_add_f32_dpp v213, v213, v213 row_ror:1 row_mask:0xf bank_mask:0xf
  v_add_f32_dpp v214, v214, v214 row_ror:1 row_mask:0xf bank_mask:0xf
  v_mfma_f32_16x16x32_bf16 v[140:143], v[68:71], v[120:123], v[140:143]
  v_add_f32_dpp v215, v215, v215 row_ror:1 row_mask:0xf bank_mask:0xf
  v_add_f32_dpp v216, v216, v216 row_ror:1 row_mask:0xf bank_mask:0xf
  v_mfma_f32_16x16x32_bf16 v[156:159], v[72:75], v[120:123], v[156:159]
  v_add_f32_dpp v217, v217, v217 row_ror:1 row_mask:0xf bank_mask:0xf
  v_add_f32_dpp v218, v218, v218 row_ror:1 row_mask:0xf bank_mask:0xf
  v_mfma_f32_16x16x32_bf16 v[172:175], v[76:79], v[120:123], v[172:175]
  v_add_f32_dpp v219, v219, v219 row_ror:1 row_mask:0xf bank_mask:0xf
  v_mfma_f32_16x16x32_bf16 v[188:191], v[80:83], v[120:123], v[188:191]
  v_mfma_f32_16x16x32_bf16 v[204:207], v[84:87], v[120:123], v[204:207]
  ds_write_b128 v36, v[212:215]
  ds_write_b128 v36, v[216:219] offset:512
  ds_write_b128 v37, v[220:223]
  ds_write_b32 v38, v224 offset:0
  ds_write_b32 v38, v225 offset:576
  s_waitcnt lgkmcnt(0)
  s_barrier
  v_and_b32 v20, 15, v0
  v_lshlrev_b32 v10, 2, v20
  v_add_u32 v10, 147456, v10
  v_and_b32 v11, 48, v0
  v_add_u32 v11, 147456, v11
  s_lshl_b32 s60, s44, 6
  v_add_u32 v22, s60, v11
  ds_read_b128 v[60:63], v22 offset:1152
  ds_read_b128 v[64:67], v22 offset:1408
  ds_read_b32 v48, v10 offset:320
  ds_read_b32 v52, v10 offset:896
  ds_read_b32 v49, v10 offset:384
  ds_read_b32 v53, v10 offset:960
  ds_read_b32 v50, v10 offset:448
  ds_read_b32 v54, v10 offset:1024
  ds_read_b32 v51, v10 offset:512
  ds_read_b32 v55, v10 offset:1088
  ds_read_b128 v[68:71], v22 offset:1664
  ds_read_b128 v[72:75], v22 offset:1920
  v_lshrrev_b32 v23, 5, v0
  v_lshl_add_u32 v23, v23, 6, v10
  v_and_b32 v24, 16, v0
  v_add_u32 v24, s60, v24
  v_add_u32 v24, 147456, v24
  v_mov_b32 v12, 0xbdd2d3e8
  s_mov_b32 s64, 0xc0135761
  s_waitcnt lgkmcnt(0)
  ds_read_b32 v56, v23 offset:320
  ds_read_b32 v58, v23 offset:896
  ds_read_b32 v57, v23 offset:448
  ds_read_b32 v59, v23 offset:1024
  ds_read_b128 v[76:79], v24 offset:2176
  ds_read_b128 v[80:83], v24 offset:2208
  v_bfe_u32 v21, v0, 4, 1
  s_lshl_b32 s60, s40, 3
  s_add_u32 s60, s60, 4
  v_add_u32 v21, s60, v21
  v_mul_u32_u24 v21, 73728, v21
  v_lshrrev_b32 v20, 5, v0
  v_lshl_add_u32 v21, v20, 8, v21
  v_and_b32 v20, 15, v0
  v_lshl_add_u32 v25, v20, 4, v21
  s_lshl_b32 s60, s49, 4
  s_lshl_b32 s61, s44, 9
  s_add_u32 s60, s60, s61
  s_add_u32 s60, s60, 16384
  v_add_u32 v13, s60, v25
  v_add_u32 v14, 2048, v13
  v_pk_fma_f32 v[128:129], v[48:49], v[60:61], v[128:129] op_sel_hi:[0,1,1] neg_lo:[1,0,0] neg_hi:[1,0,0]
  v_pk_fma_f32 v[130:131], v[48:49], v[62:63], v[130:131] op_sel_hi:[0,1,1] neg_lo:[1,0,0] neg_hi:[1,0,0]
  v_pk_fma_f32 v[132:133], v[48:49], v[60:61], v[132:133] op_sel:[1,0,0] neg_lo:[1,0,0] neg_hi:[1,0,0]
  v_pk_fma_f32 v[134:135], v[48:49], v[62:63], v[134:135] op_sel:[1,0,0] neg_lo:[1,0,0] neg_hi:[1,0,0]
  v_pk_mul_f32 v[128:129], v[52:53], v[128:129] op_sel_hi:[0,1]
  v_pk_mul_f32 v[130:131], v[52:53], v[130:131] op_sel_hi:[0,1]
  v_pk_mul_f32 v[132:133], v[52:53], v[132:133] op_sel:[1,0]
  v_pk_mul_f32 v[134:135], v[52:53], v[134:135] op_sel:[1,0]
  v_pk_mul_f32 v[28:29], v[128:129], v[128:129]
  v_pk_mul_f32 v[30:31], v[130:131], v[130:131]
  v_pk_mul_f32 v[32:33], v[132:133], v[132:133]
  v_pk_mul_f32 v[34:35], v[134:135], v[134:135]
  v_pk_fma_f32 v[144:145], v[48:49], v[64:65], v[144:145] op_sel_hi:[0,1,1] neg_lo:[1,0,0] neg_hi:[1,0,0]
  v_pk_fma_f32 v[146:147], v[48:49], v[66:67], v[146:147] op_sel_hi:[0,1,1] neg_lo:[1,0,0] neg_hi:[1,0,0]
  v_pk_fma_f32 v[148:149], v[48:49], v[64:65], v[148:149] op_sel:[1,0,0] neg_lo:[1,0,0] neg_hi:[1,0,0]
  v_pk_fma_f32 v[150:151], v[48:49], v[66:67], v[150:151] op_sel:[1,0,0] neg_lo:[1,0,0] neg_hi:[1,0,0]
  v_pk_fma_f32 v[28:29], v[28:29], v[12:13], s[64:65] op_sel_hi:[1,0,0]
  v_pk_fma_f32 v[30:31], v[30:31], v[12:13], s[64:65] op_sel_hi:[1,0,0]
  v_pk_fma_f32 v[32:33], v[32:33], v[12:13], s[64:65] op_sel_hi:[1,0,0]
  v_pk_fma_f32 v[34:35], v[34:35], v[12:13], s[64:65] op_sel_hi:[1,0,0]
  v_pk_mul_f32 v[144:145], v[52:53], v[144:145] op_sel_hi:[0,1]
  v_pk_mul_f32 v[146:147], v[52:53], v[146:147] op_sel_hi:[0,1]
  v_pk_mul_f32 v[148:149], v[52:53], v[148:149] op_sel:[1,0]
  v_pk_mul_f32 v[150:151], v[52:53], v[150:151] op_sel:[1,0]
  v_pk_mul_f32 v[28:29], v[28:29], v[128:129]
  v_pk_mul_f32 v[30:31], v[30:31], v[130:131]
  v_pk_mul_f32 v[32:33], v[32:33], v[132:133]
  v_pk_mul_f32 v[34:35], v[34:35], v[134:135]
  v_exp_f32 v28, v28
  v_exp_f32 v29, v29
  v_exp_f32 v30, v30
  v_exp_f32 v31, v31
  v_exp_f32 v32, v32
  v_exp_f32 v33, v33
  v_exp_f32 v34, v34
  v_exp_f32 v35, v35
  v_pk_mul_f32 v[144:145], v[128:129], v[144:145]
  v_pk_mul_f32 v[146:147], v[130:131], v[146:147]
  v_pk_mul_f32 v[148:149], v[132:133], v[148:149]
  v_pk_mul_f32 v[150:151], v[134:135], v[150:151]
  v_pk_add_f32 v[28:29], v[28:29], 1.0 op_sel_hi:[1,0]
  v_pk_add_f32 v[30:31], v[30:31], 1.0 op_sel_hi:[1,0]
  v_pk_add_f32 v[32:33], v[32:33], 1.0 op_sel_hi:[1,0]
  v_pk_add_f32 v[34:35], v[34:35], 1.0 op_sel_hi:[1,0]
  v_rcp_f32 v28, v28
  v_rcp_f32 v29, v29
  v_rcp_f32 v30, v30
  v_rcp_f32 v31, v31
  v_rcp_f32 v32, v32
  v_rcp_f32 v33, v33
  v_rcp_f32 v34, v34
  v_rcp_f32 v35, v35
  s_nop 0
  v_pk_mul_f32 v[144:145], v[28:29], v[144:145]
  v_pk_mul_f32 v[146:147], v[30:31], v[146:147]
  v_pk_mul_f32 v[148:149], v[32:33], v[148:149]
  v_pk_mul_f32 v[150:151], v[34:35], v[150:151]
  v_cvt_pk_bf16_f32 v84, v144, v145
  v_cvt_pk_bf16_f32 v85, v146, v147
  v_cvt_pk_bf16_f32 v86, v148, v149
  v_cvt_pk_bf16_f32 v87, v150, v151
  v_pk_fma_f32 v[136:137], v[50:51], v[60:61], v[136:137] op_sel_hi:[0,1,1] neg_lo:[1,0,0] neg_hi:[1,0,0]
  v_pk_fma_f32 v[138:139], v[50:51], v[62:63], v[138:139] op_sel_hi:[0,1,1] neg_lo:[1,0,0] neg_hi:[1,0,0]
  v_pk_fma_f32 v[140:141], v[50:51], v[60:61], v[140:141] op_sel:[1,0,0] neg_lo:[1,0,0] neg_hi:[1,0,0]
  v_pk_fma_f32 v[142:143], v[50:51], v[62:63], v[142:143] op_sel:[1,0,0] neg_lo:[1,0,0] neg_hi:[1,0,0]
  v_pk_mul_f32 v[136:137], v[54:55], v[136:137] op_sel_hi:[0,1]
  v_pk_mul_f32 v[138:139], v[54:55], v[138:139] op_sel_hi:[0,1]
  v_pk_mul_f32 v[140:141], v[54:55], v[140:141] op_sel:[1,0]
  v_pk_mul_f32 v[142:143], v[54:55], v[142:143] op_sel:[1,0]
  v_pk_mul_f32 v[28:29], v[136:137], v[136:137]
  v_pk_mul_f32 v[30:31], v[138:139], v[138:139]
  v_pk_mul_f32 v[32:33], v[140:141], v[140:141]
  v_pk_mul_f32 v[34:35], v[142:143], v[142:143]
  v_pk_fma_f32 v[152:153], v[50:51], v[64:65], v[152:153] op_sel_hi:[0,1,1] neg_lo:[1,0,0] neg_hi:[1,0,0]
  v_pk_fma_f32 v[154:155], v[50:51], v[66:67], v[154:155] op_sel_hi:[0,1,1] neg_lo:[1,0,0] neg_hi:[1,0,0]
  v_pk_fma_f32 v[156:157], v[50:51], v[64:65], v[156:157] op_sel:[1,0,0] neg_lo:[1,0,0] neg_hi:[1,0,0]
  v_pk_fma_f32 v[158:159], v[50:51], v[66:67], v[158:159] op_sel:[1,0,0] neg_lo:[1,0,0] neg_hi:[1,0,0]
  v_pk_fma_f32 v[28:29], v[28:29], v[12:13], s[64:65] op_sel_hi:[1,0,0]
  v_pk_fma_f32 v[30:31], v[30:31], v[12:13], s[64:65] op_sel_hi:[1,0,0]
  v_pk_fma_f32 v[32:33], v[32:33], v[12:13], s[64:65] op_sel_hi:[1,0,0]
  v_pk_fma_f32 v[34:35], v[34:35], v[12:13], s[64:65] op_sel_hi:[1,0,0]
  v_pk_mul_f32 v[152:153], v[54:55], v[152:153] op_sel_hi:[0,1]
  v_pk_mul_f32 v[154:155], v[54:55], v[154:155] op_sel_hi:[0,1]
  v_pk_mul_f32 v[156:157], v[54:55], v[156:157] op_sel:[1,0]
  v_pk_mul_f32 v[158:159], v[54:55], v[158:159] op_sel:[1,0]
  v_pk_mul_f32 v[28:29], v[28:29], v[136:137]
  v_pk_mul_f32 v[30:31], v[30:31], v[138:139]
  v_pk_mul_f32 v[32:33], v[32:33], v[140:141]
  v_pk_mul_f32 v[34:35], v[34:35], v[142:143]
  v_exp_f32 v28, v28
  v_exp_f32 v29, v29
  v_exp_f32 v30, v30
  v_exp_f32 v31, v31
  v_exp_f32 v32, v32
  v_exp_f32 v33, v33
  v_exp_f32 v34, v34
  v_exp_f32 v35, v35
  v_pk_mul_f32 v[152:153], v[136:137], v[152:153]
  v_pk_mul_f32 v[154:155], v[138:139], v[154:155]
  v_pk_mul_f32 v[156:157], v[140:141], v[156:157]
  v_pk_mul_f32 v[158:159], v[142:143], v[158:159]
  v_pk_add_f32 v[28:29], v[28:29], 1.0 op_sel_hi:[1,0]
  v_pk_add_f32 v[30:31], v[30:31], 1.0 op_sel_hi:[1,0]
  v_pk_add_f32 v[32:33], v[32:33], 1.0 op_sel_hi:[1,0]
  v_pk_add_f32 v[34:35], v[34:35], 1.0 op_sel_hi:[1,0]
  v_rcp_f32 v28, v28
  v_rcp_f32 v29, v29
  v_rcp_f32 v30, v30
  v_rcp_f32 v31, v31
  v_rcp_f32 v32, v32
  v_rcp_f32 v33, v33
  v_rcp_f32 v34, v34
  v_rcp_f32 v35, v35
  s_nop 0
  v_pk_mul_f32 v[152:153], v[28:29], v[152:153]
  v_pk_mul_f32 v[154:155], v[30:31], v[154:155]
  v_pk_mul_f32 v[156:157], v[32:33], v[156:157]
  v_pk_mul_f32 v[158:159], v[34:35], v[158:159]
  v_cvt_pk_bf16_f32 v88, v152, v153
  v_cvt_pk_bf16_f32 v89, v154, v155
  v_cvt_pk_bf16_f32 v90, v156, v157
  v_cvt_pk_bf16_f32 v91, v158, v159
  s_nop 1
  v_permlane16_swap_b32 v84, v86
  v_permlane16_swap_b32 v85, v87
  v_permlane16_swap_b32 v88, v90
  v_permlane16_swap_b32 v89, v91
  s_mov_b32 s63, 147456
  buffer_store_dwordx4 v[84:87], v13, s[32:35], 0 offen sc1
  buffer_store_dwordx4 v[88:91], v13, s[32:35], s63 offen sc1
  v_pk_fma_f32 v[160:161], v[48:49], v[68:69], v[160:161] op_sel_hi:[0,1,1] neg_lo:[1,0,0] neg_hi:[1,0,0]
  v_pk_fma_f32 v[162:163], v[48:49], v[70:71], v[162:163] op_sel_hi:[0,1,1] neg_lo:[1,0,0] neg_hi:[1,0,0]
  v_pk_fma_f32 v[164:165], v[48:49], v[68:69], v[164:165] op_sel:[1,0,0] neg_lo:[1,0,0] neg_hi:[1,0,0]
  v_pk_fma_f32 v[166:167], v[48:49], v[70:71], v[166:167] op_sel:[1,0,0] neg_lo:[1,0,0] neg_hi:[1,0,0]
  v_pk_mul_f32 v[160:161], v[52:53], v[160:161] op_sel_hi:[0,1]
  v_pk_mul_f32 v[162:163], v[52:53], v[162:163] op_sel_hi:[0,1]
  v_pk_mul_f32 v[164:165], v[52:53], v[164:165] op_sel:[1,0]
  v_pk_mul_f32 v[166:167], v[52:53], v[166:167] op_sel:[1,0]
  v_pk_mul_f32 v[28:29], v[160:161], v[160:161]
  v_pk_mul_f32 v[30:31], v[162:163], v[162:163]
  v_pk_mul_f32 v[32:33], v[164:165], v[164:165]
  v_pk_mul_f32 v[34:35], v[166:167], v[166:167]
  v_pk_fma_f32 v[176:177], v[48:49], v[72:73], v[176:177] op_sel_hi:[0,1,1] neg_lo:[1,0,0] neg_hi:[1,0,0]
  v_pk_fma_f32 v[178:179], v[48:49], v[74:75], v[178:179] op_sel_hi:[0,1,1] neg_lo:[1,0,0] neg_hi:[1,0,0]
  v_pk_fma_f32 v[180:181], v[48:49], v[72:73], v[180:181] op_sel:[1,0,0] neg_lo:[1,0,0] neg_hi:[1,0,0]
  v_pk_fma_f32 v[182:183], v[48:49], v[74:75], v[182:183] op_sel:[1,0,0] neg_lo:[1,0,0] neg_hi:[1,0,0]
  v_pk_fma_f32 v[28:29], v[28:29], v[12:13], s[64:65] op_sel_hi:[1,0,0]
  v_pk_fma_f32 v[30:31], v[30:31], v[12:13], s[64:65] op_sel_hi:[1,0,0]
  v_pk_fma_f32 v[32:33], v[32:33], v[12:13], s[64:65] op_sel_hi:[1,0,0]
  v_pk_fma_f32 v[34:35], v[34:35], v[12:13], s[64:65] op_sel_hi:[1,0,0]
  v_pk_mul_f32 v[176:177], v[52:53], v[176:177] op_sel_hi:[0,1]
  v_pk_mul_f32 v[178:179], v[52:53], v[178:179] op_sel_hi:[0,1]
  v_pk_mul_f32 v[180:181], v[52:53], v[180:181] op_sel:[1,0]
  v_pk_mul_f32 v[182:183], v[52:53], v[182:183] op_sel:[1,0]
  v_pk_mul_f32 v[28:29], v[28:29], v[160:161]
  v_pk_mul_f32 v[30:31], v[30:31], v[162:163]
  v_pk_mul_f32 v[32:33], v[32:33], v[164:165]
  v_pk_mul_f32 v[34:35], v[34:35], v[166:167]
  v_exp_f32 v28, v28
  v_exp_f32 v29, v29
  v_exp_f32 v30, v30
  v_exp_f32 v31, v31
  v_exp_f32 v32, v32
  v_exp_f32 v33, v33
  v_exp_f32 v34, v34
  v_exp_f32 v35, v35
  v_pk_mul_f32 v[176:177], v[160:161], v[176:177]
  v_pk_mul_f32 v[178:179], v[162:163], v[178:179]
  v_pk_mul_f32 v[180:181], v[164:165], v[180:181]
  v_pk_mul_f32 v[182:183], v[166:167], v[182:183]
  v_pk_add_f32 v[28:29], v[28:29], 1.0 op_sel_hi:[1,0]
  v_pk_add_f32 v[30:31], v[30:31], 1.0 op_sel_hi:[1,0]
  v_pk_add_f32 v[32:33], v[32:33], 1.0 op_sel_hi:[1,0]
  v_pk_add_f32 v[34:35], v[34:35], 1.0 op_sel_hi:[1,0]
  v_rcp_f32 v28, v28
  v_rcp_f32 v29, v29
  v_rcp_f32 v30, v30
  v_rcp_f32 v31, v31
  v_rcp_f32 v32, v32
  v_rcp_f32 v33, v33
  v_rcp_f32 v34, v34
  v_rcp_f32 v35, v35
  s_nop 0
  v_pk_mul_f32 v[176:177], v[28:29], v[176:177]
  v_pk_mul_f32 v[178:179], v[30:31], v[178:179]
  v_pk_mul_f32 v[180:181], v[32:33], v[180:181]
  v_pk_mul_f32 v[182:183], v[34:35], v[182:183]
  v_cvt_pk_bf16_f32 v92, v176, v177
  v_cvt_pk_bf16_f32 v93, v178, v179
  v_cvt_pk_bf16_f32 v94, v180, v181
  v_cvt_pk_bf16_f32 v95, v182, v183
  v_pk_fma_f32 v[168:169], v[50:51], v[68:69], v[168:169] op_sel_hi:[0,1,1] neg_lo:[1,0,0] neg_hi:[1,0,0]
  v_pk_fma_f32 v[170:171], v[50:51], v[70:71], v[170:171] op_sel_hi:[0,1,1] neg_lo:[1,0,0] neg_hi:[1,0,0]
  v_pk_fma_f32 v[172:173], v[50:51], v[68:69], v[172:173] op_sel:[1,0,0] neg_lo:[1,0,0] neg_hi:[1,0,0]
  v_pk_fma_f32 v[174:175], v[50:51], v[70:71], v[174:175] op_sel:[1,0,0] neg_lo:[1,0,0] neg_hi:[1,0,0]
  v_pk_mul_f32 v[168:169], v[54:55], v[168:169] op_sel_hi:[0,1]
  v_pk_mul_f32 v[170:171], v[54:55], v[170:171] op_sel_hi:[0,1]
  v_pk_mul_f32 v[172:173], v[54:55], v[172:173] op_sel:[1,0]
  v_pk_mul_f32 v[174:175], v[54:55], v[174:175] op_sel:[1,0]
  v_pk_mul_f32 v[28:29], v[168:169], v[168:169]
  v_pk_mul_f32 v[30:31], v[170:171], v[170:171]
  v_pk_mul_f32 v[32:33], v[172:173], v[172:173]
  v_pk_mul_f32 v[34:35], v[174:175], v[174:175]
  v_pk_fma_f32 v[184:185], v[50:51], v[72:73], v[184:185] op_sel_hi:[0,1,1] neg_lo:[1,0,0] neg_hi:[1,0,0]
  v_pk_fma_f32 v[186:187], v[50:51], v[74:75], v[186:187] op_sel_hi:[0,1,1] neg_lo:[1,0,0] neg_hi:[1,0,0]
  v_pk_fma_f32 v[188:189], v[50:51], v[72:73], v[188:189] op_sel:[1,0,0] neg_lo:[1,0,0] neg_hi:[1,0,0]
  v_pk_fma_f32 v[190:191], v[50:51], v[74:75], v[190:191] op_sel:[1,0,0] neg_lo:[1,0,0] neg_hi:[1,0,0]
  v_pk_fma_f32 v[28:29], v[28:29], v[12:13], s[64:65] op_sel_hi:[1,0,0]
  v_pk_fma_f32 v[30:31], v[30:31], v[12:13], s[64:65] op_sel_hi:[1,0,0]
  v_pk_fma_f32 v[32:33], v[32:33], v[12:13], s[64:65] op_sel_hi:[1,0,0]
  v_pk_fma_f32 v[34:35], v[34:35], v[12:13], s[64:65] op_sel_hi:[1,0,0]
  v_pk_mul_f32 v[184:185], v[54:55], v[184:185] op_sel_hi:[0,1]
  v_pk_mul_f32 v[186:187], v[54:55], v[186:187] op_sel_hi:[0,1]
  v_pk_mul_f32 v[188:189], v[54:55], v[188:189] op_sel:[1,0]
  v_pk_mul_f32 v[190:191], v[54:55], v[190:191] op_sel:[1,0]
  v_pk_mul_f32 v[28:29], v[28:29], v[168:169]
  v_pk_mul_f32 v[30:31], v[30:31], v[170:171]
  v_pk_mul_f32 v[32:33], v[32:33], v[172:173]
  v_pk_mul_f32 v[34:35], v[34:35], v[174:175]
  v_exp_f32 v28, v28
  v_exp_f32 v29, v29
  v_exp_f32 v30, v30
  v_exp_f32 v31, v31
  v_exp_f32 v32, v32
  v_exp_f32 v33, v33
  v_exp_f32 v34, v34
  v_exp_f32 v35, v35
  v_pk_mul_f32 v[184:185], v[168:169], v[184:185]
  v_pk_mul_f32 v[186:187], v[170:171], v[186:187]
  v_pk_mul_f32 v[188:189], v[172:173], v[188:189]
  v_pk_mul_f32 v[190:191], v[174:175], v[190:191]
  v_pk_add_f32 v[28:29], v[28:29], 1.0 op_sel_hi:[1,0]
  v_pk_add_f32 v[30:31], v[30:31], 1.0 op_sel_hi:[1,0]
  v_pk_add_f32 v[32:33], v[32:33], 1.0 op_sel_hi:[1,0]
  v_pk_add_f32 v[34:35], v[34:35], 1.0 op_sel_hi:[1,0]
  v_rcp_f32 v28, v28
  v_rcp_f32 v29, v29
  v_rcp_f32 v30, v30
  v_rcp_f32 v31, v31
  v_rcp_f32 v32, v32
  v_rcp_f32 v33, v33
  v_rcp_f32 v34, v34
  v_rcp_f32 v35, v35
  s_nop 0
  v_pk_mul_f32 v[184:185], v[28:29], v[184:185]
  v_pk_mul_f32 v[186:187], v[30:31], v[186:187]
  v_pk_mul_f32 v[188:189], v[32:33], v[188:189]
  v_pk_mul_f32 v[190:191], v[34:35], v[190:191]
  v_cvt_pk_bf16_f32 v96, v184, v185
  v_cvt_pk_bf16_f32 v97, v186, v187
  v_cvt_pk_bf16_f32 v98, v188, v189
  v_cvt_pk_bf16_f32 v99, v190, v191
  s_nop 1
  v_permlane16_swap_b32 v92, v94
  v_permlane16_swap_b32 v93, v95
  v_permlane16_swap_b32 v96, v98
  v_permlane16_swap_b32 v97, v99
  s_mov_b32 s63, 147456
  buffer_store_dwordx4 v[92:95], v14, s[32:35], 0 offen sc1
  buffer_store_dwordx4 v[96:99], v14, s[32:35], s63 offen sc1
  s_waitcnt lgkmcnt(0)
  v_permlane32_swap_b32 v192, v196
  v_permlane32_swap_b32 v193, v197
  v_permlane32_swap_b32 v194, v198
  v_permlane32_swap_b32 v195, v199
  v_permlane32_swap_b32 v200, v204
  v_permlane32_swap_b32 v201, v205
  v_permlane32_swap_b32 v202, v206
  v_permlane32_swap_b32 v203, v207
  v_bfe_u32 v21, v0, 4, 1
  v_lshlrev_b32 v21, 1, v21
  v_lshrrev_b32 v20, 5, v0
  v_add_u32 v20, v20, v21
  s_lshl_b32 s60, s40, 3
  s_add_u32 s60, s60, 4
  v_add_u32 v20, s60, v20
  v_mul_u32_u24 v20, 73728, v20
  v_and_b32 v21, 15, v0
  v_lshl_add_u32 v20, v21, 4, v20
  s_lshl_b32 s60, s51, 4
  s_lshl_b32 s61, s44, 8
  s_add_u32 s60, s60, s61
  s_add_u32 s60, s60, 16384
  v_add_u32 v15, s60, v20
  v_pk_fma_f32 v[192:193], v[56:57], v[76:77], v[192:193] op_sel_hi:[0,1,1] neg_lo:[1,0,0] neg_hi:[1,0,0]
  v_pk_fma_f32 v[194:195], v[56:57], v[78:79], v[194:195] op_sel_hi:[0,1,1] neg_lo:[1,0,0] neg_hi:[1,0,0]
  v_pk_fma_f32 v[200:201], v[56:57], v[76:77], v[200:201] op_sel:[1,0,0] neg_lo:[1,0,0] neg_hi:[1,0,0]
  v_pk_fma_f32 v[202:203], v[56:57], v[78:79], v[202:203] op_sel:[1,0,0] neg_lo:[1,0,0] neg_hi:[1,0,0]
  v_pk_mul_f32 v[192:193], v[58:59], v[192:193] op_sel_hi:[0,1]
  v_pk_mul_f32 v[194:195], v[58:59], v[194:195] op_sel_hi:[0,1]
  v_pk_mul_f32 v[200:201], v[58:59], v[200:201] op_sel:[1,0]
  v_pk_mul_f32 v[202:203], v[58:59], v[202:203] op_sel:[1,0]
  v_pk_mul_f32 v[28:29], v[192:193], v[192:193]
  v_pk_mul_f32 v[30:31], v[194:195], v[194:195]
  v_pk_mul_f32 v[32:33], v[200:201], v[200:201]
  v_pk_mul_f32 v[34:35], v[202:203], v[202:203]
  v_pk_fma_f32 v[196:197], v[56:57], v[80:81], v[196:197] op_sel_hi:[0,1,1] neg_lo:[1,0,0] neg_hi:[1,0,0]
  v_pk_fma_f32 v[198:199], v[56:57], v[82:83], v[198:199] op_sel_hi:[0,1,1] neg_lo:[1,0,0] neg_hi:[1,0,0]
  v_pk_fma_f32 v[204:205], v[56:57], v[80:81], v[204:205] op_sel:[1,0,0] neg_lo:[1,0,0] neg_hi:[1,0,0]
  v_pk_fma_f32 v[206:207], v[56:57], v[82:83], v[206:207] op_sel:[1,0,0] neg_lo:[1,0,0] neg_hi:[1,0,0]
  v_pk_fma_f32 v[28:29], v[28:29], v[12:13], s[64:65] op_sel_hi:[1,0,0]
  v_pk_fma_f32 v[30:31], v[30:31], v[12:13], s[64:65] op_sel_hi:[1,0,0]
  v_pk_fma_f32 v[32:33], v[32:33], v[12:13], s[64:65] op_sel_hi:[1,0,0]
  v_pk_fma_f32 v[34:35], v[34:35], v[12:13], s[64:65] op_sel_hi:[1,0,0]
  v_pk_mul_f32 v[196:197], v[58:59], v[196:197] op_sel_hi:[0,1]
  v_pk_mul_f32 v[198:199], v[58:59], v[198:199] op_sel_hi:[0,1]
  v_pk_mul_f32 v[204:205], v[58:59], v[204:205] op_sel:[1,0]
  v_pk_mul_f32 v[206:207], v[58:59], v[206:207] op_sel:[1,0]
  v_pk_mul_f32 v[28:29], v[28:29], v[192:193]
  v_pk_mul_f32 v[30:31], v[30:31], v[194:195]
  v_pk_mul_f32 v[32:33], v[32:33], v[200:201]
  v_pk_mul_f32 v[34:35], v[34:35], v[202:203]
  v_exp_f32 v28, v28
  v_exp_f32 v29, v29
  v_exp_f32 v30, v30
  v_exp_f32 v31, v31
  v_exp_f32 v32, v32
  v_exp_f32 v33, v33
  v_exp_f32 v34, v34
  v_exp_f32 v35, v35
  v_pk_mul_f32 v[196:197], v[192:193], v[196:197]
  v_pk_mul_f32 v[198:199], v[194:195], v[198:199]
  v_pk_mul_f32 v[204:205], v[200:201], v[204:205]
  v_pk_mul_f32 v[206:207], v[202:203], v[206:207]
  v_pk_add_f32 v[28:29], v[28:29], 1.0 op_sel_hi:[1,0]
  v_pk_add_f32 v[30:31], v[30:31], 1.0 op_sel_hi:[1,0]
  v_pk_add_f32 v[32:33], v[32:33], 1.0 op_sel_hi:[1,0]
  v_pk_add_f32 v[34:35], v[34:35], 1.0 op_sel_hi:[1,0]
  v_rcp_f32 v28, v28
  v_rcp_f32 v29, v29
  v_rcp_f32 v30, v30
  v_rcp_f32 v31, v31
  v_rcp_f32 v32, v32
  v_rcp_f32 v33, v33
  v_rcp_f32 v34, v34
  v_rcp_f32 v35, v35
  s_nop 0
  v_pk_mul_f32 v[196:197], v[28:29], v[196:197]
  v_pk_mul_f32 v[198:199], v[30:31], v[198:199]
  v_pk_mul_f32 v[204:205], v[32:33], v[204:205]
  v_pk_mul_f32 v[206:207], v[34:35], v[206:207]
  v_cvt_pk_bf16_f32 v100, v196, v197
  v_cvt_pk_bf16_f32 v101, v198, v199
  v_cvt_pk_bf16_f32 v102, v204, v205
  v_cvt_pk_bf16_f32 v103, v206, v207
  s_nop 1
  v_permlane16_swap_b32 v100, v102
  v_permlane16_swap_b32 v101, v103
  buffer_store_dwordx4 v[100:103], v15, s[32:35], 0 offen sc1
  s_branch P1_done
P1_done:
  s_lshl_b32 s60, s69, 2
  s_add_u32 s60, s60, s44
  s_mul_i32 s60, s60, 73728
  v_lshlrev_b32 v20, 4, v0
  v_add_u32 v2, s60, v20
  s_mul_i32 s67, s45, 20480
  s_add_u32 s67, s67, 32768
  v_lshrrev_b32 v21, 4, v0
  v_bfe_u32 v22, v0, 2, 2
  v_lshl_add_u32 v22, v21, 3, v22
  v_lshlrev_b32 v22, 7, v22
  v_and_b32 v23, 3, v0
  v_lshl_add_u32 v22, v23, 3, v22
  s_lshl_b32 s60, s45, 12
  v_add_u32 v22, s60, v22
  v_bfe_u32 v23, v0, 3, 2
  v_xor_b32 v24, 0, v23
  v_lshl_add_u32 v4, v24, 5, v22
  v_add_u32 v8, 0x10000, v4
  v_add_u32 v12, 0x20000, v4
  v_xor_b32 v24, 1, v23
  v_lshl_add_u32 v5, v24, 5, v22
  v_add_u32 v9, 0x10000, v5
  v_add_u32 v13, 0x20000, v5
  v_xor_b32 v24, 2, v23
  v_lshl_add_u32 v6, v24, 5, v22
  v_add_u32 v10, 0x10000, v6
  v_add_u32 v14, 0x20000, v6
  v_xor_b32 v24, 3, v23
  v_lshl_add_u32 v7, v24, 5, v22
  v_add_u32 v11, 0x10000, v7
  v_add_u32 v15, 0x20000, v7
  s_lshl_b32 s60, s69, 6
  s_lshl_b32 s61, s44, 4
  s_add_u32 s60, s60, s61
  v_and_b32 v24, 15, v0
  v_add_u32 v24, s60, v24
  v_lshlrev_b32 v24, 10, v24
  v_and_b32 v25, 1, v21
  v_lshl_add_u32 v24, v25, 5, v24
  v_lshrrev_b32 v25, 1, v21
  v_lshl_add_u32 v24, v25, 4, v24
  s_lshl_b32 s60, s74, 7
  s_lshl_b32 s61, s45, 6
  s_add_u32 s60, s60, s61
  v_add_u32 v3, s60, v24
  v_mov_b32 v128, 0
  v_mov_b32 v129, 0
  v_mov_b32 v130, 0
  v_mov_b32 v131, 0
  v_mov_b32 v132, 0
  v_mov_b32 v133, 0
  v_mov_b32 v134, 0
  v_mov_b32 v135, 0
  v_mov_b32 v136, 0
  v_mov_b32 v137, 0
  v_mov_b32 v138, 0
  v_mov_b32 v139, 0
  v_mov_b32 v140, 0
  v_mov_b32 v141, 0
  v_mov_b32 v142, 0
  v_mov_b32 v143, 0
  s_mov_b32 s24, s14
  s_and_b32 s25, s15, 0xffff
  s_mov_b32 s26, 0x200000
  s_mov_b32 s27, 0x20000
  s_lshl_b32 s60, s40, 7
  s_lshl_b32 s61, s41, 2
  s_add_u32 s60, s60, s61
  s_add_u32 s60, s60, 9834496
  v_mov_b32 v39, 0x7fffff00
  v_writelane_b32 v39, s60, 0
  s_lshr_b32 s61, s69, 1
  s_lshl_b32 s61, s61, 7
  s_add_u32 s61, s61, 9834496
  v_and_b32 v21, 15, v0
  v_lshl_add_u32 v43, v21, 2, s61
  s_bitcmp1_b32 s41, 0
  s_cbranch_scc1 L_ho_y_6054
  s_cmp_eq_u32 s43, 0
  s_cbranch_scc0 L_ho_xw_6056
  buffer_load_dword v44, v43, s[32:35], 0 offen sc1
  s_mov_b32 s3, 0
L_ho_poll_6057:
  buffer_load_dword v46, v43, s[32:35], 0 offen sc1
  s_waitcnt vmcnt(1)
  v_cmp_ne_u32 vcc, v40, v44
  s_nop 1
  s_and_b32 vcc_lo, vcc_lo, 0xaaaa
  s_cbranch_scc0 L_ho_xw_6056
  buffer_load_dword v44, v43, s[32:35], 0 offen sc1
  s_waitcnt vmcnt(1)
  v_cmp_ne_u32 vcc, v40, v46
  s_nop 1
  s_and_b32 vcc_lo, vcc_lo, 0xaaaa
  s_cbranch_scc0 L_ho_xw_6056
  s_add_u32 s3, s3, 1
  s_cmp_lt_u32 s3, 262144
  s_cbranch_scc1 L_ho_poll_6057
L_ho_xw_6056:
  s_waitcnt vmcnt(0)
  s_barrier
  s_cmp_eq_u32 s43, 0
  s_cbranch_scc0 L_ho_done_6055
  buffer_store_dword v40, v39, s[32:35], 0 offen sc1
  s_branch L_ho_done_6055
L_ho_y_6054:
  s_waitcnt vmcnt(0)
  s_barrier
  s_cmp_eq_u32 s43, 0
  s_cbranch_scc0 L_ho_other_6059
  buffer_store_dword v40, v39, s[32:35], 0 offen sc1
  buffer_load_dword v44, v43, s[32:35], 0 offen sc1
  s_mov_b32 s3, 0
L_ho_poll_6061:
  buffer_load_dword v46, v43, s[32:35], 0 offen sc1
  s_waitcnt vmcnt(1)
  v_cmp_ne_u32 vcc, v40, v44
  s_nop 1
  s_and_b32 vcc_lo, vcc_lo, 0xaaaa
  s_cbranch_scc0 L_ho_go_6058
  buffer_load_dword v44, v43, s[32:35], 0 offen sc1
  s_waitcnt vmcnt(1)
  v_cmp_ne_u32 vcc, v40, v46
  s_nop 1
  s_and_b32 vcc_lo, vcc_lo, 0xaaaa
  s_cbranch_scc0 L_ho_go_6058
  s_add_u32 s3, s3, 1
  s_cmp_lt_u32 s3, 262144
  s_cbranch_scc1 L_ho_poll_6061
  s_branch L_ho_go_6058
L_ho_other_6059:
  s_cmp_eq_u32 s45, 0
  s_cbranch_scc1 L_ho_go_6058
  s_add_u32 m0, s68, 0
  s_nop 0
  buffer_load_dwordx4 v41, s[20:23], s66 offen lds
  s_add_u32 s66, s66, 32768
  s_add_u32 m0, s68, 8192
  s_nop 0
  buffer_load_dwordx4 v41, s[20:23], s66 offen lds
  s_add_u32 s66, s66, 32768
  s_add_u32 m0, s68, 16384
  s_nop 0
  buffer_load_dwordx4 v41, s[20:23], s66 offen lds
  s_add_u32 s66, s66, 32768
  s_add_u32 m0, s68, 24576
  s_nop 0
  buffer_load_dwordx4 v41, s[20:23], s66 offen lds
  s_add_u32 s66, s66, 32768
  s_add_u32 m0, s68, 32768
  s_nop 0
  buffer_load_dwordx4 v41, s[20:23], s66 offen lds
  s_add_u32 s66, s66, 32768
  s_add_u32 m0, s68, 40960
  s_nop 0
  buffer_load_dwordx4 v41, s[20:23], s66 offen lds
  s_add_u32 s66, s66, 32768
  s_add_u32 m0, s68, 49152
  s_nop 0
  buffer_load_dwordx4 v41, s[20:23], s66 offen lds
  s_add_u32 s66, s66, 32768
  s_add_u32 m0, s68, 57344
  s_nop 0
  buffer_load_dwordx4 v41, s[20:23], s66 offen lds
  s_add_u32 s66, s66, 32768
  s_add_u32 m0, s68, 65536
  s_nop 0
  buffer_load_dwordx4 v41, s[20:23], s66 offen lds
  s_add_u32 s66, s66, 32768
  s_add_u32 m0, s68, 73728
  s_nop 0
  buffer_load_dwordx4 v41, s[20:23], s66 offen lds
  s_add_u32 s66, s66, 32768
  s_add_u32 m0, s68, 81920
  s_nop 0
  buffer_load_dwordx4 v41, s[20:23], s66 offen lds
  s_add_u32 s66, s66, 32768
  s_add_u32 m0, s68, 90112
  s_nop 0
  buffer_load_dwordx4 v41, s[20:23], s66 offen lds
  s_add_u32 s66, s66, 32768
  s_add_u32 m0, s68, 98304
  s_nop 0
  buffer_load_dwordx4 v41, s[20:23], s66 offen lds
  s_add_u32 s66, s66, 32768
  s_add_u32 m0, s68, 106496
  s_nop 0
  buffer_load_dwordx4 v41, s[20:23], s66 offen lds
  s_add_u32 s66, s66, 32768
  s_add_u32 m0, s68, 114688
  s_nop 0
  buffer_load_dwordx4 v41, s[20:23], s66 offen lds
  s_add_u32 s66, s66, 32768
  s_add_u32 m0, s68, 122880
  s_nop 0
  buffer_load_dwordx4 v41, s[20:23], s66 offen lds
  s_add_u32 s66, s66, 32768
  s_add_u32 m0, s68, 131072
  s_nop 0
  buffer_load_dwordx4 v41, s[20:23], s66 offen lds
  s_add_u32 s66, s66, 32768
  s_add_u32 m0, s68, 139264
  s_nop 0
  buffer_load_dwordx4 v41, s[20:23], s66 offen lds
  s_add_u32 s66, s66, 32768
  s_waitcnt vmcnt(0)
L_ho_go_6058:
  s_barrier
L_ho_done_6055:
  s_cmp_eq_u32 s2, 0
  s_cbranch_scc0 L_noepl_6062
  s_cmp_eq_u32 s43, 0
  s_cbranch_scc0 L_noepl_6062
  v_lshrrev_b32 v20, 2, v0
  v_lshlrev_b32 v20, 7, v20
  v_and_b32 v21, 3, v0
  v_lshl_add_u32 v20, v21, 4, v20
  v_add_u32 v47, 9830400, v20
  buffer_load_dwordx4 v[248:251], v47, s[32:35], 0 offen sc1
L_noepl_6062:
  buffer_load_dwordx4 v[80:83], v2, s[32:35], s67 offen offset:0 sc1
  buffer_load_dwordx4 v[84:87], v2, s[32:35], s67 offen offset:1024 sc1
  buffer_load_dwordx4 v[88:91], v2, s[32:35], s67 offen offset:2048 sc1
  buffer_load_dwordx4 v[92:95], v2, s[32:35], s67 offen offset:3072 sc1
  s_add_u32 s67, s67, 4096
  buffer_load_dwordx4 v[96:99], v2, s[32:35], s67 offen offset:0 sc1
  buffer_load_dwordx4 v[100:103], v2, s[32:35], s67 offen offset:1024 sc1
  buffer_load_dwordx4 v[104:107], v2, s[32:35], s67 offen offset:2048 sc1
  buffer_load_dwordx4 v[108:111], v2, s[32:35], s67 offen offset:3072 sc1
  s_add_u32 s67, s67, 4096
  ds_read_b64_tr_b16 v[48:49], v4 offset:0
  ds_read_b64_tr_b16 v[50:51], v4 offset:512
  ds_read_b64_tr_b16 v[52:53], v5 offset:0
  ds_read_b64_tr_b16 v[54:55], v5 offset:512
  ds_read_b64_tr_b16 v[56:57], v6 offset:0
  ds_read_b64_tr_b16 v[58:59], v6 offset:512
  ds_read_b64_tr_b16 v[60:61], v7 offset:0
  ds_read_b64_tr_b16 v[62:63], v7 offset:512
  s_waitcnt lgkmcnt(0)
  ds_read_b64_tr_b16 v[64:65], v4 offset:8192
  ds_read_b64_tr_b16 v[66:67], v4 offset:8704
  ds_read_b64_tr_b16 v[68:69], v5 offset:8192
  ds_read_b64_tr_b16 v[70:71], v5 offset:8704
  ds_read_b64_tr_b16 v[72:73], v6 offset:8192
  ds_read_b64_tr_b16 v[74:75], v6 offset:8704
  ds_read_b64_tr_b16 v[76:77], v7 offset:8192
  ds_read_b64_tr_b16 v[78:79], v7 offset:8704
  s_waitcnt vmcnt(7) lgkmcnt(7)
  v_mfma_f32_16x16x32_bf16 v[128:131], v[48:51], v[80:83], v[128:131]
  ds_read_b64_tr_b16 v[48:49], v4 offset:16384
  ds_read_b64_tr_b16 v[50:51], v4 offset:16896
  v_mfma_f32_16x16x32_bf16 v[132:135], v[52:55], v[80:83], v[132:135]
  ds_read_b64_tr_b16 v[52:53], v5 offset:16384
  ds_read_b64_tr_b16 v[54:55], v5 offset:16896
  v_mfma_f32_16x16x32_bf16 v[136:139], v[56:59], v[80:83], v[136:139]
  ds_read_b64_tr_b16 v[56:57], v6 offset:16384
  ds_read_b64_tr_b16 v[58:59], v6 offset:16896
  v_mfma_f32_16x16x32_bf16 v[140:143], v[60:63], v[80:83], v[140:143]
  ds_read_b64_tr_b16 v[60:61], v7 offset:16384
  ds_read_b64_tr_b16 v[62:63], v7 offset:16896
  buffer_load_dwordx4 v[112:115], v2, s[32:35], s67 offen offset:0 sc1
  buffer_load_dwordx4 v[116:119], v2, s[32:35], s67 offen offset:1024 sc1
  s_waitcnt vmcnt(8) lgkmcnt(7)
  v_mfma_f32_16x16x32_bf16 v[128:131], v[64:67], v[84:87], v[128:131]
  ds_read_b64_tr_b16 v[64:65], v4 offset:24576
  ds_read_b64_tr_b16 v[66:67], v4 offset:25088
  v_mfma_f32_16x16x32_bf16 v[132:135], v[68:71], v[84:87], v[132:135]
  ds_read_b64_tr_b16 v[68:69], v5 offset:24576
  ds_read_b64_tr_b16 v[70:71], v5 offset:25088
  v_mfma_f32_16x16x32_bf16 v[136:139], v[72:75], v[84:87], v[136:139]
  ds_read_b64_tr_b16 v[72:73], v6 offset:24576
  ds_read_b64_tr_b16 v[74:75], v6 offset:25088
  v_mfma_f32_16x16x32_bf16 v[140:143], v[76:79], v[84:87], v[140:143]
  ds_read_b64_tr_b16 v[76:77], v7 offset:24576
  ds_read_b64_tr_b16 v[78:79], v7 offset:25088
  buffer_load_dwordx4 v[120:123], v2, s[32:35], s67 offen offset:2048 sc1
  buffer_load_dwordx4 v[124:127], v2, s[32:35], s67 offen offset:3072 sc1
  s_add_u32 s67, s67, 4096
  s_barrier
  s_waitcnt vmcnt(9) lgkmcnt(7)
  v_mfma_f32_16x16x32_bf16 v[128:131], v[48:51], v[88:91], v[128:131]
  ds_read_b64_tr_b16 v[48:49], v4 offset:32768
  ds_read_b64_tr_b16 v[50:51], v4 offset:33280
  v_mfma_f32_16x16x32_bf16 v[132:135], v[52:55], v[88:91], v[132:135]
  ds_read_b64_tr_b16 v[52:53], v5 offset:32768
  ds_read_b64_tr_b16 v[54:55], v5 offset:33280
  s_add_u32 m0, s68, 0
  s_nop 0
  buffer_load_dwordx4 v41, s[20:23], s66 offen lds
  s_add_u32 s66, s66, 32768
  v_mfma_f32_16x16x32_bf16 v[136:139], v[56:59], v[88:91], v[136:139]
  ds_read_b64_tr_b16 v[56:57], v6 offset:32768
  ds_read_b64_tr_b16 v[58:59], v6 offset:33280
  v_mfma_f32_16x16x32_bf16 v[140:143], v[60:63], v[88:91], v[140:143]
  ds_read_b64_tr_b16 v[60:61], v7 offset:32768
  ds_read_b64_tr_b16 v[62:63], v7 offset:33280
  buffer_load_dwordx4 v[80:83], v2, s[32:35], s67 offen offset:0 sc1
  buffer_load_dwordx4 v[84:87], v2, s[32:35], s67 offen offset:1024 sc1
  s_waitcnt vmcnt(11) lgkmcnt(7)
  v_mfma_f32_16x16x32_bf16 v[128:131], v[64:67], v[92:95], v[128:131]
  ds_read_b64_tr_b16 v[64:65], v4 offset:40960
  ds_read_b64_tr_b16 v[66:67], v4 offset:41472
  v_mfma_f32_16x16x32_bf16 v[132:135], v[68:71], v[92:95], v[132:135]
  ds_read_b64_tr_b16 v[68:69], v5 offset:40960
  ds_read_b64_tr_b16 v[70:71], v5 offset:41472
  s_add_u32 m0, s68, 8192
  s_nop 0
  buffer_load_dwordx4 v41, s[20:23], s66 offen lds
  s_mov_b32 s66, 0
  s_mov_b32 s60, 0x80000
  s_mov_b32 s61, 0x1c0000
  s_cmp_eq_u32 s45, 0
  s_cselect_b32 s20, s70, s72
  s_cselect_b32 s21, s71, s73
  s_cselect_b32 s22, s60, s61
  s_and_b32 s21, s21, 0xffff
  s_mov_b32 s23, 0x20000
  v_mfma_f32_16x16x32_bf16 v[136:139], v[72:75], v[92:95], v[136:139]
  ds_read_b64_tr_b16 v[72:73], v6 offset:40960
  ds_read_b64_tr_b16 v[74:75], v6 offset:41472
  v_mfma_f32_16x16x32_bf16 v[140:143], v[76:79], v[92:95], v[140:143]
  ds_read_b64_tr_b16 v[76:77], v7 offset:40960
  ds_read_b64_tr_b16 v[78:79], v7 offset:41472
  buffer_load_dwordx4 v[88:91], v2, s[32:35], s67 offen offset:2048 sc1
  buffer_load_dwordx4 v[92:95], v2, s[32:35], s67 offen offset:3072 sc1
  s_add_u32 s67, s67, 4096
  s_waitcnt vmcnt(13) lgkmcnt(7)
  v_mfma_f32_16x16x32_bf16 v[128:131], v[48:51], v[96:99], v[128:131]
  ds_read_b64_tr_b16 v[48:49], v4 offset:49152
  ds_read_b64_tr_b16 v[50:51], v4 offset:49664
  v_mfma_f32_16x16x32_bf16 v[132:135], v[52:55], v[96:99], v[132:135]
  ds_read_b64_tr_b16 v[52:53], v5 offset:49152
  ds_read_b64_tr_b16 v[54:55], v5 offset:49664
  v_mfma_f32_16x16x32_bf16 v[136:139], v[56:59], v[96:99], v[136:139]
  ds_read_b64_tr_b16 v[56:57], v6 offset:49152
  ds_read_b64_tr_b16 v[58:59], v6 offset:49664
  v_mfma_f32_16x16x32_bf16 v[140:143], v[60:63], v[96:99], v[140:143]
  ds_read_b64_tr_b16 v[60:61], v7 offset:49152
  ds_read_b64_tr_b16 v[62:63], v7 offset:49664
  buffer_load_dwordx4 v[96:99], v2, s[32:35], s67 offen offset:0 sc1
  s_waitcnt vmcnt(13) lgkmcnt(7)
  v_mfma_f32_16x16x32_bf16 v[128:131], v[64:67], v[100:103], v[128:131]
  ds_read_b64_tr_b16 v[64:65], v4 offset:57344
  ds_read_b64_tr_b16 v[66:67], v4 offset:57856
  v_mfma_f32_16x16x32_bf16 v[132:135], v[68:71], v[100:103], v[132:135]
  ds_read_b64_tr_b16 v[68:69], v5 offset:57344
  ds_read_b64_tr_b16 v[70:71], v5 offset:57856
  v_mfma_f32_16x16x32_bf16 v[136:139], v[72:75], v[100:103], v[136:139]
  ds_read_b64_tr_b16 v[72:73], v6 offset:57344
  ds_read_b64_tr_b16 v[74:75], v6 offset:57856
  v_mfma_f32_16x16x32_bf16 v[140:143], v[76:79], v[100:103], v[140:143]
  ds_read_b64_tr_b16 v[76:77], v7 offset:57344
  ds_read_b64_tr_b16 v[78:79], v7 offset:57856
  buffer_load_dwordx4 v[100:103], v2, s[32:35], s67 offen offset:1024 sc1
  s_barrier
  s_cmp_eq_u32 s43, 0
  s_cbranch_scc0 L_noxp_6063
  buffer_load_dword v44, v43, s[32:35], 0 offen sc1
L_noxp_6063:
  s_waitcnt vmcnt(13) lgkmcnt(7)
  v_mfma_f32_16x16x32_bf16 v[128:131], v[48:51], v[104:107], v[128:131]
  ds_read_b64_tr_b16 v[48:49], v8 offset:0
  ds_read_b64_tr_b16 v[50:51], v8 offset:512
  v_mfma_f32_16x16x32_bf16 v[132:135], v[52:55], v[104:107], v[132:135]
  ds_read_b64_tr_b16 v[52:53], v9 offset:0
  ds_read_b64_tr_b16 v[54:55], v9 offset:512
  s_add_u32 m0, s68, 16384
  s_nop 0
  buffer_load_dwordx4 v41, s[20:23], s66 offen lds
  s_add_u32 s66, s66, 32768
  v_mfma_f32_16x16x32_bf16 v[136:139], v[56:59], v[104:107], v[136:139]
  ds_read_b64_tr_b16 v[56:57], v10 offset:0
  ds_read_b64_tr_b16 v[58:59], v10 offset:512
  v_mfma_f32_16x16x32_bf16 v[140:143], v[60:63], v[104:107], v[140:143]
  ds_read_b64_tr_b16 v[60:61], v11 offset:0
  ds_read_b64_tr_b16 v[62:63], v11 offset:512
  buffer_load_dwordx4 v[104:107], v2, s[32:35], s67 offen offset:2048 sc1
  s_waitcnt vmcnt(14) lgkmcnt(7)
  v_mfma_f32_16x16x32_bf16 v[128:131], v[64:67], v[108:111], v[128:131]
  ds_read_b64_tr_b16 v[64:65], v8 offset:8192
  ds_read_b64_tr_b16 v[66:67], v8 offset:8704
  v_mfma_f32_16x16x32_bf16 v[132:135], v[68:71], v[108:111], v[132:135]
  ds_read_b64_tr_b16 v[68:69], v9 offset:8192
  ds_read_b64_tr_b16 v[70:71], v9 offset:8704
  s_add_u32 m0, s68, 24576
  s_nop 0
  buffer_load_dwordx4 v41, s[20:23], s66 offen lds
  s_add_u32 s66, s66, 32768
  v_mfma_f32_16x16x32_bf16 v[136:139], v[72:75], v[108:111], v[136:139]
  ds_read_b64_tr_b16 v[72:73], v10 offset:8192
  ds_read_b64_tr_b16 v[74:75], v10 offset:8704
  v_mfma_f32_16x16x32_bf16 v[140:143], v[76:79], v[108:111], v[140:143]
  ds_read_b64_tr_b16 v[76:77], v11 offset:8192
  ds_read_b64_tr_b16 v[78:79], v11 offset:8704
  buffer_load_dwordx4 v[108:111], v2, s[32:35], s67 offen offset:3072 sc1
  s_lshl_b32 s67, s45, 14
  s_waitcnt vmcnt(15) lgkmcnt(7)
  v_mfma_f32_16x16x32_bf16 v[128:131], v[48:51], v[112:115], v[128:131]
  ds_read_b64_tr_b16 v[48:49], v8 offset:16384
  ds_read_b64_tr_b16 v[50:51], v8 offset:16896
  v_mfma_f32_16x16x32_bf16 v[132:135], v[52:55], v[112:115], v[132:135]
  ds_read_b64_tr_b16 v[52:53], v9 offset:16384
  ds_read_b64_tr_b16 v[54:55], v9 offset:16896
  s_add_u32 m0, s68, 32768
  s_nop 0
  buffer_load_dwordx4 v41, s[20:23], s66 offen lds
  s_add_u32 s66, s66, 32768
  v_mfma_f32_16x16x32_bf16 v[136:139], v[56:59], v[112:115], v[136:139]
  ds_read_b64_tr_b16 v[56:57], v10 offset:16384
  ds_read_b64_tr_b16 v[58:59], v10 offset:16896
  v_mfma_f32_16x16x32_bf16 v[140:143], v[60:63], v[112:115], v[140:143]
  ds_read_b64_tr_b16 v[60:61], v11 offset:16384
  ds_read_b64_tr_b16 v[62:63], v11 offset:16896
  s_waitcnt vmcnt(15) lgkmcnt(7)
  v_mfma_f32_16x16x32_bf16 v[128:131], v[64:67], v[116:119], v[128:131]
  ds_read_b64_tr_b16 v[64:65], v8 offset:24576
  ds_read_b64_tr_b16 v[66:67], v8 offset:25088
  v_mfma_f32_16x16x32_bf16 v[132:135], v[68:71], v[116:119], v[132:135]
  ds_read_b64_tr_b16 v[68:69], v9 offset:24576
  ds_read_b64_tr_b16 v[70:71], v9 offset:25088
  s_add_u32 m0, s68, 40960
  s_nop 0
  buffer_load_dwordx4 v41, s[20:23], s66 offen lds
  s_add_u32 s66, s66, 32768
  v_mfma_f32_16x16x32_bf16 v[136:139], v[72:75], v[116:119], v[136:139]
  ds_read_b64_tr_b16 v[72:73], v10 offset:24576
  ds_read_b64_tr_b16 v[74:75], v10 offset:25088
  v_mfma_f32_16x16x32_bf16 v[140:143], v[76:79], v[116:119], v[140:143]
  ds_read_b64_tr_b16 v[76:77], v11 offset:24576
  ds_read_b64_tr_b16 v[78:79], v11 offset:25088
  s_cmp_eq_u32 s43, 0
  s_cbranch_scc0 L_noxchk_6064
  s_waitcnt vmcnt(6)
  v_cmp_ne_u32 vcc, v40, v44
  s_nop 1
  s_cmp_lg_u64 vcc, 0
  s_cbranch_scc1 L_xdone_slow_6065
L_xdone_ok_6066:
L_noxchk_6064:
  s_barrier
  s_waitcnt vmcnt(15) lgkmcnt(7)
  v_mfma_f32_16x16x32_bf16 v[128:131], v[48:51], v[120:123], v[128:131]
  ds_read_b64_tr_b16 v[48:49], v8 offset:32768
  ds_read_b64_tr_b16 v[50:51], v8 offset:33280
  v_mfma_f32_16x16x32_bf16 v[132:135], v[52:55], v[120:123], v[132:135]
  ds_read_b64_tr_b16 v[52:53], v9 offset:32768
  ds_read_b64_tr_b16 v[54:55], v9 offset:33280
  s_add_u32 m0, s68, 49152
  s_nop 0
  buffer_load_dwordx4 v41, s[20:23], s66 offen lds
  s_add_u32 s66, s66, 32768
  v_mfma_f32_16x16x32_bf16 v[136:139], v[56:59], v[120:123], v[136:139]
  ds_read_b64_tr_b16 v[56:57], v10 offset:32768
  ds_read_b64_tr_b16 v[58:59], v10 offset:33280
  v_mfma_f32_16x16x32_bf16 v[140:143], v[60:63], v[120:123], v[140:143]
  ds_read_b64_tr_b16 v[60:61], v11 offset:32768
  ds_read_b64_tr_b16 v[62:63], v11 offset:33280
  buffer_load_dwordx4 v[112:115], v2, s[32:35], s67 offen offset:0 sc1
  buffer_load_dwordx4 v[116:119], v2, s[32:35], s67 offen offset:1024 sc1
  s_waitcnt vmcnt(17) lgkmcnt(7)
  v_mfma_f32_16x16x32_bf16 v[128:131], v[64:67], v[124:127], v[128:131]
  ds_read_b64_tr_b16 v[64:65], v8 offset:40960
  ds_read_b64_tr_b16 v[66:67], v8 offset:41472
  v_mfma_f32_16x16x32_bf16 v[132:135], v[68:71], v[124:127], v[132:135]
  ds_read_b64_tr_b16 v[68:69], v9 offset:40960
  ds_read_b64_tr_b16 v[70:71], v9 offset:41472
  v_mfma_f32_16x16x32_bf16 v[136:139], v[72:75], v[124:127], v[136:139]
  ds_read_b64_tr_b16 v[72:73], v10 offset:40960
  ds_read_b64_tr_b16 v[74:75], v10 offset:41472
  v_mfma_f32_16x16x32_bf16 v[140:143], v[76:79], v[124:127], v[140:143]
  ds_read_b64_tr_b16 v[76:77], v11 offset:40960
  ds_read_b64_tr_b16 v[78:79], v11 offset:41472
  buffer_load_dwordx4 v[120:123], v2, s[32:35], s67 offen offset:2048 sc1
  buffer_load_dwordx4 v[124:127], v2, s[32:35], s67 offen offset:3072 sc1
  s_add_u32 s67, s67, 4096
  s_waitcnt vmcnt(17) lgkmcnt(7)
  v_mfma_f32_16x16x32_bf16 v[128:131], v[48:51], v[80:83], v[128:131]
  ds_read_b64_tr_b16 v[48:49], v8 offset:49152
  ds_read_b64_tr_b16 v[50:51], v8 offset:49664
  v_mfma_f32_16x16x32_bf16 v[132:135], v[52:55], v[80:83], v[132:135]
  ds_read_b64_tr_b16 v[52:53], v9 offset:49152
  ds_read_b64_tr_b16 v[54:55], v9 offset:49664
  s_add_u32 m0, s68, 57344
  s_nop 0
  buffer_load_dwordx4 v41, s[20:23], s66 offen lds
  s_add_u32 s66, s66, 32768
  v_mfma_f32_16x16x32_bf16 v[136:139], v[56:59], v[80:83], v[136:139]
  ds_read_b64_tr_b16 v[56:57], v10 offset:49152
  ds_read_b64_tr_b16 v[58:59], v10 offset:49664
  v_mfma_f32_16x16x32_bf16 v[140:143], v[60:63], v[80:83], v[140:143]
  ds_read_b64_tr_b16 v[60:61], v11 offset:49152
  ds_read_b64_tr_b16 v[62:63], v11 offset:49664
  buffer_load_dwordx4 v[80:83], v2, s[32:35], s67 offen offset:0 sc1
  s_waitcnt vmcnt(18) lgkmcnt(7)
  v_mfma_f32_16x16x32_bf16 v[128:131], v[64:67], v[84:87], v[128:131]
  ds_read_b64_tr_b16 v[64:65], v8 offset:57344
  ds_read_b64_tr_b16 v[66:67], v8 offset:57856
  v_mfma_f32_16x16x32_bf16 v[132:135], v[68:71], v[84:87], v[132:135]
  ds_read_b64_tr_b16 v[68:69], v9 offset:57344
  ds_read_b64_tr_b16 v[70:71], v9 offset:57856
  s_add_u32 m0, s68, 65536
  s_nop 0
  buffer_load_dwordx4 v41, s[20:23], s66 offen lds
  s_add_u32 s66, s66, 32768
  v_mfma_f32_16x16x32_bf16 v[136:139], v[72:75], v[84:87], v[136:139]
  ds_read_b64_tr_b16 v[72:73], v10 offset:57344
  ds_read_b64_tr_b16 v[74:75], v10 offset:57856
  v_mfma_f32_16x16x32_bf16 v[140:143], v[76:79], v[84:87], v[140:143]
  ds_read_b64_tr_b16 v[76:77], v11 offset:57344
  ds_read_b64_tr_b16 v[78:79], v11 offset:57856
  buffer_load_dwordx4 v[84:87], v2, s[32:35], s67 offen offset:1024 sc1
  s_waitcnt vmcnt(19)
  s_barrier
  s_waitcnt vmcnt(18) lgkmcnt(7)
  v_mfma_f32_16x16x32_bf16 v[128:131], v[48:51], v[88:91], v[128:131]
  ds_read_b64_tr_b16 v[48:49], v12 offset:0
  ds_read_b64_tr_b16 v[50:51], v12 offset:512
  v_mfma_f32_16x16x32_bf16 v[132:135], v[52:55], v[88:91], v[132:135]
  ds_read_b64_tr_b16 v[52:53], v13 offset:0
  ds_read_b64_tr_b16 v[54:55], v13 offset:512
  v_mfma_f32_16x16x32_bf16 v[136:139], v[56:59], v[88:91], v[136:139]
  ds_read_b64_tr_b16 v[56:57], v14 offset:0
  ds_read_b64_tr_b16 v[58:59], v14 offset:512
  v_mfma_f32_16x16x32_bf16 v[140:143], v[60:63], v[88:91], v[140:143]
  ds_read_b64_tr_b16 v[60:61], v15 offset:0
  ds_read_b64_tr_b16 v[62:63], v15 offset:512
  buffer_load_dwordx4 v[88:91], v2, s[32:35], s67 offen offset:2048 sc1
  s_waitcnt vmcnt(18) lgkmcnt(7)
  v_mfma_f32_16x16x32_bf16 v[128:131], v[64:67], v[92:95], v[128:131]
  ds_read_b64_tr_b16 v[64:65], v12 offset:8192
  ds_read_b64_tr_b16 v[66:67], v12 offset:8704
  v_mfma_f32_16x16x32_bf16 v[132:135], v[68:71], v[92:95], v[132:135]
  ds_read_b64_tr_b16 v[68:69], v13 offset:8192
  ds_read_b64_tr_b16 v[70:71], v13 offset:8704
  s_add_u32 m0, s68, 73728
  s_nop 0
  buffer_load_dwordx4 v41, s[20:23], s66 offen lds
  s_add_u32 s66, s66, 32768
  v_mfma_f32_16x16x32_bf16 v[136:139], v[72:75], v[92:95], v[136:139]
  ds_read_b64_tr_b16 v[72:73], v14 offset:8192
  ds_read_b64_tr_b16 v[74:75], v14 offset:8704
  v_mfma_f32_16x16x32_bf16 v[140:143], v[76:79], v[92:95], v[140:143]
  ds_read_b64_tr_b16 v[76:77], v15 offset:8192
  ds_read_b64_tr_b16 v[78:79], v15 offset:8704
  buffer_load_dwordx4 v[92:95], v2, s[32:35], s67 offen offset:3072 sc1
  s_add_u32 s67, s67, 4096
  s_waitcnt vmcnt(19) lgkmcnt(7)
  v_mfma_f32_16x16x32_bf16 v[128:131], v[48:51], v[96:99], v[128:131]
  ds_read_b64_tr_b16 v[48:49], v4 offset:0
  ds_read_b64_tr_b16 v[50:51], v4 offset:512
  v_mfma_f32_16x16x32_bf16 v[132:135], v[52:55], v[96:99], v[132:135]
  ds_read_b64_tr_b16 v[52:53], v5 offset:0
  ds_read_b64_tr_b16 v[54:55], v5 offset:512
  s_add_u32 m0, s68, 81920
  s_nop 0
  buffer_load_dwordx4 v41, s[20:23], s66 offen lds
  s_add_u32 s66, s66, 32768
  v_mfma_f32_16x16x32_bf16 v[136:139], v[56:59], v[96:99], v[136:139]
  ds_read_b64_tr_b16 v[56:57], v6 offset:0
  ds_read_b64_tr_b16 v[58:59], v6 offset:512
  v_mfma_f32_16x16x32_bf16 v[140:143], v[60:63], v[96:99], v[140:143]
  ds_read_b64_tr_b16 v[60:61], v7 offset:0
  ds_read_b64_tr_b16 v[62:63], v7 offset:512
  buffer_load_dwordx4 v[96:99], v2, s[32:35], s67 offen offset:0 sc1
  s_waitcnt vmcnt(20) lgkmcnt(7)
  v_mfma_f32_16x16x32_bf16 v[128:131], v[64:67], v[100:103], v[128:131]
  ds_read_b64_tr_b16 v[64:65], v4 offset:8192
  ds_read_b64_tr_b16 v[66:67], v4 offset:8704
  v_mfma_f32_16x16x32_bf16 v[132:135], v[68:71], v[100:103], v[132:135]
  ds_read_b64_tr_b16 v[68:69], v5 offset:8192
  ds_read_b64_tr_b16 v[70:71], v5 offset:8704
  v_mfma_f32_16x16x32_bf16 v[136:139], v[72:75], v[100:103], v[136:139]
  ds_read_b64_tr_b16 v[72:73], v6 offset:8192
  ds_read_b64_tr_b16 v[74:75], v6 offset:8704
  v_mfma_f32_16x16x32_bf16 v[140:143], v[76:79], v[100:103], v[140:143]
  ds_read_b64_tr_b16 v[76:77], v7 offset:8192
  ds_read_b64_tr_b16 v[78:79], v7 offset:8704
  buffer_load_dwordx4 v[100:103], v2, s[32:35], s67 offen offset:1024 sc1
  s_waitcnt vmcnt(15)
  s_barrier
  s_waitcnt vmcnt(19) lgkmcnt(7)
  v_mfma_f32_16x16x32_bf16 v[128:131], v[48:51], v[104:107], v[128:131]
  ds_read_b64_tr_b16 v[48:49], v4 offset:16384
  ds_read_b64_tr_b16 v[50:51], v4 offset:16896
  v_mfma_f32_16x16x32_bf16 v[132:135], v[52:55], v[104:107], v[132:135]
  ds_read_b64_tr_b16 v[52:53], v5 offset:16384
  ds_read_b64_tr_b16 v[54:55], v5 offset:16896
  s_add_u32 m0, s68, 90112
  s_nop 0
  buffer_load_dwordx4 v41, s[20:23], s66 offen lds
  s_add_u32 s66, s66, 32768
  v_mfma_f32_16x16x32_bf16 v[136:139], v[56:59], v[104:107], v[136:139]
  ds_read_b64_tr_b16 v[56:57], v6 offset:16384
  ds_read_b64_tr_b16 v[58:59], v6 offset:16896
  v_mfma_f32_16x16x32_bf16 v[140:143], v[60:63], v[104:107], v[140:143]
  ds_read_b64_tr_b16 v[60:61], v7 offset:16384
  ds_read_b64_tr_b16 v[62:63], v7 offset:16896
  buffer_load_dwordx4 v[104:107], v2, s[32:35], s67 offen offset:2048 sc1
  s_waitcnt vmcnt(19) lgkmcnt(7)
  v_mfma_f32_16x16x32_bf16 v[128:131], v[64:67], v[108:111], v[128:131]
  ds_read_b64_tr_b16 v[64:65], v4 offset:24576
  ds_read_b64_tr_b16 v[66:67], v4 offset:25088
  v_mfma_f32_16x16x32_bf16 v[132:135], v[68:71], v[108:111], v[132:135]
  ds_read_b64_tr_b16 v[68:69], v5 offset:24576
  ds_read_b64_tr_b16 v[70:71], v5 offset:25088
  s_add_u32 m0, s68, 98304
  s_nop 0
  buffer_load_dwordx4 v41, s[20:23], s66 offen lds
  s_add_u32 s66, s66, 32768
  v_mfma_f32_16x16x32_bf16 v[136:139], v[72:75], v[108:111], v[136:139]
  ds_read_b64_tr_b16 v[72:73], v6 offset:24576
  ds_read_b64_tr_b16 v[74:75], v6 offset:25088
  v_mfma_f32_16x16x32_bf16 v[140:143], v[76:79], v[108:111], v[140:143]
  ds_read_b64_tr_b16 v[76:77], v7 offset:24576
  ds_read_b64_tr_b16 v[78:79], v7 offset:25088
  buffer_load_dwordx4 v[108:111], v2, s[32:35], s67 offen offset:3072 sc1
  s_add_u32 s67, s67, 4096
  s_cmp_eq_u32 s45, 0
  s_cbranch_scc0 L_noacc_6067
  s_nop 7
  v_mov_b32 v144, v128
  v_mov_b32 v145, v129
  v_mov_b32 v146, v130
  v_mov_b32 v147, v131
  v_mov_b32 v148, v132
  v_mov_b32 v149, v133
  v_mov_b32 v150, v134
  v_mov_b32 v151, v135
  v_mov_b32 v152, v136
  v_mov_b32 v153, v137
  v_mov_b32 v154, v138
  v_mov_b32 v155, v139
  v_mov_b32 v156, v140
  v_mov_b32 v157, v141
  v_mov_b32 v158, v142
  v_mov_b32 v159, v143
  v_mov_b32 v128, 0
  v_mov_b32 v129, 0
  v_mov_b32 v130, 0
  v_mov_b32 v131, 0
  v_mov_b32 v132, 0
  v_mov_b32 v133, 0
  v_mov_b32 v134, 0
  v_mov_b32 v135, 0
  v_mov_b32 v136, 0
  v_mov_b32 v137, 0
  v_mov_b32 v138, 0
  v_mov_b32 v139, 0
  v_mov_b32 v140, 0
  v_mov_b32 v141, 0
  v_mov_b32 v142, 0
  v_mov_b32 v143, 0
  s_nop 1
L_noacc_6067:
  s_waitcnt vmcnt(17) lgkmcnt(7)
  v_mfma_f32_16x16x32_bf16 v[128:131], v[48:51], v[112:115], v[128:131]
  ds_read_b64_tr_b16 v[48:49], v4 offset:32768
  ds_read_b64_tr_b16 v[50:51], v4 offset:33280
  v_mfma_f32_16x16x32_bf16 v[132:135], v[52:55], v[112:115], v[132:135]
  ds_read_b64_tr_b16 v[52:53], v5 offset:32768
  ds_read_b64_tr_b16 v[54:55], v5 offset:33280
  v_mfma_f32_16x16x32_bf16 v[136:139], v[56:59], v[112:115], v[136:139]
  ds_read_b64_tr_b16 v[56:57], v6 offset:32768
  ds_read_b64_tr_b16 v[58:59], v6 offset:33280
  v_mfma_f32_16x16x32_bf16 v[140:143], v[60:63], v[112:115], v[140:143]
  ds_read_b64_tr_b16 v[60:61], v7 offset:32768
  ds_read_b64_tr_b16 v[62:63], v7 offset:33280
  buffer_load_dwordx4 v[112:115], v2, s[32:35], s67 offen offset:0 sc1
  s_waitcnt vmcnt(17) lgkmcnt(7)
  v_mfma_f32_16x16x32_bf16 v[128:131], v[64:67], v[116:119], v[128:131]
  ds_read_b64_tr_b16 v[64:65], v4 offset:40960
  ds_read_b64_tr_b16 v[66:67], v4 offset:41472
  v_mfma_f32_16x16x32_bf16 v[132:135], v[68:71], v[116:119], v[132:135]
  ds_read_b64_tr_b16 v[68:69], v5 offset:40960
  ds_read_b64_tr_b16 v[70:71], v5 offset:41472
  s_add_u32 m0, s68, 106496
  s_nop 0
  buffer_load_dwordx4 v41, s[20:23], s66 offen lds
  s_add_u32 s66, s66, 32768
  v_mfma_f32_16x16x32_bf16 v[136:139], v[72:75], v[116:119], v[136:139]
  ds_read_b64_tr_b16 v[72:73], v6 offset:40960
  ds_read_b64_tr_b16 v[74:75], v6 offset:41472
  v_mfma_f32_16x16x32_bf16 v[140:143], v[76:79], v[116:119], v[140:143]
  ds_read_b64_tr_b16 v[76:77], v7 offset:40960
  ds_read_b64_tr_b16 v[78:79], v7 offset:41472
  buffer_load_dwordx4 v[116:119], v2, s[32:35], s67 offen offset:1024 sc1
  s_waitcnt vmcnt(11)
  s_barrier
  s_waitcnt vmcnt(18) lgkmcnt(7)
  v_mfma_f32_16x16x32_bf16 v[128:131], v[48:51], v[120:123], v[128:131]
  ds_read_b64_tr_b16 v[48:49], v4 offset:49152
  ds_read_b64_tr_b16 v[50:51], v4 offset:49664
  v_mfma_f32_16x16x32_bf16 v[132:135], v[52:55], v[120:123], v[132:135]
  ds_read_b64_tr_b16 v[52:53], v5 offset:49152
  ds_read_b64_tr_b16 v[54:55], v5 offset:49664
  s_add_u32 m0, s68, 114688
  s_nop 0
  buffer_load_dwordx4 v41, s[20:23], s66 offen lds
  s_add_u32 s66, s66, 32768
  v_mfma_f32_16x16x32_bf16 v[136:139], v[56:59], v[120:123], v[136:139]
  ds_read_b64_tr_b16 v[56:57], v6 offset:49152
  ds_read_b64_tr_b16 v[58:59], v6 offset:49664
  v_mfma_f32_16x16x32_bf16 v[140:143], v[60:63], v[120:123], v[140:143]
  ds_read_b64_tr_b16 v[60:61], v7 offset:49152
  ds_read_b64_tr_b16 v[62:63], v7 offset:49664
  buffer_load_dwordx4 v[120:123], v2, s[32:35], s67 offen offset:2048 sc1
  buffer_load_dwordx4 v[16:19], v3, s[16:19], 0 offen
  s_waitcnt vmcnt(20) lgkmcnt(7)
  v_mfma_f32_16x16x32_bf16 v[128:131], v[64:67], v[124:127], v[128:131]
  ds_read_b64_tr_b16 v[64:65], v4 offset:57344
  ds_read_b64_tr_b16 v[66:67], v4 offset:57856
  v_mfma_f32_16x16x32_bf16 v[132:135], v[68:71], v[124:127], v[132:135]
  ds_read_b64_tr_b16 v[68:69], v5 offset:57344
  ds_read_b64_tr_b16 v[70:71], v5 offset:57856
  v_mfma_f32_16x16x32_bf16 v[136:139], v[72:75], v[124:127], v[136:139]
  ds_read_b64_tr_b16 v[72:73], v6 offset:57344
  ds_read_b64_tr_b16 v[74:75], v6 offset:57856
  v_mfma_f32_16x16x32_bf16 v[140:143], v[76:79], v[124:127], v[140:143]
  ds_read_b64_tr_b16 v[76:77], v7 offset:57344
  ds_read_b64_tr_b16 v[78:79], v7 offset:57856
  buffer_load_dwordx4 v[124:127], v2, s[32:35], s67 offen offset:3072 sc1
  s_add_u32 s67, s67, 4096
  s_waitcnt vmcnt(19) lgkmcnt(7)
  v_mfma_f32_16x16x32_bf16 v[128:131], v[48:51], v[80:83], v[128:131]
  ds_read_b64_tr_b16 v[48:49], v8 offset:0
  ds_read_b64_tr_b16 v[50:51], v8 offset:512
  v_mfma_f32_16x16x32_bf16 v[132:135], v[52:55], v[80:83], v[132:135]
  ds_read_b64_tr_b16 v[52:53], v9 offset:0
  ds_read_b64_tr_b16 v[54:55], v9 offset:512
  s_add_u32 m0, s68, 122880
  s_nop 0
  buffer_load_dwordx4 v41, s[20:23], s66 offen lds
  s_add_u32 s66, s66, 32768
  v_mfma_f32_16x16x32_bf16 v[136:139], v[56:59], v[80:83], v[136:139]
  ds_read_b64_tr_b16 v[56:57], v10 offset:0
  ds_read_b64_tr_b16 v[58:59], v10 offset:512
  v_mfma_f32_16x16x32_bf16 v[140:143], v[60:63], v[80:83], v[140:143]
  ds_read_b64_tr_b16 v[60:61], v11 offset:0
  ds_read_b64_tr_b16 v[62:63], v11 offset:512
  s_waitcnt vmcnt(18) lgkmcnt(7)
  v_mfma_f32_16x16x32_bf16 v[128:131], v[64:67], v[84:87], v[128:131]
  ds_read_b64_tr_b16 v[64:65], v8 offset:8192
  ds_read_b64_tr_b16 v[66:67], v8 offset:8704
  v_mfma_f32_16x16x32_bf16 v[132:135], v[68:71], v[84:87], v[132:135]
  ds_read_b64_tr_b16 v[68:69], v9 offset:8192
  ds_read_b64_tr_b16 v[70:71], v9 offset:8704
  s_add_u32 m0, s68, 131072
  s_nop 0
  buffer_load_dwordx4 v41, s[20:23], s66 offen lds
  s_add_u32 s66, s66, 32768
  v_mfma_f32_16x16x32_bf16 v[136:139], v[72:75], v[84:87], v[136:139]
  ds_read_b64_tr_b16 v[72:73], v10 offset:8192
  ds_read_b64_tr_b16 v[74:75], v10 offset:8704
  v_mfma_f32_16x16x32_bf16 v[140:143], v[76:79], v[84:87], v[140:143]
  ds_read_b64_tr_b16 v[76:77], v11 offset:8192
  ds_read_b64_tr_b16 v[78:79], v11 offset:8704
  s_waitcnt vmcnt(7)
  s_barrier
  s_waitcnt vmcnt(18) lgkmcnt(7)
  v_mfma_f32_16x16x32_bf16 v[128:131], v[48:51], v[88:91], v[128:131]
  ds_read_b64_tr_b16 v[48:49], v8 offset:16384
  ds_read_b64_tr_b16 v[50:51], v8 offset:16896
  v_mfma_f32_16x16x32_bf16 v[132:135], v[52:55], v[88:91], v[132:135]
  ds_read_b64_tr_b16 v[52:53], v9 offset:16384
  ds_read_b64_tr_b16 v[54:55], v9 offset:16896
  v_mfma_f32_16x16x32_bf16 v[136:139], v[56:59], v[88:91], v[136:139]
  ds_read_b64_tr_b16 v[56:57], v10 offset:16384
  ds_read_b64_tr_b16 v[58:59], v10 offset:16896
  v_mfma_f32_16x16x32_bf16 v[140:143], v[60:63], v[88:91], v[140:143]
  ds_read_b64_tr_b16 v[60:61], v11 offset:16384
  ds_read_b64_tr_b16 v[62:63], v11 offset:16896
  s_waitcnt vmcnt(16) lgkmcnt(7)
  v_mfma_f32_16x16x32_bf16 v[128:131], v[64:67], v[92:95], v[128:131]
  ds_read_b64_tr_b16 v[64:65], v8 offset:24576
  ds_read_b64_tr_b16 v[66:67], v8 offset:25088
  v_mfma_f32_16x16x32_bf16 v[132:135], v[68:71], v[92:95], v[132:135]
  ds_read_b64_tr_b16 v[68:69], v9 offset:24576
  ds_read_b64_tr_b16 v[70:71], v9 offset:25088
  s_add_u32 m0, s68, 139264
  s_nop 0
  buffer_load_dwordx4 v41, s[20:23], s66 offen lds
  s_add_u32 s66, s66, 32768
  v_mfma_f32_16x16x32_bf16 v[136:139], v[72:75], v[92:95], v[136:139]
  ds_read_b64_tr_b16 v[72:73], v10 offset:24576
  ds_read_b64_tr_b16 v[74:75], v10 offset:25088
  v_mfma_f32_16x16x32_bf16 v[140:143], v[76:79], v[92:95], v[140:143]
  ds_read_b64_tr_b16 v[76:77], v11 offset:24576
  ds_read_b64_tr_b16 v[78:79], v11 offset:25088
  s_waitcnt vmcnt(15) lgkmcnt(7)
  v_mfma_f32_16x16x32_bf16 v[128:131], v[48:51], v[96:99], v[128:131]
  ds_read_b64_tr_b16 v[48:49], v8 offset:32768
  ds_read_b64_tr_b16 v[50:51], v8 offset:33280
  v_mfma_f32_16x16x32_bf16 v[132:135], v[52:55], v[96:99], v[132:135]
  ds_read_b64_tr_b16 v[52:53], v9 offset:32768
  ds_read_b64_tr_b16 v[54:55], v9 offset:33280
  v_mfma_f32_16x16x32_bf16 v[136:139], v[56:59], v[96:99], v[136:139]
  ds_read_b64_tr_b16 v[56:57], v10 offset:32768
  ds_read_b64_tr_b16 v[58:59], v10 offset:33280
  v_mfma_f32_16x16x32_bf16 v[140:143], v[60:63], v[96:99], v[140:143]
  ds_read_b64_tr_b16 v[60:61], v11 offset:32768
  ds_read_b64_tr_b16 v[62:63], v11 offset:33280
  s_waitcnt vmcnt(14) lgkmcnt(7)
  v_mfma_f32_16x16x32_bf16 v[128:131], v[64:67], v[100:103], v[128:131]
  ds_read_b64_tr_b16 v[64:65], v8 offset:40960
  ds_read_b64_tr_b16 v[66:67], v8 offset:41472
  v_mfma_f32_16x16x32_bf16 v[132:135], v[68:71], v[100:103], v[132:135]
  ds_read_b64_tr_b16 v[68:69], v9 offset:40960
  ds_read_b64_tr_b16 v[70:71], v9 offset:41472
  v_mfma_f32_16x16x32_bf16 v[136:139], v[72:75], v[100:103], v[136:139]
  ds_read_b64_tr_b16 v[72:73], v10 offset:40960
  ds_read_b64_tr_b16 v[74:75], v10 offset:41472
  v_mfma_f32_16x16x32_bf16 v[140:143], v[76:79], v[100:103], v[140:143]
  ds_read_b64_tr_b16 v[76:77], v11 offset:40960
  ds_read_b64_tr_b16 v[78:79], v11 offset:41472
  s_waitcnt vmcnt(0)
  s_barrier
  s_waitcnt vmcnt(12) lgkmcnt(7)
  v_mfma_f32_16x16x32_bf16 v[128:131], v[48:51], v[104:107], v[128:131]
  ds_read_b64_tr_b16 v[48:49], v8 offset:49152
  ds_read_b64_tr_b16 v[50:51], v8 offset:49664
  v_mfma_f32_16x16x32_bf16 v[132:135], v[52:55], v[104:107], v[132:135]
  ds_read_b64_tr_b16 v[52:53], v9 offset:49152
  ds_read_b64_tr_b16 v[54:55], v9 offset:49664
  v_mfma_f32_16x16x32_bf16 v[136:139], v[56:59], v[104:107], v[136:139]
  ds_read_b64_tr_b16 v[56:57], v10 offset:49152
  ds_read_b64_tr_b16 v[58:59], v10 offset:49664
  v_mfma_f32_16x16x32_bf16 v[140:143], v[60:63], v[104:107], v[140:143]
  ds_read_b64_tr_b16 v[60:61], v11 offset:49152
  ds_read_b64_tr_b16 v[62:63], v11 offset:49664
  s_waitcnt vmcnt(10) lgkmcnt(7)
  v_mfma_f32_16x16x32_bf16 v[128:131], v[64:67], v[108:111], v[128:131]
  ds_read_b64_tr_b16 v[64:65], v8 offset:57344
  ds_read_b64_tr_b16 v[66:67], v8 offset:57856
  v_mfma_f32_16x16x32_bf16 v[132:135], v[68:71], v[108:111], v[132:135]
  ds_read_b64_tr_b16 v[68:69], v9 offset:57344
  ds_read_b64_tr_b16 v[70:71], v9 offset:57856
  v_mfma_f32_16x16x32_bf16 v[136:139], v[72:75], v[108:111], v[136:139]
  ds_read_b64_tr_b16 v[72:73], v10 offset:57344
  ds_read_b64_tr_b16 v[74:75], v10 offset:57856
  v_mfma_f32_16x16x32_bf16 v[140:143], v[76:79], v[108:111], v[140:143]
  ds_read_b64_tr_b16 v[76:77], v11 offset:57344
  ds_read_b64_tr_b16 v[78:79], v11 offset:57856
  s_waitcnt vmcnt(9) lgkmcnt(7)
  v_mfma_f32_16x16x32_bf16 v[128:131], v[48:51], v[112:115], v[128:131]
  ds_read_b64_tr_b16 v[48:49], v12 offset:0
  ds_read_b64_tr_b16 v[50:51], v12 offset:512
  v_mfma_f32_16x16x32_bf16 v[132:135], v[52:55], v[112:115], v[132:135]
  ds_read_b64_tr_b16 v[52:53], v13 offset:0
  ds_read_b64_tr_b16 v[54:55], v13 offset:512
  v_mfma_f32_16x16x32_bf16 v[136:139], v[56:59], v[112:115], v[136:139]
  ds_read_b64_tr_b16 v[56:57], v14 offset:0
  ds_read_b64_tr_b16 v[58:59], v14 offset:512
  v_mfma_f32_16x16x32_bf16 v[140:143], v[60:63], v[112:115], v[140:143]
  ds_read_b64_tr_b16 v[60:61], v15 offset:0
  ds_read_b64_tr_b16 v[62:63], v15 offset:512
  s_waitcnt vmcnt(7) lgkmcnt(7)
  v_mfma_f32_16x16x32_bf16 v[128:131], v[64:67], v[116:119], v[128:131]
  ds_read_b64_tr_b16 v[64:65], v12 offset:8192
  ds_read_b64_tr_b16 v[66:67], v12 offset:8704
  v_mfma_f32_16x16x32_bf16 v[132:135], v[68:71], v[116:119], v[132:135]
  ds_read_b64_tr_b16 v[68:69], v13 offset:8192
  ds_read_b64_tr_b16 v[70:71], v13 offset:8704
  v_mfma_f32_16x16x32_bf16 v[136:139], v[72:75], v[116:119], v[136:139]
  ds_read_b64_tr_b16 v[72:73], v14 offset:8192
  ds_read_b64_tr_b16 v[74:75], v14 offset:8704
  v_mfma_f32_16x16x32_bf16 v[140:143], v[76:79], v[116:119], v[140:143]
  ds_read_b64_tr_b16 v[76:77], v15 offset:8192
  ds_read_b64_tr_b16 v[78:79], v15 offset:8704
  s_waitcnt vmcnt(5) lgkmcnt(7)
  v_mfma_f32_16x16x32_bf16 v[128:131], v[48:51], v[120:123], v[128:131]
  v_mfma_f32_16x16x32_bf16 v[132:135], v[52:55], v[120:123], v[132:135]
  v_mfma_f32_16x16x32_bf16 v[136:139], v[56:59], v[120:123], v[136:139]
  v_mfma_f32_16x16x32_bf16 v[140:143], v[60:63], v[120:123], v[140:143]
  s_waitcnt vmcnt(3) lgkmcnt(0)
  v_mfma_f32_16x16x32_bf16 v[128:131], v[64:67], v[124:127], v[128:131]
  v_mfma_f32_16x16x32_bf16 v[132:135], v[68:71], v[124:127], v[132:135]
  v_mfma_f32_16x16x32_bf16 v[136:139], v[72:75], v[124:127], v[136:139]
  v_mfma_f32_16x16x32_bf16 v[140:143], v[76:79], v[124:127], v[140:143]
  s_waitcnt vmcnt(4)
  s_nop 7
  s_mul_i32 s60, s44, 6144
  v_lshlrev_b32 v20, 4, v0
  v_add_u32 v20, s60, v20
  s_cmp_eq_u32 s45, 0
  s_cbranch_scc0 L_k2_kh1_6068
  ds_write_b128 v20, v[136:139]
  ds_write_b128 v20, v[140:143] offset:1024
  ds_write_b128 v20, v[152:155] offset:2048
  ds_write_b128 v20, v[156:159] offset:3072
  v_mov_b32 v56, v128
  v_mov_b32 v57, v129
  v_mov_b32 v58, v130
  v_mov_b32 v59, v131
  v_mov_b32 v60, v132
  v_mov_b32 v61, v133
  v_mov_b32 v62, v134
  v_mov_b32 v63, v135
  s_waitcnt lgkmcnt(0)
  s_barrier
  ds_read_b128 v[48:51], v20 offset:4096
  ds_read_b128 v[52:55], v20 offset:5120
  s_waitcnt lgkmcnt(0)
  v_pk_add_f32 v[64:65], v[144:145], v[48:49]
  v_pk_add_f32 v[66:67], v[146:147], v[50:51]
  v_pk_add_f32 v[68:69], v[148:149], v[52:53]
  v_pk_add_f32 v[70:71], v[150:151], v[54:55]
  s_branch L_k2_join_6069
L_k2_kh1_6068:
  ds_write_b128 v20, v[128:131] offset:4096
  ds_write_b128 v20, v[132:135] offset:5120
  s_waitcnt lgkmcnt(0)
  s_barrier
  ds_read_b128 v[56:59], v20
  ds_read_b128 v[60:63], v20 offset:1024
  ds_read_b128 v[48:51], v20 offset:2048
  ds_read_b128 v[52:55], v20 offset:3072
  s_waitcnt lgkmcnt(0)
  v_pk_add_f32 v[64:65], v[136:137], v[48:49]
  v_pk_add_f32 v[66:67], v[138:139], v[50:51]
  v_pk_add_f32 v[68:69], v[140:141], v[52:53]
  v_pk_add_f32 v[70:71], v[142:143], v[54:55]
L_k2_join_6069:
  s_mov_b32 s64, 0xbfb8aa3b
  v_pk_mul_f32 v[72:73], v[64:65], s[64:65] op_sel_hi:[1,0]
  v_pk_mul_f32 v[74:75], v[66:67], s[64:65] op_sel_hi:[1,0]
  v_pk_mul_f32 v[76:77], v[68:69], s[64:65] op_sel_hi:[1,0]
  v_pk_mul_f32 v[78:79], v[70:71], s[64:65] op_sel_hi:[1,0]
  v_exp_f32 v72, v72
  v_exp_f32 v73, v73
  v_exp_f32 v74, v74
  v_exp_f32 v75, v75
  v_exp_f32 v76, v76
  v_exp_f32 v77, v77
  v_exp_f32 v78, v78
  v_exp_f32 v79, v79
  v_pk_mul_f32 v[56:57], v[56:57], v[64:65]
  v_pk_mul_f32 v[58:59], v[58:59], v[66:67]
  v_pk_mul_f32 v[60:61], v[60:61], v[68:69]
  v_pk_mul_f32 v[62:63], v[62:63], v[70:71]
  v_pk_add_f32 v[72:73], v[72:73], 1.0 op_sel_hi:[1,0]
  v_pk_add_f32 v[74:75], v[74:75], 1.0 op_sel_hi:[1,0]
  v_pk_add_f32 v[76:77], v[76:77], 1.0 op_sel_hi:[1,0]
  v_pk_add_f32 v[78:79], v[78:79], 1.0 op_sel_hi:[1,0]
  v_rcp_f32 v72, v72
  v_rcp_f32 v73, v73
  v_rcp_f32 v74, v74
  v_rcp_f32 v75, v75
  v_rcp_f32 v76, v76
  v_rcp_f32 v77, v77
  v_rcp_f32 v78, v78
  v_rcp_f32 v79, v79
  v_lshlrev_b32 v64, 16, v16
  v_and_b32 v65, 0xffff0000, v16
  v_lshlrev_b32 v66, 16, v17
  v_and_b32 v67, 0xffff0000, v17
  v_lshlrev_b32 v68, 16, v18
  v_and_b32 v69, 0xffff0000, v18
  v_lshlrev_b32 v70, 16, v19
  v_and_b32 v71, 0xffff0000, v19
  v_pk_mul_f32 v[56:57], v[56:57], v[72:73]
  v_pk_mul_f32 v[58:59], v[58:59], v[74:75]
  v_pk_mul_f32 v[60:61], v[60:61], v[76:77]
  v_pk_mul_f32 v[62:63], v[62:63], v[78:79]
  s_nop 1
  v_permlane16_swap_b32 v56, v60
  v_permlane16_swap_b32 v57, v61
  v_permlane16_swap_b32 v58, v62
  v_permlane16_swap_b32 v59, v63
  s_nop 1
  v_pk_add_f32 v[56:57], v[56:57], v[64:65]
  v_pk_add_f32 v[58:59], v[58:59], v[66:67]
  v_pk_add_f32 v[60:61], v[60:61], v[68:69]
  v_pk_add_f32 v[62:63], v[62:63], v[70:71]
  v_cvt_pk_bf16_f32 v72, v56, v57
  v_cvt_pk_bf16_f32 v73, v58, v59
  v_cvt_pk_bf16_f32 v74, v60, v61
  v_cvt_pk_bf16_f32 v75, v62, v63
  buffer_store_dwordx4 v[72:75], v3, s[24:27], 0 offen sc1
  s_cmp_eq_u32 s2, 0
  s_cbranch_scc0 L_nobump_6070
  s_cmp_eq_u32 s43, 0
  s_cbranch_scc0 L_nobump_6070
  s_mov_b32 s3, 0
L_bumploop_6071:
  v_xor_b32 v248, v40, v248
  v_xor_b32 v249, v40, v249
  v_xor_b32 v250, v40, v250
  v_xor_b32 v251, v40, v251
  v_or_b32 v248, v248, v249
  v_or3_b32 v248, v248, v250, v251
  v_cmp_ne_u32 vcc, 0, v248
  s_nop 1
  s_cmp_lg_u64 vcc, 0
  s_cbranch_scc0 L_bumpgo_6072
  buffer_load_dwordx4 v[248:251], v47, s[32:35], 0 offen sc1
  s_add_u32 s3, s3, 1
  s_waitcnt vmcnt(0)
  s_cmp_lt_u32 s3, 262144
  s_cbranch_scc1 L_bumploop_6071
L_bumpgo_6072:
  v_mov_b32 v20, 0x7fffff00
  s_mov_b32 s60, 9838592
  v_writelane_b32 v20, s60, 0
  s_nop 1
  buffer_store_dword v40, v20, s[32:35], 0 offen sc1
L_nobump_6070:
  s_branch K_end
L_xdone_slow_6065:
  s_mov_b32 s3, 0
L_xdone_slow_6065_loop:
  buffer_load_dword v44, v43, s[32:35], 0 offen sc1
  s_add_u32 s3, s3, 1
  s_waitcnt vmcnt(0)
  v_cmp_ne_u32 vcc, v40, v44
  s_nop 1
  s_cmp_lg_u64 vcc, 0
  s_cbranch_scc0 L_xdone_ok_6066
  s_cmp_lt_u32 s3, 262144
  s_cbranch_scc1 L_xdone_slow_6065_loop
  s_branch L_xdone_ok_6066

K_end:
  s_endpgm
.section .rodata,"a"
.p2align 6
.amdhsa_kernel recurrent_scan__sliding_local_dilated__glu_gated_geglu__prompt_kernel
  .amdhsa_next_free_vgpr 256
  .amdhsa_next_free_sgpr 102
  .amdhsa_accum_offset 256
  .amdhsa_group_segment_fixed_size 0
  .amdhsa_kernarg_size 80
  .amdhsa_user_sgpr_count 2
  .amdhsa_user_sgpr_kernarg_segment_ptr 1
  .amdhsa_system_sgpr_workgroup_id_x 1
  .amdhsa_float_denorm_mode_32 3
.end_amdhsa_kernel
.text
```
